```python
import torch

def _softmax(x, axis=-1):
    return torch.softmax(x, dim=axis)

def _gelu(x):
    return torch.nn.functional.gelu(x, approximate='tanh')

def _silu(x):
    return torch.nn.functional.silu(x)

def _sigmoid(x):
    return torch.sigmoid(x)

def _layernorm(x, axis=-1, eps=1e-05):
    m = x.mean(dim=axis, keepdim=True)
    v = x.var(dim=axis, keepdim=True, unbiased=False)
    return (x - m) / torch.sqrt(v + eps)

def _scatter_add(tgt, idx, src, axis=0):
    return tgt.clone().index_add_(axis, idx, src)

def _segment_sum(src, seg, n):
    out = torch.zeros((n,) + src.shape[1:], dtype=src.dtype)
    return out.index_add_(0, seg, src)

def _pad(x, pw):
    flat = tuple((v for pair in reversed(pw) for v in pair))
    return torch.nn.functional.pad(x, flat)
kernel_name = 'adaLN_cond__softmax_full_mha__glu_gated_geglu__prompt'

def setup_inputs():

    _w = lambda a: (lambda t: t.to(torch.bfloat16) if t.is_floating_point() else t)(torch.as_tensor(a))

    def _A_setup():
        B, S, D = (1, 2048, 448)
        return {'x': _w((lambda *s: torch.randn(*s, dtype=torch.bfloat16) * 0.05)(B, S, D)), 'wqkv': _w((lambda *s: torch.randn(*s, dtype=torch.bfloat16) * 0.05)(D, 3 * D)), 'wo': _w((lambda *s: torch.randn(*s, dtype=torch.bfloat16) * 0.05)(D, D))}
    _A_in = _A_setup()

    def _B_setup():
        B, S, Dm, Df = (1, 2048, 448, 1792)
        return {'x': _w((lambda *s: torch.randn(*s, dtype=torch.bfloat16) * 0.05)(B, S, Dm)), 'w_gate': _w((lambda *s: torch.randn(*s, dtype=torch.bfloat16) * 0.8)(Dm, Df) * Dm ** (-0.5)), 'w_up': _w((lambda *s: torch.randn(*s, dtype=torch.bfloat16) * 0.8)(Dm, Df) * Dm ** (-0.5)), 'w_down': _w((lambda *s: torch.randn(*s, dtype=torch.bfloat16) * 0.8)(Df, Dm) * Df ** (-0.5))}
    _B_in = _B_setup()
    return {'A_x': _A_in['x'], 'A_wqkv': _A_in['wqkv'], 'A_wo': _A_in['wo'], 'B_x': _B_in['x'], 'B_w_gate': _B_in['w_gate'], 'B_w_up': _B_in['w_up'], 'B_w_down': _B_in['w_down'], 'c': _w((lambda *s: torch.randn(*s, dtype=torch.bfloat16) * 0.1)(1, 448) * 8.0), 'w_mod': _w((lambda *s: torch.randn(*s, dtype=torch.bfloat16) * 0.1)(448, 6 * 448) * 448 ** (-0.5) * 8.0)}

def reference(A_x, A_wqkv, A_wo, B_x, B_w_gate, B_w_up, B_w_down, c, w_mod):

    def _A_ref(x, wqkv, wo):
        B, S, D = x.shape
        H = 16
        Dh = D // H
        qkv = (lambda x, *d: x.permute(*d))((x @ wqkv).reshape(B, S, 3, H, Dh), 2, 0, 3, 1, 4)
        q, k, v = (qkv[0], qkv[1], qkv[2])
        scale = Dh ** (-0.5)
        scores = torch.einsum('bhqd,bhkd->bhqk', q, k) * scale
        p = _softmax(scores, axis=-1)
        o = torch.einsum('bhqk,bhkd->bhqd', p, v)
        return (lambda x, *d: x.permute(*d))(o, 0, 2, 1, 3).reshape(B, S, D) @ wo

    def _B_ref(x, w_gate, w_up, w_down):
        g = torch.einsum('bsd,df->bsf', x, w_gate)
        u = torch.einsum('bsd,df->bsf', x, w_up)
        h = _gelu(g) * u
        return torch.einsum('bsf,fd->bsd', h, w_down)
    x = A_x
    mod = (_silu(c) @ w_mod).reshape(c.shape[0], 6, 1, -1)
    sa, ca, ga, sb, cb, gb = (mod[:, 0].clone(), mod[:, 1].clone(), mod[:, 2].clone(), mod[:, 3].clone(), mod[:, 4].clone(), mod[:, 5].clone())
    h = _layernorm(x, axis=-1) * (1 + ca) + sa
    x = x + ga * _A_ref(h, A_wqkv, A_wo)
    h = _layernorm(x, axis=-1) * (1 + cb) + sb
    x = x + gb * _B_ref(h, B_w_gate, B_w_up, B_w_down)
    return x
```

```asm
; @launch grid=(256,1,1) block=(256,1,1) lds=163840
.amdgcn_target "amdgcn-amd-amdhsa--gfx950"
.text
.globl adaLN_cond__softmax_full_mha__glu_gated_geglu__prompt_kernel
.p2align 8
.type adaLN_cond__softmax_full_mha__glu_gated_geglu__prompt_kernel,@function
adaLN_cond__softmax_full_mha__glu_gated_geglu__prompt_kernel:
  s_cmp_ge_u32 s2, 256
  s_cbranch_scc1 L_end
  s_load_dwordx16 s[4:19], s[0:1], 0
  s_load_dwordx8 s[20:27], s[0:1], 64
  v_and_b32 v1, 63, v0
  v_lshrrev_b32 v2, 6, v0
  v_and_b32 v3, 31, v1
  v_readfirstlane_b32 s3, v2
  v_lshrrev_b32 v4, 5, v1
  v_lshlrev_b32 v6, 4, v1
  s_and_b32 s44, s2, 7
  s_lshr_b32 s45, s2, 3
  s_lshr_b32 s46, s44, 1
  s_lshl_b32 s46, s46, 2
  s_and_b32 s47, s45, 3
  s_add_u32 s66, s46, s47
  s_and_b32 s46, s44, 1
  s_lshl_b32 s46, s46, 3
  s_lshr_b32 s47, s45, 2
  s_add_u32 s65, s46, s47
  s_mul_hi_u32 s46, s45, 0x24924925
  s_mul_i32 s47, s46, 7
  s_sub_u32 s68, s45, s47
  s_lshl_b32 s47, s44, 2
  s_add_u32 s67, s47, s46
  s_min_u32 s67, s67, 31
  s_lshr_b32 s46, s44, 1
  s_lshl_b32 s46, s46, 2
  s_lshr_b32 s47, s45, 3
  s_add_u32 s69, s46, s47
  s_and_b32 s46, s44, 1
  s_lshl_b32 s46, s46, 3
  s_and_b32 s47, s45, 7
  s_add_u32 s70, s46, s47
  s_and_b32 s46, s3, 1
  s_lshl_b32 s75, s68, 1
  s_add_u32 s75, s75, s46
  s_lshr_b32 s46, s3, 1
  s_lshl_b32 s76, s67, 1
  s_add_u32 s76, s76, s46
  s_lshl_b32 s77, s69, 2
  s_add_u32 s77, s77, s3
  s_mul_i32 s78, s70, 200704
  s_add_u32 s78, s78, 4521984
  s_lshr_b32 s46, s45, 2
  s_lshl_b32 s46, s46, 3
  s_add_u32 s46, s46, s44
  s_lshl_b32 s58, s46, 2
  s_and_b32 s47, s45, 3
  s_add_u32 s58, s58, s47
  s_cmp_ge_u32 s46, 28
  s_cselect_b32 s59, 1, 0
  s_mul_i32 s48, s59, 28
  s_sub_u32 s48, s46, s48
  s_min_u32 s60, s48, 27
  s_mov_b32 s100, s47
  s_mul_i32 s46, s44, 28
  s_add_u32 s46, s46, s45
  s_sub_u32 s46, s46, 4
  s_and_b32 s61, s46, 15
  s_lshr_b32 s62, s46, 4
  s_cmp_lt_u32 s45, 4
  s_cselect_b32 s62, 14, s62
  s_getpc_b64 s[96:97]
L_pc:
  s_lshl_b32 s48, s45, 2
  s_add_u32 s48, s48, s3
  s_mul_hi_u32 s49, s48, 0x13b13b14
  s_mul_i32 s49, s49, 13
  s_sub_u32 s48, s48, s49
  s_lshl_b32 s48, s48, 12
  v_lshlrev_b32 v254, 6, v1
  v_add_u32 v254, s48, v254
  v_min_u32 v254, L_end-L_pc, v254
  s_waitcnt lgkmcnt(0)
  s_add_u32 s10, s68, s67
  s_and_b32 s10, s10, 3
  s_and_b32 s11, s69, 3
  s_mov_b32 s28, s26
  s_and_b32 s29, s27, 0xffff
  s_mov_b32 s30, 27525120
  s_mov_b32 s31, 0x20000
  s_load_dword s64, s[26:27], 32768
  v_mov_b32 v13, 2147483632
  s_cmp_ge_u32 s58, 56
  s_cbranch_scc1 L_nj1u_1
  s_mov_b32 s32, s20
  s_and_b32 s33, s21, 0xffff
  s_mov_b32 s34, 2408448
  s_mov_b32 s35, 0x20000
  s_mov_b32 s36, s18
  s_and_b32 s37, s19, 0xffff
  s_mov_b32 s38, 896
  s_mov_b32 s39, 0x20000
  v_lshrrev_b32 v5, 3, v0
  s_and_b32 s44, s58, 3
  s_mul_i32 s44, s44, 112
  v_add_u32 v5, s44, v5
  v_mul_u32_u24 v7, 0x1500, v5
  v_and_b32 v8, 7, v0
  v_lshl_add_u32 v7, v8, 4, v7
  s_lshr_b32 s44, s58, 2
  s_lshl_b32 s44, s44, 7
  v_add_u32 v7, s44, v7
  v_lshlrev_b32 v8, 1, v5
  v_lshrrev_b32 v9, 3, v0
  v_cmp_gt_u32 vcc, 16, v9
  v_add_u32 v9, 0, v7
  buffer_load_dwordx4 v[96:99], v9, s[32:35], 0 offen
  v_add_u32 v9, 172032, v7
  buffer_load_dwordx4 v[104:107], v9, s[32:35], 0 offen
  v_add_u32 v9, 344064, v7
  buffer_load_dwordx4 v[112:115], v9, s[32:35], 0 offen
  v_add_u32 v9, 516096, v7
  v_cndmask_b32 v9, v13, v9, vcc
  buffer_load_dwordx4 v[120:123], v9, s[32:35], 0 offen
  v_add_u32 v9, 0, v8
  buffer_load_ushort v128, v9, s[36:39], 0 offen
  v_add_u32 v9, 64, v8
  buffer_load_ushort v129, v9, s[36:39], 0 offen
  v_add_u32 v9, 128, v8
  buffer_load_ushort v130, v9, s[36:39], 0 offen
  v_add_u32 v9, 192, v8
  v_cndmask_b32 v9, v13, v9, vcc
  buffer_load_ushort v131, v9, s[36:39], 0 offen
L_nj1u_1:
  s_mov_b32 s40, s4
  s_and_b32 s41, s5, 0xffff
  s_mov_b32 s42, 1835008
  s_mov_b32 s43, 0x20000
  v_lshrrev_b32 v7, 5, v0
  s_lshl_b32 s44, s2, 3
  v_add_u32 v7, s44, v7
  v_mul_u32_u24 v7, 896, v7
  v_and_b32 v8, 31, v0
  v_lshl_add_u32 v7, v8, 5, v7
  v_cmp_gt_u32 vcc, 28, v8
  s_nop 1
  v_cndmask_b32 v7, v13, v7, vcc
  buffer_load_dwordx4 v[224:227], v7, s[40:43], 0 offen
  buffer_load_dwordx4 v[232:235], v7, s[40:43], 0 offen offset:16
  global_load_dword v255, v254, s[96:97]
  s_mov_b32 s50, s61
  s_mov_b32 s51, s62
  v_lshrrev_b32 v10, 5, v0
  v_bfe_u32 v11, v0, 3, 2
  v_and_b32 v12, 7, v0
  s_mul_i32 s48, s51, 86016
  s_mul_i32 s49, s50, 56
  s_add_u32 s48, s48, s49
  v_mul_u32_u24 v15, 21504, v11
  v_mul_u32_u24 v8, 896, v10
  v_add3_u32 v15, v15, v8, s48
  v_lshl_add_u32 v15, v12, 3, v15
  v_cmp_gt_u32 vcc, 96, v0
  v_cmp_ne_u32 s[52:53], 7, v12
  s_and_b64 vcc, vcc, s[52:53]
  s_nop 0
  v_cndmask_b32 v15, v13, v15, vcc
  v_lshrrev_b32 v14, 1, v11
  v_mul_u32_u24 v14, 3, v14
  v_add_u32 v14, v14, v10
  v_lshlrev_b32 v14, 10, v14
  v_and_b32 v9, 1, v11
  v_lshl_add_u32 v14, v9, 9, v14
  v_lshl_add_u32 v14, v12, 6, v14
  v_add_u32 v14, 148480, v14
  s_waitcnt vmcnt(1) lgkmcnt(0)
  s_add_u32 s64, s64, 2654435769
  s_cmp_ge_u32 s58, 56
  s_cbranch_scc1 L_nj1c_3
  v_lshlrev_b32 v128, 16, v128
  v_mul_f32 v136, 0xbfb8aa3b, v128
  v_lshlrev_b32 v129, 16, v129
  v_mul_f32 v137, 0xbfb8aa3b, v129
  v_lshlrev_b32 v130, 16, v130
  v_mul_f32 v138, 0xbfb8aa3b, v130
  v_lshlrev_b32 v131, 16, v131
  v_mul_f32 v139, 0xbfb8aa3b, v131
  v_exp_f32 v136, v136
  v_exp_f32 v137, v137
  v_exp_f32 v138, v138
  v_exp_f32 v139, v139
  v_add_f32 v136, 1.0, v136
  v_add_f32 v137, 1.0, v137
  v_add_f32 v138, 1.0, v138
  v_add_f32 v139, 1.0, v139
  v_rcp_f32 v136, v136
  v_rcp_f32 v137, v137
  v_rcp_f32 v138, v138
  v_rcp_f32 v139, v139
  s_nop 0
  v_mul_f32 v128, v128, v136
  v_mul_f32 v129, v129, v137
  v_mul_f32 v130, v130, v138
  v_mul_f32 v131, v131, v139
  v_cvt_pk_bf16_f32 v128, v128, v128
  v_lshlrev_b32 v128, 16, v128
  v_cvt_pk_bf16_f32 v129, v129, v129
  v_lshlrev_b32 v129, 16, v129
  v_cvt_pk_bf16_f32 v130, v130, v130
  v_lshlrev_b32 v130, 16, v130
  v_cvt_pk_bf16_f32 v131, v131, v131
  v_lshlrev_b32 v131, 16, v131
  v_lshlrev_b32 v160, 16, v96
  v_and_b32 v161, 0xffff0000, v96
  v_mul_f32 v144, v160, v128
  v_mul_f32 v145, v161, v128
  v_lshlrev_b32 v160, 16, v97
  v_and_b32 v161, 0xffff0000, v97
  v_mul_f32 v146, v160, v128
  v_mul_f32 v147, v161, v128
  v_lshlrev_b32 v160, 16, v98
  v_and_b32 v161, 0xffff0000, v98
  v_mul_f32 v152, v160, v128
  v_mul_f32 v153, v161, v128
  v_lshlrev_b32 v160, 16, v99
  v_and_b32 v161, 0xffff0000, v99
  v_mul_f32 v154, v160, v128
  v_mul_f32 v155, v161, v128
  v_lshlrev_b32 v160, 16, v104
  v_and_b32 v161, 0xffff0000, v104
  v_fmac_f32 v144, v160, v129
  v_fmac_f32 v145, v161, v129
  v_lshlrev_b32 v160, 16, v105
  v_and_b32 v161, 0xffff0000, v105
  v_fmac_f32 v146, v160, v129
  v_fmac_f32 v147, v161, v129
  v_lshlrev_b32 v160, 16, v106
  v_and_b32 v161, 0xffff0000, v106
  v_fmac_f32 v152, v160, v129
  v_fmac_f32 v153, v161, v129
  v_lshlrev_b32 v160, 16, v107
  v_and_b32 v161, 0xffff0000, v107
  v_fmac_f32 v154, v160, v129
  v_fmac_f32 v155, v161, v129
  v_lshlrev_b32 v160, 16, v112
  v_and_b32 v161, 0xffff0000, v112
  v_fmac_f32 v144, v160, v130
  v_fmac_f32 v145, v161, v130
  v_lshlrev_b32 v160, 16, v113
  v_and_b32 v161, 0xffff0000, v113
  v_fmac_f32 v146, v160, v130
  v_fmac_f32 v147, v161, v130
  v_lshlrev_b32 v160, 16, v114
  v_and_b32 v161, 0xffff0000, v114
  v_fmac_f32 v152, v160, v130
  v_fmac_f32 v153, v161, v130
  v_lshlrev_b32 v160, 16, v115
  v_and_b32 v161, 0xffff0000, v115
  v_fmac_f32 v154, v160, v130
  v_fmac_f32 v155, v161, v130
  v_lshlrev_b32 v160, 16, v120
  v_and_b32 v161, 0xffff0000, v120
  v_fmac_f32 v144, v160, v131
  v_fmac_f32 v145, v161, v131
  v_lshlrev_b32 v160, 16, v121
  v_and_b32 v161, 0xffff0000, v121
  v_fmac_f32 v146, v160, v131
  v_fmac_f32 v147, v161, v131
  v_lshlrev_b32 v160, 16, v122
  v_and_b32 v161, 0xffff0000, v122
  v_fmac_f32 v152, v160, v131
  v_fmac_f32 v153, v161, v131
  v_lshlrev_b32 v160, 16, v123
  v_and_b32 v161, 0xffff0000, v123
  v_fmac_f32 v154, v160, v131
  v_fmac_f32 v155, v161, v131
  s_nop 1
  v_add_f32_dpp v144, v144, v144 row_ror:8 row_mask:0xf bank_mask:0xf
  v_add_f32_dpp v145, v145, v145 row_ror:8 row_mask:0xf bank_mask:0xf
  v_add_f32_dpp v146, v146, v146 row_ror:8 row_mask:0xf bank_mask:0xf
  v_add_f32_dpp v147, v147, v147 row_ror:8 row_mask:0xf bank_mask:0xf
  v_add_f32_dpp v152, v152, v152 row_ror:8 row_mask:0xf bank_mask:0xf
  v_add_f32_dpp v153, v153, v153 row_ror:8 row_mask:0xf bank_mask:0xf
  v_add_f32_dpp v154, v154, v154 row_ror:8 row_mask:0xf bank_mask:0xf
  v_add_f32_dpp v155, v155, v155 row_ror:8 row_mask:0xf bank_mask:0xf
  v_mov_b32 v168, v144
  v_mov_b32 v169, v145
  v_mov_b32 v170, v146
  v_mov_b32 v171, v147
  v_mov_b32 v176, v152
  v_mov_b32 v177, v153
  v_mov_b32 v178, v154
  v_mov_b32 v179, v155
  s_nop 0
  v_permlane16_swap_b32 v144, v168
  v_permlane16_swap_b32 v145, v169
  v_permlane16_swap_b32 v146, v170
  v_permlane16_swap_b32 v147, v171
  v_permlane16_swap_b32 v152, v176
  v_permlane16_swap_b32 v153, v177
  v_permlane16_swap_b32 v154, v178
  v_permlane16_swap_b32 v155, v179
  s_nop 0
  v_add_f32 v144, v144, v168
  v_add_f32 v145, v145, v169
  v_add_f32 v146, v146, v170
  v_add_f32 v147, v147, v171
  v_add_f32 v152, v152, v176
  v_add_f32 v153, v153, v177
  v_add_f32 v154, v154, v178
  v_add_f32 v155, v155, v179
  v_mov_b32 v168, v144
  v_mov_b32 v169, v145
  v_mov_b32 v170, v146
  v_mov_b32 v171, v147
  v_mov_b32 v176, v152
  v_mov_b32 v177, v153
  v_mov_b32 v178, v154
  v_mov_b32 v179, v155
  s_nop 0
  v_permlane32_swap_b32 v144, v168
  v_permlane32_swap_b32 v145, v169
  v_permlane32_swap_b32 v146, v170
  v_permlane32_swap_b32 v147, v171
  v_permlane32_swap_b32 v152, v176
  v_permlane32_swap_b32 v153, v177
  v_permlane32_swap_b32 v154, v178
  v_permlane32_swap_b32 v155, v179
  s_nop 0
  v_add_f32 v144, v144, v168
  v_add_f32 v145, v145, v169
  v_add_f32 v146, v146, v170
  v_add_f32 v147, v147, v171
  v_add_f32 v152, v152, v176
  v_add_f32 v153, v153, v177
  v_add_f32 v154, v154, v178
  v_add_f32 v155, v155, v179
  v_lshlrev_b32 v7, 8, v2
  v_lshl_add_u32 v7, v1, 5, v7
  v_add_u32 v7, 147456, v7
  v_cmp_gt_u32 vcc, 8, v1
  s_and_saveexec_b64 s[46:47], vcc
  ds_write_b128 v7, v[144:147]
  ds_write_b128 v7, v[152:155] offset:16
  s_mov_b64 exec, s[46:47]
  s_waitcnt lgkmcnt(0)
  s_barrier
  v_and_b32 v7, 63, v0
  v_lshlrev_b32 v7, 2, v7
  v_add_u32 v7, 147456, v7
  ds_read_b32 v136, v7 offset:0
  ds_read_b32 v137, v7 offset:256
  ds_read_b32 v138, v7 offset:512
  ds_read_b32 v139, v7 offset:768
  v_mov_b32 v9, s64
  s_and_b32 s44, s58, 3
  s_mul_i32 s44, s44, 21504
  s_lshr_b32 s45, s58, 2
  s_lshl_b32 s45, s45, 9
  s_add_u32 s44, s44, s45
  s_add_u32 s44, s44, 25427968
  v_lshlrev_b32 v7, 3, v0
  v_cmp_gt_u32 vcc, 64, v0
  s_waitcnt lgkmcnt(0)
  v_add_f32 v136, v136, v137
  v_add_f32 v138, v138, v139
  v_add_f32 v8, v136, v138
  v_cndmask_b32 v7, v13, v7, vcc
  buffer_store_dwordx2 v[8:9], v7, s[28:31], s44 offen sc1
L_nj1c_3:
  s_mov_b32 s40, s6
  s_and_b32 s41, s7, 0xffff
  s_mov_b32 s42, 1204224
  s_mov_b32 s43, 0x20000
  s_cmp_ge_u32 s62, 14
  s_cselect_b32 s42, 0, s42
  v_add_u32 v9, 0, v15
  buffer_load_dwordx2 v[184:185], v9, s[40:43], 0 offen
  v_add_u32 v9, 2688, v15
  buffer_load_dwordx2 v[186:187], v9, s[40:43], 0 offen
  v_add_u32 v9, 5376, v15
  buffer_load_dwordx2 v[192:193], v9, s[40:43], 0 offen
  v_add_u32 v9, 8064, v15
  buffer_load_dwordx2 v[194:195], v9, s[40:43], 0 offen
  v_add_u32 v9, 10752, v15
  buffer_load_dwordx2 v[200:201], v9, s[40:43], 0 offen
  v_add_u32 v9, 13440, v15
  buffer_load_dwordx2 v[202:203], v9, s[40:43], 0 offen
  v_add_u32 v9, 16128, v15
  buffer_load_dwordx2 v[208:209], v9, s[40:43], 0 offen
  v_add_u32 v9, 18816, v15
  buffer_load_dwordx2 v[210:211], v9, s[40:43], 0 offen
  s_cmp_lt_u32 s58, 56
  s_cbranch_scc1 L_nj1n_2
  s_cmp_ge_u32 s58, 168
  s_cbranch_scc1 L_nj1n_2
  s_mov_b32 s32, s20
  s_and_b32 s33, s21, 0xffff
  s_mov_b32 s34, 2408448
  s_mov_b32 s35, 0x20000
  s_mov_b32 s36, s18
  s_and_b32 s37, s19, 0xffff
  s_mov_b32 s38, 896
  s_mov_b32 s39, 0x20000
  v_lshrrev_b32 v5, 3, v0
  s_and_b32 s44, s58, 3
  s_mul_i32 s44, s44, 112
  v_add_u32 v5, s44, v5
  v_mul_u32_u24 v7, 0x1500, v5
  v_and_b32 v8, 7, v0
  v_lshl_add_u32 v7, v8, 4, v7
  s_lshr_b32 s44, s58, 2
  s_lshl_b32 s44, s44, 7
  v_add_u32 v7, s44, v7
  v_lshlrev_b32 v8, 1, v5
  v_lshrrev_b32 v9, 3, v0
  v_cmp_gt_u32 vcc, 16, v9
  v_add_u32 v9, 0, v7
  buffer_load_dwordx4 v[96:99], v9, s[32:35], 0 offen
  v_add_u32 v9, 172032, v7
  buffer_load_dwordx4 v[104:107], v9, s[32:35], 0 offen
  v_add_u32 v9, 344064, v7
  buffer_load_dwordx4 v[112:115], v9, s[32:35], 0 offen
  v_add_u32 v9, 516096, v7
  v_cndmask_b32 v9, v13, v9, vcc
  buffer_load_dwordx4 v[120:123], v9, s[32:35], 0 offen
  v_add_u32 v9, 0, v8
  buffer_load_ushort v128, v9, s[36:39], 0 offen
  v_add_u32 v9, 64, v8
  buffer_load_ushort v129, v9, s[36:39], 0 offen
  v_add_u32 v9, 128, v8
  buffer_load_ushort v130, v9, s[36:39], 0 offen
  v_add_u32 v9, 192, v8
  v_cndmask_b32 v9, v13, v9, vcc
  buffer_load_ushort v131, v9, s[36:39], 0 offen
L_nj1n_2:
  v_mov_b32 v40, v14
  s_cmp_eq_u32 s3, 3
  s_cbranch_scc1 L_b3_4
  s_cmp_eq_u32 s59, 0
  s_cselect_b32 s32, s12, s14
  s_cselect_b32 s33, s13, s15
  s_and_b32 s33, s33, 0xffff
  s_mov_b32 s34, 1605632
  s_mov_b32 s35, 0x20000
  v_lshrrev_b32 v14, 3, v0
  v_min_u32 v14, 13, v14
  v_lshrrev_b32 v15, 1, v14
  v_and_b32 v14, 1, v14
  v_lshlrev_b32 v15, 4, v15
  v_lshl_add_u32 v15, v14, 2, v15
  s_mul_i32 s44, s100, 112
  v_add_u32 v15, s44, v15
  v_mul_u32_u24 v15, 3584, v15
  v_and_b32 v14, 7, v0
  v_lshl_add_u32 v5, v14, 4, v15
  s_lshl_b32 s44, s60, 7
  v_add_u32 v5, s44, v5
  v_mov_b32 v0, v5
  s_mov_b32 s63, 3584
  s_branch L_be_5
L_b3_4:
  s_min_u32 s55, s2, 251
  s_mul_hi_u32 s48, s55, 0x71c71c8
  s_mul_i32 s49, s48, 36
  s_sub_u32 s49, s55, s49
  s_cmp_lt_u32 s49, 28
  s_cselect_b32 s32, s16, s8
  s_cselect_b32 s33, s17, s9
  s_mov_b32 s34, 401408
  s_cselect_b32 s34, 1605632, s34
  s_cselect_b32 s54, 1, 0
  s_and_b32 s33, s33, 0xffff
  s_mov_b32 s35, 0x20000
  s_sub_u32 s44, s49, 28
  s_cmp_eq_u32 s54, 1
  s_cselect_b32 s44, s49, s44
  s_lshl_b32 s44, s44, 3
  v_lshrrev_b32 v10, 3, v1
  v_add_u32 v10, s44, v10
  s_lshl_b32 s48, s48, 3
  v_and_b32 v9, 7, v1
  v_add_u32 v9, s48, v9
  v_lshrrev_b32 v11, 1, v10
  v_and_b32 v12, 1, v10
  v_lshlrev_b32 v15, 4, v11
  v_lshl_add_u32 v15, v12, 2, v15
  v_lshrrev_b32 v8, 1, v11
  v_mul_u32_u24 v8, 28, v8
  v_and_b32 v14, 1, v11
  v_lshlrev_b32 v14, 4, v14
  v_lshl_add_u32 v14, v12, 2, v14
  v_add_u32 v8, v8, v14
  s_cmp_eq_u32 s54, 1
  s_cselect_b64 s[52:53], -1, 0
  v_cndmask_b32 v15, v8, v15, s[52:53]
  v_mov_b32 v8, -64
  v_cndmask_b32 v14, v14, v8, s[52:53]
  v_mul_u32_u24 v5, 896, v15
  v_lshl_add_u32 v5, v9, 4, v5
  v_add_u32 v8, 8, v14
  v_cmp_gt_i32 vcc, 28, v8
  v_mov_b32 v10, 2147483632
  s_nop 0
  v_cndmask_b32 v0, v10, v5, vcc
  s_mov_b32 s63, 896
L_be_5:
  s_mul_i32 s44, s63, 0
  buffer_load_dwordx4 a[100:103], v5, s[32:35], s44 offen
  s_mul_i32 s44, s63, 1
  buffer_load_dwordx4 a[104:107], v5, s[32:35], s44 offen
  s_mul_i32 s44, s63, 2
  buffer_load_dwordx4 a[108:111], v5, s[32:35], s44 offen
  s_mul_i32 s44, s63, 3
  buffer_load_dwordx4 a[112:115], v5, s[32:35], s44 offen
  s_mul_i32 s44, s63, 8
  buffer_load_dwordx4 a[116:119], v0, s[32:35], s44 offen
  s_mul_i32 s44, s63, 9
  buffer_load_dwordx4 a[120:123], v0, s[32:35], s44 offen
  s_mul_i32 s44, s63, 10
  buffer_load_dwordx4 a[124:127], v0, s[32:35], s44 offen
  s_mul_i32 s44, s63, 11
  buffer_load_dwordx4 a[128:131], v0, s[32:35], s44 offen
  s_lshl_b32 s44, s3, 6
  v_or_b32 v0, s44, v1
  v_mov_b32 v13, 2147483632
  v_mov_b32 v14, v40
  s_mov_b32 s44, 0xffff0000
  v_lshlrev_b32 v16, 16, v224
  v_and_b32 v17, s44, v224
  v_lshlrev_b32 v18, 16, v225
  v_and_b32 v19, s44, v225
  v_lshlrev_b32 v20, 16, v226
  v_and_b32 v21, s44, v226
  v_lshlrev_b32 v22, 16, v227
  v_and_b32 v23, s44, v227
  v_lshlrev_b32 v24, 16, v232
  v_and_b32 v25, s44, v232
  v_lshlrev_b32 v26, 16, v233
  v_and_b32 v27, s44, v233
  v_lshlrev_b32 v28, 16, v234
  v_and_b32 v29, s44, v234
  v_lshlrev_b32 v30, 16, v235
  v_and_b32 v31, s44, v235
  v_add_f32 v8, v16, v17
  v_add_f32 v8, v8, v18
  v_add_f32 v8, v8, v19
  v_add_f32 v8, v8, v20
  v_add_f32 v8, v8, v21
  v_add_f32 v8, v8, v22
  v_add_f32 v8, v8, v23
  v_add_f32 v8, v8, v24
  v_add_f32 v8, v8, v25
  v_add_f32 v8, v8, v26
  v_add_f32 v8, v8, v27
  v_add_f32 v8, v8, v28
  v_add_f32 v8, v8, v29
  v_add_f32 v8, v8, v30
  v_add_f32 v8, v8, v31
  s_nop 1
  v_add_f32_dpp v8, v8, v8 row_ror:8 row_mask:0xf bank_mask:0xf
  s_nop 1
  v_add_f32_dpp v8, v8, v8 row_ror:4 row_mask:0xf bank_mask:0xf
  s_nop 1
  v_add_f32_dpp v8, v8, v8 row_ror:2 row_mask:0xf bank_mask:0xf
  s_nop 1
  v_add_f32_dpp v8, v8, v8 row_ror:1 row_mask:0xf bank_mask:0xf
  v_mov_b32 v9, v8
  s_nop 1
  v_permlane16_swap_b32 v8, v9
  s_nop 1
  v_add_f32 v8, v8, v9
  v_mul_f32 v8, 0x3b124925, v8
  v_and_b32 v10, 31, v0
  v_cmp_gt_u32 vcc, 28, v10
  v_mov_b32 v11, 0
  s_nop 0
  v_cndmask_b32 v11, v11, v8, vcc
  v_sub_f32 v16, v16, v11
  v_sub_f32 v17, v17, v11
  v_sub_f32 v18, v18, v11
  v_sub_f32 v19, v19, v11
  v_sub_f32 v20, v20, v11
  v_sub_f32 v21, v21, v11
  v_sub_f32 v22, v22, v11
  v_sub_f32 v23, v23, v11
  v_sub_f32 v24, v24, v11
  v_sub_f32 v25, v25, v11
  v_sub_f32 v26, v26, v11
  v_sub_f32 v27, v27, v11
  v_sub_f32 v28, v28, v11
  v_sub_f32 v29, v29, v11
  v_sub_f32 v30, v30, v11
  v_sub_f32 v31, v31, v11
  v_mul_f32 v9, v16, v16
  v_fmac_f32 v9, v17, v17
  v_fmac_f32 v9, v18, v18
  v_fmac_f32 v9, v19, v19
  v_fmac_f32 v9, v20, v20
  v_fmac_f32 v9, v21, v21
  v_fmac_f32 v9, v22, v22
  v_fmac_f32 v9, v23, v23
  v_fmac_f32 v9, v24, v24
  v_fmac_f32 v9, v25, v25
  v_fmac_f32 v9, v26, v26
  v_fmac_f32 v9, v27, v27
  v_fmac_f32 v9, v28, v28
  v_fmac_f32 v9, v29, v29
  v_fmac_f32 v9, v30, v30
  v_fmac_f32 v9, v31, v31
  s_nop 1
  v_add_f32_dpp v9, v9, v9 row_ror:8 row_mask:0xf bank_mask:0xf
  s_nop 1
  v_add_f32_dpp v9, v9, v9 row_ror:4 row_mask:0xf bank_mask:0xf
  s_nop 1
  v_add_f32_dpp v9, v9, v9 row_ror:2 row_mask:0xf bank_mask:0xf
  s_nop 1
  v_add_f32_dpp v9, v9, v9 row_ror:1 row_mask:0xf bank_mask:0xf
  v_mov_b32 v10, v9
  s_nop 1
  v_permlane16_swap_b32 v9, v10
  s_nop 1
  v_add_f32 v9, v9, v10
  v_mul_f32 v9, 0x3b124925, v9
  v_add_f32 v9, 0x3727c5ac, v9
  v_rsq_f32 v9, v9
  s_nop 0
  v_mul_f32 v16, v16, v9
  v_mul_f32 v17, v17, v9
  v_mul_f32 v18, v18, v9
  v_mul_f32 v19, v19, v9
  v_mul_f32 v20, v20, v9
  v_mul_f32 v21, v21, v9
  v_mul_f32 v22, v22, v9
  v_mul_f32 v23, v23, v9
  v_mul_f32 v24, v24, v9
  v_mul_f32 v25, v25, v9
  v_mul_f32 v26, v26, v9
  v_mul_f32 v27, v27, v9
  v_mul_f32 v28, v28, v9
  v_mul_f32 v29, v29, v9
  v_mul_f32 v30, v30, v9
  v_mul_f32 v31, v31, v9
  s_waitcnt vmcnt(8)
  s_mov_b32 s46, 0x05040100
  s_mov_b32 s47, 0x07060302
  v_perm_b32 v32, v186, v184, s46
  v_perm_b32 v33, v194, v192, s46
  v_perm_b32 v34, v202, v200, s46
  v_perm_b32 v35, v210, v208, s46
  v_perm_b32 v36, v186, v184, s47
  v_perm_b32 v37, v194, v192, s47
  v_perm_b32 v38, v202, v200, s47
  v_perm_b32 v39, v210, v208, s47
  v_perm_b32 v40, v187, v185, s46
  v_perm_b32 v41, v195, v193, s46
  v_perm_b32 v42, v203, v201, s46
  v_perm_b32 v43, v211, v209, s46
  v_perm_b32 v44, v187, v185, s47
  v_perm_b32 v45, v195, v193, s47
  v_perm_b32 v46, v203, v201, s47
  v_perm_b32 v47, v211, v209, s47
  s_cmp_ge_u32 s62, 14
  s_cbranch_scc1 L_noj2_6
  v_cmp_gt_u32 vcc, 96, v0
  s_and_saveexec_b64 s[52:53], vcc
  ds_write_b128 v14, v[32:35] offset:0
  ds_write_b128 v14, v[36:39] offset:16
  ds_write_b128 v14, v[40:43] offset:32
  ds_write_b128 v14, v[44:47] offset:48
  s_mov_b64 exec, s[52:53]
  s_waitcnt lgkmcnt(0)
  s_barrier
  s_mul_i32 s48, s61, 86016
  s_mul_i32 s49, s62, 6144
  s_add_u32 s48, s48, s49
  s_add_u32 s48, s48, 1048576
  s_lshl_b32 s49, s3, 10
  s_add_u32 s48, s48, s49
  v_add_u32 v7, s49, v6
  v_add_u32 v7, 148480, v7
  ds_read_b128 v[32:35], v7
  ds_read_b128 v[36:39], v7 offset:4096
  s_waitcnt lgkmcnt(0)
  buffer_store_dwordx4 v[32:35], v6, s[28:31], s48 offen sc1
  s_cmp_ge_u32 s3, 2
  s_cbranch_scc1 L_noj2b_7
  s_add_u32 s48, s48, 4096
  buffer_store_dwordx4 v[36:39], v6, s[28:31], s48 offen sc1
L_noj2b_7:
L_noj2_6:
  s_mul_i32 s44, s61, 14
  s_add_u32 s44, s44, s62
  s_cmp_ge_u32 s62, 14
  s_cselect_b32 s44, 255, s44
  s_lshl_b32 s44, s44, 8
  s_add_u32 s101, s44, 655360
  s_waitcnt vmcnt(0)
  s_barrier
  s_cmp_lg_u32 s3, 0
  s_cbranch_scc1 L_pub_8
  v_mov_b32 v14, s64
  v_mov_b32 v15, 0
  s_mov_b64 exec, 1
  buffer_store_dword v14, v15, s[28:31], s101 offen sc1
  s_mov_b64 exec, -1
L_pub_8:
  v_min_u32 v5, 223, v0
  v_lshlrev_b32 v7, 4, v5
  v_add_u32 v14, 3584, v7
  s_mov_b32 s18, 25427968
  s_mov_b32 s19, 25449472
  s_mov_b32 s20, 25470976
  s_mov_b32 s21, 25492480
  s_mov_b32 s71, 0
L_mod_9:
  buffer_load_dwordx4 v[48:51], v14, s[28:31], s18 offen sc1
  buffer_load_dwordx4 v[64:67], v7, s[28:31], s18 offen sc1
  buffer_load_dwordx4 v[52:55], v14, s[28:31], s19 offen sc1
  buffer_load_dwordx4 v[68:71], v7, s[28:31], s19 offen sc1
  buffer_load_dwordx4 v[56:59], v14, s[28:31], s20 offen sc1
  buffer_load_dwordx4 v[72:75], v7, s[28:31], s20 offen sc1
  buffer_load_dwordx4 v[60:63], v14, s[28:31], s21 offen sc1
  buffer_load_dwordx4 v[76:79], v7, s[28:31], s21 offen sc1
  s_waitcnt vmcnt(0)
  v_cmp_ne_u32 vcc, s64, v49
  v_cmp_ne_u32 s[56:57], s64, v51
  s_or_b64 vcc, vcc, s[56:57]
  v_cmp_ne_u32 s[56:57], s64, v65
  s_or_b64 vcc, vcc, s[56:57]
  v_cmp_ne_u32 s[56:57], s64, v67
  s_or_b64 vcc, vcc, s[56:57]
  v_cmp_ne_u32 s[56:57], s64, v53
  s_or_b64 vcc, vcc, s[56:57]
  v_cmp_ne_u32 s[56:57], s64, v55
  s_or_b64 vcc, vcc, s[56:57]
  v_cmp_ne_u32 s[56:57], s64, v69
  s_or_b64 vcc, vcc, s[56:57]
  v_cmp_ne_u32 s[56:57], s64, v71
  s_or_b64 vcc, vcc, s[56:57]
  v_cmp_ne_u32 s[56:57], s64, v57
  s_or_b64 vcc, vcc, s[56:57]
  v_cmp_ne_u32 s[56:57], s64, v59
  s_or_b64 vcc, vcc, s[56:57]
  v_cmp_ne_u32 s[56:57], s64, v73
  s_or_b64 vcc, vcc, s[56:57]
  v_cmp_ne_u32 s[56:57], s64, v75
  s_or_b64 vcc, vcc, s[56:57]
  v_cmp_ne_u32 s[56:57], s64, v61
  s_or_b64 vcc, vcc, s[56:57]
  v_cmp_ne_u32 s[56:57], s64, v63
  s_or_b64 vcc, vcc, s[56:57]
  v_cmp_ne_u32 s[56:57], s64, v77
  s_or_b64 vcc, vcc, s[56:57]
  v_cmp_ne_u32 s[56:57], s64, v79
  s_or_b64 vcc, vcc, s[56:57]
  s_add_u32 s71, s71, 1
  s_cmp_gt_u32 s71, 400000
  s_cbranch_scc1 L_modd_10
  s_cbranch_vccnz L_mod_9
L_modd_10:
  v_add_f32 v48, v48, v52
  v_add_f32 v56, v56, v60
  v_add_f32 v48, v48, v56
  v_add_f32 v50, v50, v54
  v_add_f32 v58, v58, v62
  v_add_f32 v50, v50, v58
  v_add_f32 v64, v64, v68
  v_add_f32 v72, v72, v76
  v_add_f32 v64, v64, v72
  v_add_f32 v66, v66, v70
  v_add_f32 v74, v74, v78
  v_add_f32 v66, v66, v74
  v_cvt_pk_bf16_f32 v8, v48, v50
  v_cvt_pk_bf16_f32 v9, v64, v66
  s_mov_b32 s44, 0xffff0000
  v_lshlrev_b32 v10, 16, v8
  v_and_b32 v11, s44, v8
  v_add_f32 v10, 1.0, v10
  v_add_f32 v11, 1.0, v11
  v_cvt_pk_bf16_f32 v8, v10, v11
  v_lshlrev_b32 v10, 16, v8
  v_and_b32 v11, s44, v8
  v_lshlrev_b32 v8, 16, v9
  v_and_b32 v9, s44, v9
  v_lshlrev_b32 v12, 3, v5
  v_add_u32 v12, 86016, v12
  ds_write_b64 v12, v[10:11]
  ds_write_b64 v12, v[8:9] offset:1792
  s_waitcnt lgkmcnt(0)
  s_barrier
  v_and_b32 v10, 31, v0
  v_min_u32 v10, 27, v10
  v_lshlrev_b32 v12, 6, v10
  v_add_u32 v12, 86016, v12
  ds_read_b128 v[48:51], v12 offset:0
  ds_read_b128 v[64:67], v12 offset:1792
  ds_read_b128 v[52:55], v12 offset:16
  ds_read_b128 v[68:71], v12 offset:1808
  ds_read_b128 v[56:59], v12 offset:32
  ds_read_b128 v[72:75], v12 offset:1824
  ds_read_b128 v[60:63], v12 offset:48
  ds_read_b128 v[76:79], v12 offset:1840
  s_waitcnt lgkmcnt(0)
  v_fmac_f32 v64, v16, v48
  v_fmac_f32 v65, v17, v49
  v_fmac_f32 v66, v18, v50
  v_fmac_f32 v67, v19, v51
  v_fmac_f32 v68, v20, v52
  v_fmac_f32 v69, v21, v53
  v_fmac_f32 v70, v22, v54
  v_fmac_f32 v71, v23, v55
  v_fmac_f32 v72, v24, v56
  v_fmac_f32 v73, v25, v57
  v_fmac_f32 v74, v26, v58
  v_fmac_f32 v75, v27, v59
  v_fmac_f32 v76, v28, v60
  v_fmac_f32 v77, v29, v61
  v_fmac_f32 v78, v30, v62
  v_fmac_f32 v79, v31, v63
  v_cvt_pk_bf16_f32 v16, v64, v65
  v_cvt_pk_bf16_f32 v17, v66, v67
  v_cvt_pk_bf16_f32 v18, v68, v69
  v_cvt_pk_bf16_f32 v19, v70, v71
  v_cvt_pk_bf16_f32 v20, v72, v73
  v_cvt_pk_bf16_f32 v21, v74, v75
  v_cvt_pk_bf16_f32 v22, v76, v77
  v_cvt_pk_bf16_f32 v23, v78, v79
  v_lshrrev_b32 v12, 5, v0
  v_lshlrev_b32 v12, 4, v12
  v_lshl_add_u32 v12, v10, 8, v12
  v_add_u32 v12, 90112, v12
  v_and_b32 v11, 31, v0
  v_cmp_gt_u32 vcc, 28, v11
  s_and_saveexec_b64 s[46:47], vcc
  ds_write_b128 v12, v[16:19]
  ds_write_b128 v12, v[20:23] offset:128
  s_mov_b64 exec, s[46:47]
  s_waitcnt lgkmcnt(0)
  s_barrier
  s_lshl_b32 s44, s3, 10
  v_add_u32 v12, s44, v6
  v_add_u32 v12, 90112, v12
  ds_read_b128 v[48:51], v12
  ds_read_b128 v[52:55], v12 offset:4096
  v_lshrrev_b32 v11, 3, v1
  v_lshlrev_b32 v11, 9, v11
  v_and_b32 v12, 7, v1
  v_lshl_add_u32 v11, v12, 4, v11
  s_lshr_b32 s44, s2, 2
  s_mul_i32 s44, s44, 28672
  s_and_b32 s45, s2, 3
  s_lshl_b32 s45, s45, 7
  s_add_u32 s44, s44, s45
  s_lshl_b32 s45, s3, 12
  s_add_u32 s44, s44, s45
  s_add_u32 s44, s44, 25559040
  s_waitcnt lgkmcnt(0)
  buffer_store_dwordx4 v[48:51], v11, s[28:31], s44 offen sc1
  s_cmp_eq_u32 s3, 3
  s_cbranch_scc1 L_h3_11
  s_add_u32 s44, s44, 16384
  buffer_store_dwordx4 v[52:55], v11, s[28:31], s44 offen sc1
L_h3_11:
  s_mul_i32 s44, s66, 3584
  s_add_u32 s48, s44, 655360
  s_cmp_lg_u32 s3, 0
  s_cbranch_scc1 L_wait_12
  v_min_u32 v8, 13, v1
  v_lshlrev_b32 v8, 8, v8
  s_mov_b32 s71, 0
L_poll_13:
  buffer_load_dword v9, v8, s[28:31], s48 offen sc1
  s_waitcnt vmcnt(0)
  v_cmp_ne_u32 vcc, s64, v9
  s_add_u32 s71, s71, 1
  s_cmp_gt_u32 s71, 400000
  s_cbranch_scc1 L_wait_12
  s_cbranch_vccnz L_poll_13
L_wait_12:
  s_waitcnt vmcnt(0)
  s_barrier
  s_lshl_b32 s44, s2, 8
  s_add_u32 s48, s44, 917504
  s_cmp_lg_u32 s3, 0
  s_cbranch_scc1 L_pub_14
  v_mov_b32 v14, s64
  v_mov_b32 v15, 0
  s_mov_b64 exec, 1
  buffer_store_dword v14, v15, s[28:31], s48 offen sc1
  s_mov_b64 exec, -1
L_pub_14:
  s_mul_i32 s52, s66, 86016
  s_add_u32 s52, s52, 1048576
  s_and_b32 s46, s65, 7
  s_mul_i32 s46, s46, 5
  s_lshr_b32 s46, s46, 1
  s_lshl_b32 s46, s46, 12
  s_lshl_b32 s45, s3, 10
  s_add_u32 s47, s46, s45
  s_mov_b32 m0, s47
  s_add_u32 s47, s47, s52
  buffer_load_dwordx4 v6, s[28:31], s47 offen sc1 lds
  s_add_u32 s46, s46, 4096
  s_cmp_ge_u32 s46, 86016
  s_cselect_b32 s46, 0, s46
  s_add_u32 s47, s46, s45
  s_mov_b32 m0, s47
  s_add_u32 s47, s47, s52
  buffer_load_dwordx4 v6, s[28:31], s47 offen sc1 lds
  s_add_u32 s46, s46, 4096
  s_cmp_ge_u32 s46, 86016
  s_cselect_b32 s46, 0, s46
  s_add_u32 s47, s46, s45
  s_mov_b32 m0, s47
  s_add_u32 s47, s47, s52
  buffer_load_dwordx4 v6, s[28:31], s47 offen sc1 lds
  s_add_u32 s46, s46, 4096
  s_cmp_ge_u32 s46, 86016
  s_cselect_b32 s46, 0, s46
  s_add_u32 s47, s46, s45
  s_mov_b32 m0, s47
  s_add_u32 s47, s47, s52
  buffer_load_dwordx4 v6, s[28:31], s47 offen sc1 lds
  s_add_u32 s46, s46, 4096
  s_cmp_ge_u32 s46, 86016
  s_cselect_b32 s46, 0, s46
  s_add_u32 s47, s46, s45
  s_mov_b32 m0, s47
  s_add_u32 s47, s47, s52
  buffer_load_dwordx4 v6, s[28:31], s47 offen sc1 lds
  s_add_u32 s46, s46, 4096
  s_cmp_ge_u32 s46, 86016
  s_cselect_b32 s46, 0, s46
  s_add_u32 s47, s46, s45
  s_mov_b32 m0, s47
  s_add_u32 s47, s47, s52
  buffer_load_dwordx4 v6, s[28:31], s47 offen sc1 lds
  s_add_u32 s46, s46, 4096
  s_cmp_ge_u32 s46, 86016
  s_cselect_b32 s46, 0, s46
  s_add_u32 s47, s46, s45
  s_mov_b32 m0, s47
  s_add_u32 s47, s47, s52
  buffer_load_dwordx4 v6, s[28:31], s47 offen sc1 lds
  s_add_u32 s46, s46, 4096
  s_cmp_ge_u32 s46, 86016
  s_cselect_b32 s46, 0, s46
  s_add_u32 s47, s46, s45
  s_mov_b32 m0, s47
  s_add_u32 s47, s47, s52
  buffer_load_dwordx4 v6, s[28:31], s47 offen sc1 lds
  s_add_u32 s46, s46, 4096
  s_cmp_ge_u32 s46, 86016
  s_cselect_b32 s46, 0, s46
  s_add_u32 s47, s46, s45
  s_mov_b32 m0, s47
  s_add_u32 s47, s47, s52
  buffer_load_dwordx4 v6, s[28:31], s47 offen sc1 lds
  s_add_u32 s46, s46, 4096
  s_cmp_ge_u32 s46, 86016
  s_cselect_b32 s46, 0, s46
  s_add_u32 s47, s46, s45
  s_mov_b32 m0, s47
  s_add_u32 s47, s47, s52
  buffer_load_dwordx4 v6, s[28:31], s47 offen sc1 lds
  s_add_u32 s46, s46, 4096
  s_cmp_ge_u32 s46, 86016
  s_cselect_b32 s46, 0, s46
  s_add_u32 s47, s46, s45
  s_mov_b32 m0, s47
  s_add_u32 s47, s47, s52
  buffer_load_dwordx4 v6, s[28:31], s47 offen sc1 lds
  s_add_u32 s46, s46, 4096
  s_cmp_ge_u32 s46, 86016
  s_cselect_b32 s46, 0, s46
  s_add_u32 s47, s46, s45
  s_mov_b32 m0, s47
  s_add_u32 s47, s47, s52
  buffer_load_dwordx4 v6, s[28:31], s47 offen sc1 lds
  s_add_u32 s46, s46, 4096
  s_cmp_ge_u32 s46, 86016
  s_cselect_b32 s46, 0, s46
  s_add_u32 s47, s46, s45
  s_mov_b32 m0, s47
  s_add_u32 s47, s47, s52
  buffer_load_dwordx4 v6, s[28:31], s47 offen sc1 lds
  s_add_u32 s46, s46, 4096
  s_cmp_ge_u32 s46, 86016
  s_cselect_b32 s46, 0, s46
  s_add_u32 s47, s46, s45
  s_mov_b32 m0, s47
  s_add_u32 s47, s47, s52
  buffer_load_dwordx4 v6, s[28:31], s47 offen sc1 lds
  s_add_u32 s46, s46, 4096
  s_cmp_ge_u32 s46, 86016
  s_cselect_b32 s46, 0, s46
  s_add_u32 s47, s46, s45
  s_mov_b32 m0, s47
  s_add_u32 s47, s47, s52
  buffer_load_dwordx4 v6, s[28:31], s47 offen sc1 lds
  s_add_u32 s46, s46, 4096
  s_cmp_ge_u32 s46, 86016
  s_cselect_b32 s46, 0, s46
  s_add_u32 s47, s46, s45
  s_mov_b32 m0, s47
  s_add_u32 s47, s47, s52
  buffer_load_dwordx4 v6, s[28:31], s47 offen sc1 lds
  s_add_u32 s46, s46, 4096
  s_cmp_ge_u32 s46, 86016
  s_cselect_b32 s46, 0, s46
  s_add_u32 s47, s46, s45
  s_mov_b32 m0, s47
  s_add_u32 s47, s47, s52
  buffer_load_dwordx4 v6, s[28:31], s47 offen sc1 lds
  s_add_u32 s46, s46, 4096
  s_cmp_ge_u32 s46, 86016
  s_cselect_b32 s46, 0, s46
  s_add_u32 s47, s46, s45
  s_mov_b32 m0, s47
  s_add_u32 s47, s47, s52
  buffer_load_dwordx4 v6, s[28:31], s47 offen sc1 lds
  s_add_u32 s46, s46, 4096
  s_cmp_ge_u32 s46, 86016
  s_cselect_b32 s46, 0, s46
  s_add_u32 s47, s46, s45
  s_mov_b32 m0, s47
  s_add_u32 s47, s47, s52
  buffer_load_dwordx4 v6, s[28:31], s47 offen sc1 lds
  s_add_u32 s46, s46, 4096
  s_cmp_ge_u32 s46, 86016
  s_cselect_b32 s46, 0, s46
  s_add_u32 s47, s46, s45
  s_mov_b32 m0, s47
  s_add_u32 s47, s47, s52
  buffer_load_dwordx4 v6, s[28:31], s47 offen sc1 lds
  s_add_u32 s46, s46, 4096
  s_cmp_ge_u32 s46, 86016
  s_cselect_b32 s46, 0, s46
  s_add_u32 s47, s46, s45
  s_mov_b32 m0, s47
  s_add_u32 s47, s47, s52
  buffer_load_dwordx4 v6, s[28:31], s47 offen sc1 lds
  v_mov_b32 v13, 2147483632
  s_cmp_lt_u32 s58, 56
  s_cbranch_scc1 L_nj1d_15
  s_cmp_ge_u32 s58, 168
  s_cbranch_scc1 L_nj1d_15
  v_lshlrev_b32 v128, 16, v128
  v_mul_f32 v136, 0xbfb8aa3b, v128
  v_lshlrev_b32 v129, 16, v129
  v_mul_f32 v137, 0xbfb8aa3b, v129
  v_lshlrev_b32 v130, 16, v130
  v_mul_f32 v138, 0xbfb8aa3b, v130
  v_lshlrev_b32 v131, 16, v131
  v_mul_f32 v139, 0xbfb8aa3b, v131
  v_exp_f32 v136, v136
  v_exp_f32 v137, v137
  v_exp_f32 v138, v138
  v_exp_f32 v139, v139
  v_add_f32 v136, 1.0, v136
  v_add_f32 v137, 1.0, v137
  v_add_f32 v138, 1.0, v138
  v_add_f32 v139, 1.0, v139
  v_rcp_f32 v136, v136
  v_rcp_f32 v137, v137
  v_rcp_f32 v138, v138
  v_rcp_f32 v139, v139
  s_nop 0
  v_mul_f32 v128, v128, v136
  v_mul_f32 v129, v129, v137
  v_mul_f32 v130, v130, v138
  v_mul_f32 v131, v131, v139
  v_cvt_pk_bf16_f32 v128, v128, v128
  v_lshlrev_b32 v128, 16, v128
  v_cvt_pk_bf16_f32 v129, v129, v129
  v_lshlrev_b32 v129, 16, v129
  v_cvt_pk_bf16_f32 v130, v130, v130
  v_lshlrev_b32 v130, 16, v130
  v_cvt_pk_bf16_f32 v131, v131, v131
  v_lshlrev_b32 v131, 16, v131
  v_lshlrev_b32 v160, 16, v96
  v_and_b32 v161, 0xffff0000, v96
  v_mul_f32 v144, v160, v128
  v_mul_f32 v145, v161, v128
  v_lshlrev_b32 v160, 16, v97
  v_and_b32 v161, 0xffff0000, v97
  v_mul_f32 v146, v160, v128
  v_mul_f32 v147, v161, v128
  v_lshlrev_b32 v160, 16, v98
  v_and_b32 v161, 0xffff0000, v98
  v_mul_f32 v152, v160, v128
  v_mul_f32 v153, v161, v128
  v_lshlrev_b32 v160, 16, v99
  v_and_b32 v161, 0xffff0000, v99
  v_mul_f32 v154, v160, v128
  v_mul_f32 v155, v161, v128
  v_lshlrev_b32 v160, 16, v104
  v_and_b32 v161, 0xffff0000, v104
  v_fmac_f32 v144, v160, v129
  v_fmac_f32 v145, v161, v129
  v_lshlrev_b32 v160, 16, v105
  v_and_b32 v161, 0xffff0000, v105
  v_fmac_f32 v146, v160, v129
  v_fmac_f32 v147, v161, v129
  v_lshlrev_b32 v160, 16, v106
  v_and_b32 v161, 0xffff0000, v106
  v_fmac_f32 v152, v160, v129
  v_fmac_f32 v153, v161, v129
  v_lshlrev_b32 v160, 16, v107
  v_and_b32 v161, 0xffff0000, v107
  v_fmac_f32 v154, v160, v129
  v_fmac_f32 v155, v161, v129
  v_lshlrev_b32 v160, 16, v112
  v_and_b32 v161, 0xffff0000, v112
  v_fmac_f32 v144, v160, v130
  v_fmac_f32 v145, v161, v130
  v_lshlrev_b32 v160, 16, v113
  v_and_b32 v161, 0xffff0000, v113
  v_fmac_f32 v146, v160, v130
  v_fmac_f32 v147, v161, v130
  v_lshlrev_b32 v160, 16, v114
  v_and_b32 v161, 0xffff0000, v114
  v_fmac_f32 v152, v160, v130
  v_fmac_f32 v153, v161, v130
  v_lshlrev_b32 v160, 16, v115
  v_and_b32 v161, 0xffff0000, v115
  v_fmac_f32 v154, v160, v130
  v_fmac_f32 v155, v161, v130
  v_lshlrev_b32 v160, 16, v120
  v_and_b32 v161, 0xffff0000, v120
  v_fmac_f32 v144, v160, v131
  v_fmac_f32 v145, v161, v131
  v_lshlrev_b32 v160, 16, v121
  v_and_b32 v161, 0xffff0000, v121
  v_fmac_f32 v146, v160, v131
  v_fmac_f32 v147, v161, v131
  v_lshlrev_b32 v160, 16, v122
  v_and_b32 v161, 0xffff0000, v122
  v_fmac_f32 v152, v160, v131
  v_fmac_f32 v153, v161, v131
  v_lshlrev_b32 v160, 16, v123
  v_and_b32 v161, 0xffff0000, v123
  v_fmac_f32 v154, v160, v131
  v_fmac_f32 v155, v161, v131
  s_nop 1
  v_add_f32_dpp v144, v144, v144 row_ror:8 row_mask:0xf bank_mask:0xf
  v_add_f32_dpp v145, v145, v145 row_ror:8 row_mask:0xf bank_mask:0xf
  v_add_f32_dpp v146, v146, v146 row_ror:8 row_mask:0xf bank_mask:0xf
  v_add_f32_dpp v147, v147, v147 row_ror:8 row_mask:0xf bank_mask:0xf
  v_add_f32_dpp v152, v152, v152 row_ror:8 row_mask:0xf bank_mask:0xf
  v_add_f32_dpp v153, v153, v153 row_ror:8 row_mask:0xf bank_mask:0xf
  v_add_f32_dpp v154, v154, v154 row_ror:8 row_mask:0xf bank_mask:0xf
  v_add_f32_dpp v155, v155, v155 row_ror:8 row_mask:0xf bank_mask:0xf
  v_mov_b32 v168, v144
  v_mov_b32 v169, v145
  v_mov_b32 v170, v146
  v_mov_b32 v171, v147
  v_mov_b32 v176, v152
  v_mov_b32 v177, v153
  v_mov_b32 v178, v154
  v_mov_b32 v179, v155
  s_nop 0
  v_permlane16_swap_b32 v144, v168
  v_permlane16_swap_b32 v145, v169
  v_permlane16_swap_b32 v146, v170
  v_permlane16_swap_b32 v147, v171
  v_permlane16_swap_b32 v152, v176
  v_permlane16_swap_b32 v153, v177
  v_permlane16_swap_b32 v154, v178
  v_permlane16_swap_b32 v155, v179
  s_nop 0
  v_add_f32 v144, v144, v168
  v_add_f32 v145, v145, v169
  v_add_f32 v146, v146, v170
  v_add_f32 v147, v147, v171
  v_add_f32 v152, v152, v176
  v_add_f32 v153, v153, v177
  v_add_f32 v154, v154, v178
  v_add_f32 v155, v155, v179
  v_mov_b32 v168, v144
  v_mov_b32 v169, v145
  v_mov_b32 v170, v146
  v_mov_b32 v171, v147
  v_mov_b32 v176, v152
  v_mov_b32 v177, v153
  v_mov_b32 v178, v154
  v_mov_b32 v179, v155
  s_nop 0
  v_permlane32_swap_b32 v144, v168
  v_permlane32_swap_b32 v145, v169
  v_permlane32_swap_b32 v146, v170
  v_permlane32_swap_b32 v147, v171
  v_permlane32_swap_b32 v152, v176
  v_permlane32_swap_b32 v153, v177
  v_permlane32_swap_b32 v154, v178
  v_permlane32_swap_b32 v155, v179
  s_nop 0
  v_add_f32 v144, v144, v168
  v_add_f32 v145, v145, v169
  v_add_f32 v146, v146, v170
  v_add_f32 v147, v147, v171
  v_add_f32 v152, v152, v176
  v_add_f32 v153, v153, v177
  v_add_f32 v154, v154, v178
  v_add_f32 v155, v155, v179
  v_lshlrev_b32 v7, 8, v2
  v_lshl_add_u32 v7, v1, 5, v7
  v_add_u32 v7, 147456, v7
  v_cmp_gt_u32 vcc, 8, v1
  s_and_saveexec_b64 s[46:47], vcc
  ds_write_b128 v7, v[144:147]
  ds_write_b128 v7, v[152:155] offset:16
  s_mov_b64 exec, s[46:47]
  s_waitcnt lgkmcnt(0)
  s_barrier
  v_and_b32 v7, 63, v0
  v_lshlrev_b32 v7, 2, v7
  v_add_u32 v7, 147456, v7
  ds_read_b32 v136, v7 offset:0
  ds_read_b32 v137, v7 offset:256
  ds_read_b32 v138, v7 offset:512
  ds_read_b32 v139, v7 offset:768
  v_mov_b32 v9, s64
  s_and_b32 s44, s58, 3
  s_mul_i32 s44, s44, 21504
  s_lshr_b32 s45, s58, 2
  s_lshl_b32 s45, s45, 9
  s_add_u32 s44, s44, s45
  s_add_u32 s44, s44, 25427968
  v_lshlrev_b32 v7, 3, v0
  v_cmp_gt_u32 vcc, 64, v0
  s_waitcnt lgkmcnt(0)
  v_add_f32 v136, v136, v137
  v_add_f32 v138, v138, v139
  v_add_f32 v8, v136, v138
  v_cndmask_b32 v7, v13, v7, vcc
  buffer_store_dwordx2 v[8:9], v7, s[28:31], s44 offen sc1
L_nj1d_15:
  s_lshl_b32 s44, s65, 12
  s_add_u32 s48, s44, 917504
  s_waitcnt vmcnt(0)
  s_cmp_lg_u32 s3, 0
  s_cbranch_scc1 L_wait_16
  v_min_u32 v8, 15, v1
  v_lshlrev_b32 v8, 8, v8
  s_mov_b32 s71, 0
L_poll_17:
  buffer_load_dword v9, v8, s[28:31], s48 offen sc1
  s_waitcnt vmcnt(0)
  v_cmp_ne_u32 vcc, s64, v9
  s_add_u32 s71, s71, 1
  s_cmp_gt_u32 s71, 400000
  s_cbranch_scc1 L_wait_16
  s_cbranch_vccnz L_poll_17
L_wait_16:
  s_barrier
  s_lshl_b32 s44, s65, 2
  s_add_u32 s44, s44, s3
  s_mul_i32 s44, s44, 28672
  s_add_u32 s62, s44, 25559040
  buffer_load_dwordx4 v[16:19], v6, s[28:31], s62 offen offset:0 sc1
  buffer_load_dwordx4 v[20:23], v6, s[28:31], s62 offen offset:1024 sc1
  buffer_load_dwordx4 v[24:27], v6, s[28:31], s62 offen offset:2048 sc1
  buffer_load_dwordx4 v[28:31], v6, s[28:31], s62 offen offset:3072 sc1
  s_add_u32 s62, s62, 4096
  buffer_load_dwordx4 v[32:35], v6, s[28:31], s62 offen offset:0 sc1
  buffer_load_dwordx4 v[36:39], v6, s[28:31], s62 offen offset:1024 sc1
  buffer_load_dwordx4 v[40:43], v6, s[28:31], s62 offen offset:2048 sc1
  buffer_load_dwordx4 v[44:47], v6, s[28:31], s62 offen offset:3072 sc1
  v_add_u32 v7, 64512, v6
  ds_read_b128 v[128:131], v6 offset:0
  ds_read_b128 v[132:135], v6 offset:1024
  ds_read_b128 v[136:139], v6 offset:2048
  ds_read_b128 v[140:143], v6 offset:3072
  ds_read_b128 v[144:147], v6 offset:4096
  ds_read_b128 v[148:151], v6 offset:5120
  s_waitcnt lgkmcnt(3)
  s_waitcnt vmcnt(7)
  v_mfma_f32_32x32x16_bf16 v[176:191], v[128:131], v[16:19], 0
  ds_read_b128 v[152:155], v6 offset:6144
  v_mfma_f32_32x32x16_bf16 v[192:207], v[132:135], v[16:19], 0
  ds_read_b128 v[156:159], v6 offset:7168
  v_mfma_f32_32x32x16_bf16 v[208:223], v[16:19], v[136:139], 0
  ds_read_b128 v[160:163], v6 offset:8192
  s_add_u32 s62, s62, 4096
  buffer_load_dwordx4 v[48:51], v6, s[28:31], s62 offen offset:0 sc1
  buffer_load_dwordx4 v[52:55], v6, s[28:31], s62 offen offset:1024 sc1
  s_waitcnt lgkmcnt(3)
  s_waitcnt vmcnt(8)
  v_mfma_f32_32x32x16_bf16 v[176:191], v[140:143], v[20:23], v[176:191]
  ds_read_b128 v[164:167], v6 offset:9216
  v_mfma_f32_32x32x16_bf16 v[192:207], v[144:147], v[20:23], v[192:207]
  ds_read_b128 v[168:171], v6 offset:10240
  v_mfma_f32_32x32x16_bf16 v[208:223], v[20:23], v[148:151], v[208:223]
  ds_read_b128 v[172:175], v6 offset:11264
  buffer_load_dwordx4 v[56:59], v6, s[28:31], s62 offen offset:2048 sc1
  buffer_load_dwordx4 v[60:63], v6, s[28:31], s62 offen offset:3072 sc1
  s_waitcnt lgkmcnt(3)
  s_waitcnt vmcnt(9)
  v_mfma_f32_32x32x16_bf16 v[176:191], v[152:155], v[24:27], v[176:191]
  ds_read_b128 v[128:131], v6 offset:12288
  v_mfma_f32_32x32x16_bf16 v[192:207], v[156:159], v[24:27], v[192:207]
  ds_read_b128 v[132:135], v6 offset:13312
  v_mfma_f32_32x32x16_bf16 v[208:223], v[24:27], v[160:163], v[208:223]
  ds_read_b128 v[136:139], v6 offset:14336
  s_add_u32 s62, s62, 4096
  buffer_load_dwordx4 v[64:67], v6, s[28:31], s62 offen offset:0 sc1
  buffer_load_dwordx4 v[68:71], v6, s[28:31], s62 offen offset:1024 sc1
  s_waitcnt lgkmcnt(3)
  s_waitcnt vmcnt(10)
  v_mfma_f32_32x32x16_bf16 v[176:191], v[164:167], v[28:31], v[176:191]
  ds_read_b128 v[140:143], v6 offset:15360
  v_mfma_f32_32x32x16_bf16 v[192:207], v[168:171], v[28:31], v[192:207]
  ds_read_b128 v[144:147], v6 offset:16384
  v_mfma_f32_32x32x16_bf16 v[208:223], v[28:31], v[172:175], v[208:223]
  ds_read_b128 v[148:151], v6 offset:17408
  buffer_load_dwordx4 v[72:75], v6, s[28:31], s62 offen offset:2048 sc1
  buffer_load_dwordx4 v[76:79], v6, s[28:31], s62 offen offset:3072 sc1
  s_waitcnt lgkmcnt(3)
  s_waitcnt vmcnt(11)
  v_mfma_f32_32x32x16_bf16 v[176:191], v[128:131], v[32:35], v[176:191]
  ds_read_b128 v[152:155], v6 offset:18432
  v_mfma_f32_32x32x16_bf16 v[192:207], v[132:135], v[32:35], v[192:207]
  ds_read_b128 v[156:159], v6 offset:19456
  v_mfma_f32_32x32x16_bf16 v[208:223], v[32:35], v[136:139], v[208:223]
  ds_read_b128 v[160:163], v6 offset:20480
  s_add_u32 s62, s62, 4096
  buffer_load_dwordx4 v[80:83], v6, s[28:31], s62 offen offset:0 sc1
  buffer_load_dwordx4 v[84:87], v6, s[28:31], s62 offen offset:1024 sc1
  s_waitcnt lgkmcnt(3)
  s_waitcnt vmcnt(12)
  v_mfma_f32_32x32x16_bf16 v[176:191], v[140:143], v[36:39], v[176:191]
  ds_read_b128 v[164:167], v6 offset:21504
  v_mfma_f32_32x32x16_bf16 v[192:207], v[144:147], v[36:39], v[192:207]
  ds_read_b128 v[168:171], v6 offset:22528
  v_mfma_f32_32x32x16_bf16 v[208:223], v[36:39], v[148:151], v[208:223]
  ds_read_b128 v[172:175], v6 offset:23552
  buffer_load_dwordx4 v[88:91], v6, s[28:31], s62 offen offset:2048 sc1
  buffer_load_dwordx4 v[92:95], v6, s[28:31], s62 offen offset:3072 sc1
  s_waitcnt lgkmcnt(3)
  s_waitcnt vmcnt(13)
  v_mfma_f32_32x32x16_bf16 v[176:191], v[152:155], v[40:43], v[176:191]
  ds_read_b128 v[128:131], v6 offset:24576
  v_mfma_f32_32x32x16_bf16 v[192:207], v[156:159], v[40:43], v[192:207]
  ds_read_b128 v[132:135], v6 offset:25600
  v_mfma_f32_32x32x16_bf16 v[208:223], v[40:43], v[160:163], v[208:223]
  ds_read_b128 v[136:139], v6 offset:26624
  s_add_u32 s62, s62, 4096
  buffer_load_dwordx4 v[96:99], v6, s[28:31], s62 offen offset:0 sc1
  buffer_load_dwordx4 v[100:103], v6, s[28:31], s62 offen offset:1024 sc1
  s_waitcnt lgkmcnt(3)
  s_waitcnt vmcnt(14)
  v_mfma_f32_32x32x16_bf16 v[176:191], v[164:167], v[44:47], v[176:191]
  ds_read_b128 v[140:143], v6 offset:27648
  v_mfma_f32_32x32x16_bf16 v[192:207], v[168:171], v[44:47], v[192:207]
  ds_read_b128 v[144:147], v6 offset:28672
  v_mfma_f32_32x32x16_bf16 v[208:223], v[44:47], v[172:175], v[208:223]
  ds_read_b128 v[148:151], v6 offset:29696
  buffer_load_dwordx4 v[104:107], v6, s[28:31], s62 offen offset:2048 sc1
  buffer_load_dwordx4 v[108:111], v6, s[28:31], s62 offen offset:3072 sc1
  s_waitcnt lgkmcnt(3)
  s_waitcnt vmcnt(15)
  v_mfma_f32_32x32x16_bf16 v[176:191], v[128:131], v[48:51], v[176:191]
  ds_read_b128 v[152:155], v6 offset:30720
  v_mfma_f32_32x32x16_bf16 v[192:207], v[132:135], v[48:51], v[192:207]
  ds_read_b128 v[156:159], v6 offset:31744
  v_mfma_f32_32x32x16_bf16 v[208:223], v[48:51], v[136:139], v[208:223]
  ds_read_b128 v[160:163], v6 offset:32768
  s_add_u32 s62, s62, 4096
  buffer_load_dwordx4 v[112:115], v6, s[28:31], s62 offen offset:0 sc1
  buffer_load_dwordx4 v[116:119], v6, s[28:31], s62 offen offset:1024 sc1
  s_waitcnt lgkmcnt(3)
  s_waitcnt vmcnt(16)
  v_mfma_f32_32x32x16_bf16 v[176:191], v[140:143], v[52:55], v[176:191]
  ds_read_b128 v[164:167], v6 offset:33792
  v_mfma_f32_32x32x16_bf16 v[192:207], v[144:147], v[52:55], v[192:207]
  ds_read_b128 v[168:171], v6 offset:34816
  v_mfma_f32_32x32x16_bf16 v[208:223], v[52:55], v[148:151], v[208:223]
  ds_read_b128 v[172:175], v6 offset:35840
  buffer_load_dwordx4 v[120:123], v6, s[28:31], s62 offen offset:2048 sc1
  buffer_load_dwordx4 v[124:127], v6, s[28:31], s62 offen offset:3072 sc1
  s_waitcnt lgkmcnt(3)
  s_waitcnt vmcnt(17)
  v_mfma_f32_32x32x16_bf16 v[176:191], v[152:155], v[56:59], v[176:191]
  ds_read_b128 v[128:131], v6 offset:36864
  v_mfma_f32_32x32x16_bf16 v[192:207], v[156:159], v[56:59], v[192:207]
  ds_read_b128 v[132:135], v6 offset:37888
  v_mfma_f32_32x32x16_bf16 v[208:223], v[56:59], v[160:163], v[208:223]
  ds_read_b128 v[136:139], v6 offset:38912
  s_waitcnt lgkmcnt(3)
  s_waitcnt vmcnt(16)
  v_mfma_f32_32x32x16_bf16 v[176:191], v[164:167], v[60:63], v[176:191]
  ds_read_b128 v[140:143], v6 offset:39936
  v_mfma_f32_32x32x16_bf16 v[192:207], v[168:171], v[60:63], v[192:207]
  ds_read_b128 v[144:147], v6 offset:40960
  v_mfma_f32_32x32x16_bf16 v[208:223], v[60:63], v[172:175], v[208:223]
  ds_read_b128 v[148:151], v6 offset:41984
  s_waitcnt lgkmcnt(3)
  s_waitcnt vmcnt(15)
  v_mfma_f32_32x32x16_bf16 v[176:191], v[128:131], v[64:67], v[176:191]
  ds_read_b128 v[152:155], v6 offset:43008
  v_mfma_f32_32x32x16_bf16 v[192:207], v[132:135], v[64:67], v[192:207]
  ds_read_b128 v[156:159], v6 offset:44032
  v_mfma_f32_32x32x16_bf16 v[208:223], v[64:67], v[136:139], v[208:223]
  ds_read_b128 v[160:163], v6 offset:45056
  v_mov_b32 v8, -1
  v_mov_b32 v9, -1
  v_mov_b32 v10, -1
  v_mov_b32 v11, -1
  s_lshl_b32 s44, s65, 2
  s_add_u32 s44, s44, s3
  s_lshl_b32 s44, s44, 5
  s_lshl_b32 s45, s66, 1
  s_add_u32 s44, s44, s45
  s_lshl_b32 s44, s44, 10
  s_add_u32 s44, s44, 14024704
  buffer_store_dwordx4 v[8:11], v6, s[28:31], s44 offen sc1
  buffer_store_dwordx4 v[8:11], v6, s[28:31], s44 offen offset:1024 sc1
  s_waitcnt lgkmcnt(3)
  s_waitcnt vmcnt(16)
  v_mfma_f32_32x32x16_bf16 v[176:191], v[140:143], v[68:71], v[176:191]
  ds_read_b128 v[164:167], v6 offset:46080
  v_mfma_f32_32x32x16_bf16 v[192:207], v[144:147], v[68:71], v[192:207]
  ds_read_b128 v[168:171], v6 offset:47104
  v_mfma_f32_32x32x16_bf16 v[208:223], v[68:71], v[148:151], v[208:223]
  ds_read_b128 v[172:175], v6 offset:48128
  s_waitcnt lgkmcnt(3)
  s_waitcnt vmcnt(15)
  v_mfma_f32_32x32x16_bf16 v[176:191], v[152:155], v[72:75], v[176:191]
  ds_read_b128 v[128:131], v6 offset:49152
  v_mfma_f32_32x32x16_bf16 v[192:207], v[156:159], v[72:75], v[192:207]
  ds_read_b128 v[132:135], v6 offset:50176
  v_mfma_f32_32x32x16_bf16 v[208:223], v[72:75], v[160:163], v[208:223]
  ds_read_b128 v[136:139], v6 offset:51200
  s_cmp_ge_u32 s2, 224
  s_cbranch_scc1 L_nopo_18
  s_mul_i32 s44, s76, 28
  s_lshl_b32 s45, s75, 1
  s_add_u32 s44, s44, s45
  s_lshl_b32 s44, s44, 10
  s_add_u32 s44, s44, 16121856
  buffer_store_dwordx4 v[8:11], v6, s[28:31], s44 offen sc1
  buffer_store_dwordx4 v[8:11], v6, s[28:31], s44 offen offset:1024 sc1
  s_mul_i32 s44, s76, 14
  s_add_u32 s44, s44, s75
  s_lshl_b32 s44, s44, 8
  s_add_u32 s44, s44, 65536
  v_lshlrev_b32 v12, 2, v1
  buffer_store_dword v8, v12, s[28:31], s44 offen sc1
L_nopo_18:
  s_waitcnt lgkmcnt(3)
  s_waitcnt vmcnt(14)
  v_mfma_f32_32x32x16_bf16 v[176:191], v[164:167], v[76:79], v[176:191]
  ds_read_b128 v[140:143], v6 offset:52224
  v_mfma_f32_32x32x16_bf16 v[192:207], v[168:171], v[76:79], v[192:207]
  ds_read_b128 v[144:147], v6 offset:53248
  v_mfma_f32_32x32x16_bf16 v[208:223], v[76:79], v[172:175], v[208:223]
  ds_read_b128 v[148:151], v6 offset:54272
  s_waitcnt lgkmcnt(3)
  s_waitcnt vmcnt(13)
  v_mfma_f32_32x32x16_bf16 v[176:191], v[128:131], v[80:83], v[176:191]
  ds_read_b128 v[152:155], v6 offset:55296
  v_mfma_f32_32x32x16_bf16 v[192:207], v[132:135], v[80:83], v[192:207]
  ds_read_b128 v[156:159], v6 offset:56320
  v_mfma_f32_32x32x16_bf16 v[208:223], v[80:83], v[136:139], v[208:223]
  ds_read_b128 v[160:163], v6 offset:57344
  s_waitcnt lgkmcnt(3)
  s_waitcnt vmcnt(12)
  v_mfma_f32_32x32x16_bf16 v[176:191], v[140:143], v[84:87], v[176:191]
  ds_read_b128 v[164:167], v6 offset:58368
  v_mfma_f32_32x32x16_bf16 v[192:207], v[144:147], v[84:87], v[192:207]
  ds_read_b128 v[168:171], v6 offset:59392
  v_mfma_f32_32x32x16_bf16 v[208:223], v[84:87], v[148:151], v[208:223]
  ds_read_b128 v[172:175], v6 offset:60416
  s_waitcnt lgkmcnt(3)
  s_waitcnt vmcnt(11)
  v_mfma_f32_32x32x16_bf16 v[176:191], v[152:155], v[88:91], v[176:191]
  ds_read_b128 v[128:131], v6 offset:61440
  v_mfma_f32_32x32x16_bf16 v[192:207], v[156:159], v[88:91], v[192:207]
  ds_read_b128 v[132:135], v6 offset:62464
  v_mfma_f32_32x32x16_bf16 v[208:223], v[88:91], v[160:163], v[208:223]
  ds_read_b128 v[136:139], v6 offset:63488
  s_mul_i32 s53, s100, 112
  s_lshl_b32 s44, s3, 6
  v_or_b32 v233, s44, v1
  v_min_u32 v233, 223, v233
  v_cmp_gt_u32 vcc, 112, v233
  v_add_u32 v232, 1792, v233
  v_add_u32 v233, 1232, v233
  v_cndmask_b32 v232, v233, v232, vcc
  v_add_u32 v232, s53, v232
  v_lshlrev_b32 v232, 3, v232
  buffer_load_dwordx2 v[224:225], v232, s[28:31], s18 offen sc1
  buffer_load_dwordx2 v[226:227], v232, s[28:31], s19 offen sc1
  buffer_load_dwordx2 v[228:229], v232, s[28:31], s20 offen sc1
  buffer_load_dwordx2 v[230:231], v232, s[28:31], s21 offen sc1
  s_waitcnt lgkmcnt(3)
  s_waitcnt vmcnt(14)
  v_mfma_f32_32x32x16_bf16 v[176:191], v[164:167], v[92:95], v[176:191]
  ds_read_b128 v[140:143], v6 offset:64512
  v_mfma_f32_32x32x16_bf16 v[192:207], v[168:171], v[92:95], v[192:207]
  ds_read_b128 v[144:147], v7 offset:1024
  v_mfma_f32_32x32x16_bf16 v[208:223], v[92:95], v[172:175], v[208:223]
  ds_read_b128 v[148:151], v7 offset:2048
  s_waitcnt lgkmcnt(3)
  s_waitcnt vmcnt(13)
  v_mfma_f32_32x32x16_bf16 v[176:191], v[128:131], v[96:99], v[176:191]
  ds_read_b128 v[152:155], v7 offset:3072
  v_mfma_f32_32x32x16_bf16 v[192:207], v[132:135], v[96:99], v[192:207]
  ds_read_b128 v[156:159], v7 offset:4096
  v_mfma_f32_32x32x16_bf16 v[208:223], v[96:99], v[136:139], v[208:223]
  ds_read_b128 v[160:163], v7 offset:5120
  s_waitcnt lgkmcnt(3)
  s_waitcnt vmcnt(12)
  v_mfma_f32_32x32x16_bf16 v[176:191], v[140:143], v[100:103], v[176:191]
  ds_read_b128 v[164:167], v7 offset:6144
  v_mfma_f32_32x32x16_bf16 v[192:207], v[144:147], v[100:103], v[192:207]
  ds_read_b128 v[168:171], v7 offset:7168
  v_mfma_f32_32x32x16_bf16 v[208:223], v[100:103], v[148:151], v[208:223]
  ds_read_b128 v[172:175], v7 offset:8192
  s_waitcnt lgkmcnt(3)
  s_waitcnt vmcnt(11)
  v_mfma_f32_32x32x16_bf16 v[176:191], v[152:155], v[104:107], v[176:191]
  ds_read_b128 v[128:131], v7 offset:9216
  v_mfma_f32_32x32x16_bf16 v[192:207], v[156:159], v[104:107], v[192:207]
  ds_read_b128 v[132:135], v7 offset:10240
  v_mfma_f32_32x32x16_bf16 v[208:223], v[104:107], v[160:163], v[208:223]
  ds_read_b128 v[136:139], v7 offset:11264
  s_waitcnt lgkmcnt(3)
  s_waitcnt vmcnt(10)
  v_mfma_f32_32x32x16_bf16 v[176:191], v[164:167], v[108:111], v[176:191]
  ds_read_b128 v[140:143], v7 offset:12288
  v_mfma_f32_32x32x16_bf16 v[192:207], v[168:171], v[108:111], v[192:207]
  ds_read_b128 v[144:147], v7 offset:13312
  v_mfma_f32_32x32x16_bf16 v[208:223], v[108:111], v[172:175], v[208:223]
  ds_read_b128 v[148:151], v7 offset:14336
  s_waitcnt lgkmcnt(3)
  s_waitcnt vmcnt(9)
  v_mfma_f32_32x32x16_bf16 v[176:191], v[128:131], v[112:115], v[176:191]
  ds_read_b128 v[152:155], v7 offset:15360
  v_mfma_f32_32x32x16_bf16 v[192:207], v[132:135], v[112:115], v[192:207]
  ds_read_b128 v[156:159], v7 offset:16384
  v_mfma_f32_32x32x16_bf16 v[208:223], v[112:115], v[136:139], v[208:223]
  ds_read_b128 v[160:163], v7 offset:17408
  s_waitcnt lgkmcnt(3)
  s_waitcnt vmcnt(8)
  v_mfma_f32_32x32x16_bf16 v[176:191], v[140:143], v[116:119], v[176:191]
  ds_read_b128 v[164:167], v7 offset:18432
  v_mfma_f32_32x32x16_bf16 v[192:207], v[144:147], v[116:119], v[192:207]
  ds_read_b128 v[168:171], v7 offset:19456
  v_mfma_f32_32x32x16_bf16 v[208:223], v[116:119], v[148:151], v[208:223]
  ds_read_b128 v[172:175], v7 offset:20480
  s_waitcnt lgkmcnt(3)
  s_waitcnt vmcnt(7)
  v_mfma_f32_32x32x16_bf16 v[176:191], v[152:155], v[120:123], v[176:191]
  v_mfma_f32_32x32x16_bf16 v[192:207], v[156:159], v[120:123], v[192:207]
  v_mfma_f32_32x32x16_bf16 v[208:223], v[120:123], v[160:163], v[208:223]
  s_waitcnt lgkmcnt(0)
  s_waitcnt vmcnt(6)
  v_mfma_f32_32x32x16_bf16 v[176:191], v[164:167], v[124:127], v[176:191]
  v_mfma_f32_32x32x16_bf16 v[192:207], v[168:171], v[124:127], v[192:207]
  v_mfma_f32_32x32x16_bf16 v[208:223], v[124:127], v[172:175], v[208:223]
  s_nop 11
  v_cvt_pk_bf16_f32 v80, v192, v193
  v_cvt_pk_bf16_f32 v88, v208, v209
  v_cvt_pk_bf16_f32 v81, v194, v195
  v_cvt_pk_bf16_f32 v89, v210, v211
  v_cvt_pk_bf16_f32 v82, v196, v197
  v_cvt_pk_bf16_f32 v90, v212, v213
  v_cvt_pk_bf16_f32 v83, v198, v199
  v_cvt_pk_bf16_f32 v91, v214, v215
  v_cvt_pk_bf16_f32 v84, v200, v201
  v_cvt_pk_bf16_f32 v92, v216, v217
  v_cvt_pk_bf16_f32 v85, v202, v203
  v_cvt_pk_bf16_f32 v93, v218, v219
  v_cvt_pk_bf16_f32 v86, v204, v205
  v_cvt_pk_bf16_f32 v94, v220, v221
  v_cvt_pk_bf16_f32 v87, v206, v207
  v_cvt_pk_bf16_f32 v95, v222, v223
  v_cmp_eq_u32 vcc, 28, v3
  v_mov_b32 v8, 0x3f803f80
  s_nop 0
  v_cndmask_b32 v88, v88, v8, vcc
  v_cndmask_b32 v89, v89, v8, vcc
  v_cndmask_b32 v90, v90, v8, vcc
  v_cndmask_b32 v91, v91, v8, vcc
  v_cndmask_b32 v92, v92, v8, vcc
  v_cndmask_b32 v93, v93, v8, vcc
  v_cndmask_b32 v94, v94, v8, vcc
  v_cndmask_b32 v95, v95, v8, vcc
  s_lshl_b32 s44, s66, 6
  s_lshl_b32 s45, s65, 2
  s_add_u32 s44, s44, s45
  s_add_u32 s44, s44, s3
  s_lshl_b32 s45, s44, 12
  s_add_u32 s45, s45, 7733248
  buffer_store_dwordx4 v[80:83], v6, s[28:31], s45 offen offset:0 sc1
  buffer_store_dwordx4 v[84:87], v6, s[28:31], s45 offen offset:1024 sc1
  buffer_store_dwordx4 v[88:91], v6, s[28:31], s45 offen offset:2048 sc1
  buffer_store_dwordx4 v[92:95], v6, s[28:31], s45 offen offset:3072 sc1
  v_mul_f32 v16, 0x3e8b97f6, v176
  v_mul_f32 v17, 0x3e8b97f6, v177
  v_mul_f32 v18, 0x3e8b97f6, v178
  v_mul_f32 v19, 0x3e8b97f6, v179
  v_mul_f32 v20, 0x3e8b97f6, v180
  v_mul_f32 v21, 0x3e8b97f6, v181
  v_mul_f32 v22, 0x3e8b97f6, v182
  v_mul_f32 v23, 0x3e8b97f6, v183
  v_mul_f32 v24, 0x3e8b97f6, v184
  v_mul_f32 v25, 0x3e8b97f6, v185
  v_mul_f32 v26, 0x3e8b97f6, v186
  v_mul_f32 v27, 0x3e8b97f6, v187
  v_mul_f32 v28, 0x3e8b97f6, v188
  v_mul_f32 v29, 0x3e8b97f6, v189
  v_mul_f32 v30, 0x3e8b97f6, v190
  v_mul_f32 v31, 0x3e8b97f6, v191
  v_cvt_pk_bf16_f32 v96, v16, v17
  v_cvt_pk_bf16_f32 v97, v18, v19
  v_cvt_pk_bf16_f32 v98, v20, v21
  v_cvt_pk_bf16_f32 v99, v22, v23
  v_cvt_pk_bf16_f32 v100, v24, v25
  v_cvt_pk_bf16_f32 v101, v26, v27
  v_cvt_pk_bf16_f32 v102, v28, v29
  v_cvt_pk_bf16_f32 v103, v30, v31
  s_lshl_b32 s44, s3, 11
  s_add_u32 s44, s44, 90112
  v_add_u32 v7, s44, v6
  ds_write_b128 v7, v[96:99]
  ds_write_b128 v7, v[100:103] offset:1024
  s_waitcnt vmcnt(4)
  s_mov_b32 s71, 0
L_jgp_20:
  v_cmp_ne_u32 vcc, s64, v225
  v_cmp_ne_u32 s[56:57], s64, v227
  s_or_b64 vcc, vcc, s[56:57]
  v_cmp_ne_u32 s[56:57], s64, v229
  s_or_b64 vcc, vcc, s[56:57]
  v_cmp_ne_u32 s[56:57], s64, v231
  s_or_b64 vcc, vcc, s[56:57]
  s_cbranch_vccz L_jgok_19
  s_add_u32 s71, s71, 1
  s_cmp_gt_u32 s71, 400000
  s_cbranch_scc1 L_jgok_19
  buffer_load_dwordx2 v[224:225], v232, s[28:31], s18 offen sc1
  buffer_load_dwordx2 v[226:227], v232, s[28:31], s19 offen sc1
  buffer_load_dwordx2 v[228:229], v232, s[28:31], s20 offen sc1
  buffer_load_dwordx2 v[230:231], v232, s[28:31], s21 offen sc1
  s_waitcnt vmcnt(0)
  s_branch L_jgp_20
L_jgok_19:
  v_add_f32 v224, v224, v226
  v_add_f32 v228, v228, v230
  v_add_f32 v224, v224, v228
  v_cvt_pk_bf16_f32 v224, v224, v224
  v_lshlrev_b32 v224, 16, v224
  v_add_f32 v225, 1.0, v224
  v_cvt_pk_bf16_f32 v225, v225, v225
  v_lshlrev_b32 v225, 16, v225
  v_min_u32 v226, 223, v0
  v_cmp_gt_u32 vcc, 112, v226
  v_lshlrev_b32 v226, 2, v226
  v_add_u32 v226, 156672, v226
  v_cndmask_b32 v224, v224, v225, vcc
  ds_write_b32 v226, v224
  s_waitcnt lgkmcnt(0)
  s_barrier
  v_accvgpr_read_b32 v32, a100
  v_accvgpr_read_b32 v33, a101
  v_accvgpr_read_b32 v34, a102
  v_accvgpr_read_b32 v35, a103
  v_accvgpr_read_b32 v36, a104
  v_accvgpr_read_b32 v37, a105
  v_accvgpr_read_b32 v38, a106
  v_accvgpr_read_b32 v39, a107
  v_accvgpr_read_b32 v40, a108
  v_accvgpr_read_b32 v41, a109
  v_accvgpr_read_b32 v42, a110
  v_accvgpr_read_b32 v43, a111
  v_accvgpr_read_b32 v44, a112
  v_accvgpr_read_b32 v45, a113
  v_accvgpr_read_b32 v46, a114
  v_accvgpr_read_b32 v47, a115
  v_accvgpr_read_b32 v48, a116
  v_accvgpr_read_b32 v49, a117
  v_accvgpr_read_b32 v50, a118
  v_accvgpr_read_b32 v51, a119
  v_accvgpr_read_b32 v52, a120
  v_accvgpr_read_b32 v53, a121
  v_accvgpr_read_b32 v54, a122
  v_accvgpr_read_b32 v55, a123
  v_accvgpr_read_b32 v56, a124
  v_accvgpr_read_b32 v57, a125
  v_accvgpr_read_b32 v58, a126
  v_accvgpr_read_b32 v59, a127
  v_accvgpr_read_b32 v60, a128
  v_accvgpr_read_b32 v61, a129
  v_accvgpr_read_b32 v62, a130
  v_accvgpr_read_b32 v63, a131
  s_cmp_ge_u32 s3, 2
  s_cbranch_scc1 L_j4pre_21
  v_lshrrev_b32 v8, 3, v0
  v_min_u32 v8, 13, v8
  v_lshrrev_b32 v5, 1, v8
  v_and_b32 v9, 1, v8
  v_lshlrev_b32 v13, 4, v5
  v_lshl_add_u32 v13, v9, 2, v13
  v_lshlrev_b32 v13, 2, v13
  v_add_u32 v13, 156672, v13
  ds_read_b128 v[192:195], v13
  ds_read_b128 v[196:199], v13 offset:32
  ds_read_b128 v[200:203], v13 offset:448
  ds_read_b128 v[204:207], v13 offset:480
  s_mov_b32 s55, 0xffff0000
  v_lshlrev_b32 v128, 16, v32
  v_and_b32 v129, s55, v32
  v_lshlrev_b32 v130, 16, v33
  v_and_b32 v131, s55, v33
  v_lshlrev_b32 v132, 16, v34
  v_and_b32 v133, s55, v34
  v_lshlrev_b32 v134, 16, v35
  v_and_b32 v135, s55, v35
  v_lshlrev_b32 v136, 16, v36
  v_and_b32 v137, s55, v36
  v_lshlrev_b32 v138, 16, v37
  v_and_b32 v139, s55, v37
  v_lshlrev_b32 v140, 16, v38
  v_and_b32 v141, s55, v38
  v_lshlrev_b32 v142, 16, v39
  v_and_b32 v143, s55, v39
  v_lshlrev_b32 v144, 16, v40
  v_and_b32 v145, s55, v40
  v_lshlrev_b32 v146, 16, v41
  v_and_b32 v147, s55, v41
  v_lshlrev_b32 v148, 16, v42
  v_and_b32 v149, s55, v42
  v_lshlrev_b32 v150, 16, v43
  v_and_b32 v151, s55, v43
  v_lshlrev_b32 v152, 16, v44
  v_and_b32 v153, s55, v44
  v_lshlrev_b32 v154, 16, v45
  v_and_b32 v155, s55, v45
  v_lshlrev_b32 v156, 16, v46
  v_and_b32 v157, s55, v46
  v_lshlrev_b32 v158, 16, v47
  v_and_b32 v159, s55, v47
  v_lshlrev_b32 v160, 16, v48
  v_and_b32 v161, s55, v48
  v_lshlrev_b32 v162, 16, v49
  v_and_b32 v163, s55, v49
  v_lshlrev_b32 v164, 16, v50
  v_and_b32 v165, s55, v50
  v_lshlrev_b32 v166, 16, v51
  v_and_b32 v167, s55, v51
  v_lshlrev_b32 v168, 16, v52
  v_and_b32 v169, s55, v52
  v_lshlrev_b32 v170, 16, v53
  v_and_b32 v171, s55, v53
  v_lshlrev_b32 v172, 16, v54
  v_and_b32 v173, s55, v54
  v_lshlrev_b32 v174, 16, v55
  v_and_b32 v175, s55, v55
  v_lshlrev_b32 v176, 16, v56
  v_and_b32 v177, s55, v56
  v_lshlrev_b32 v178, 16, v57
  v_and_b32 v179, s55, v57
  v_lshlrev_b32 v180, 16, v58
  v_and_b32 v181, s55, v58
  v_lshlrev_b32 v182, 16, v59
  v_and_b32 v183, s55, v59
  v_lshlrev_b32 v184, 16, v60
  v_and_b32 v185, s55, v60
  v_lshlrev_b32 v186, 16, v61
  v_and_b32 v187, s55, v61
  v_lshlrev_b32 v188, 16, v62
  v_and_b32 v189, s55, v62
  v_lshlrev_b32 v190, 16, v63
  v_and_b32 v191, s55, v63
  s_waitcnt lgkmcnt(0)
  v_mov_b32 v16, v192
  v_mov_b32 v208, v200
  v_mov_b32 v18, v193
  v_mov_b32 v210, v201
  v_mov_b32 v20, v194
  v_mov_b32 v212, v202
  v_mov_b32 v22, v195
  v_mov_b32 v214, v203
  v_mov_b32 v24, v196
  v_mov_b32 v216, v204
  v_mov_b32 v26, v197
  v_mov_b32 v218, v205
  v_mov_b32 v28, v198
  v_mov_b32 v220, v206
  v_mov_b32 v30, v199
  v_mov_b32 v222, v207
L_j4pre_21:
  s_waitcnt lgkmcnt(0)
  s_lshl_b32 s44, s66, 4
  s_add_u32 s44, s44, s65
  s_lshl_b32 s44, s44, 8
  s_add_u32 s48, s44, 393216
  s_waitcnt vmcnt(0)
  s_barrier
  s_cmp_lg_u32 s3, 0
  s_cbranch_scc1 L_pub_22
  v_mov_b32 v14, s64
  v_mov_b32 v15, 0
  s_mov_b64 exec, 1
  buffer_store_dword v14, v15, s[28:31], s48 offen sc1
  s_mov_b64 exec, -1
L_pub_22:
  s_cmp_lg_u32 s3, 3
  s_cbranch_scc1 L_noj3_25
  s_cmp_ge_u32 s2, 252
  s_cbranch_scc1 L_noj3_25
  s_min_u32 s55, s2, 251
  s_mul_hi_u32 s48, s55, 0x71c71c8
  s_mul_i32 s49, s48, 36
  s_sub_u32 s49, s55, s49
  s_cmp_lt_u32 s49, 28
  s_cselect_b32 s32, s16, s8
  s_cselect_b32 s33, s17, s9
  s_mov_b32 s34, 401408
  s_cselect_b32 s34, 1605632, s34
  s_cselect_b32 s54, 1, 0
  s_and_b32 s33, s33, 0xffff
  s_mov_b32 s35, 0x20000
  s_sub_u32 s44, s49, 28
  s_cmp_eq_u32 s54, 1
  s_cselect_b32 s44, s49, s44
  s_lshl_b32 s44, s44, 3
  v_lshrrev_b32 v10, 3, v1
  v_add_u32 v10, s44, v10
  s_lshl_b32 s48, s48, 3
  v_and_b32 v9, 7, v1
  v_add_u32 v9, s48, v9
  v_lshrrev_b32 v11, 1, v10
  v_and_b32 v12, 1, v10
  v_lshlrev_b32 v15, 4, v11
  v_lshl_add_u32 v15, v12, 2, v15
  v_lshrrev_b32 v8, 1, v11
  v_mul_u32_u24 v8, 28, v8
  v_and_b32 v14, 1, v11
  v_lshlrev_b32 v14, 4, v14
  v_lshl_add_u32 v14, v12, 2, v14
  v_add_u32 v8, v8, v14
  s_cmp_eq_u32 s54, 1
  s_cselect_b64 s[52:53], -1, 0
  v_cndmask_b32 v15, v8, v15, s[52:53]
  v_mov_b32 v8, -64
  v_cndmask_b32 v14, v14, v8, s[52:53]
  v_lshrrev_b32 v8, 2, v9
  s_cmp_eq_u32 s54, 1
  s_cselect_b32 s48, 112, 32
  s_mov_b32 s49, 2424832
  s_cselect_b32 s49, 2883584, s49
  v_mul_u32_u24 v15, s48, v8
  v_add_u32 v15, v15, v11
  v_lshlrev_b32 v15, 10, v15
  v_add_u32 v15, s49, v15
  v_and_b32 v8, 3, v9
  v_lshlrev_b32 v8, 7, v8
  v_lshl_add_u32 v8, v12, 9, v8
  v_add_u32 v15, v15, v8
  s_mov_b32 s46, 0x05040100
  s_mov_b32 s47, 0x07060302
  v_perm_b32 v96, v36, v32, s46
  v_perm_b32 v97, v44, v40, s46
  v_perm_b32 v98, v52, v48, s46
  v_perm_b32 v99, v60, v56, s46
  v_perm_b32 v100, v36, v32, s47
  v_perm_b32 v101, v44, v40, s47
  v_perm_b32 v102, v52, v48, s47
  v_perm_b32 v103, v60, v56, s47
  v_perm_b32 v104, v37, v33, s46
  v_perm_b32 v105, v45, v41, s46
  v_perm_b32 v106, v53, v49, s46
  v_perm_b32 v107, v61, v57, s46
  v_perm_b32 v108, v37, v33, s47
  v_perm_b32 v109, v45, v41, s47
  v_perm_b32 v110, v53, v49, s47
  v_perm_b32 v111, v61, v57, s47
  v_perm_b32 v112, v38, v34, s46
  v_perm_b32 v113, v46, v42, s46
  v_perm_b32 v114, v54, v50, s46
  v_perm_b32 v115, v62, v58, s46
  v_perm_b32 v116, v38, v34, s47
  v_perm_b32 v117, v46, v42, s47
  v_perm_b32 v118, v54, v50, s47
  v_perm_b32 v119, v62, v58, s47
  v_perm_b32 v120, v39, v35, s46
  v_perm_b32 v121, v47, v43, s46
  v_perm_b32 v122, v55, v51, s46
  v_perm_b32 v123, v63, v59, s46
  v_perm_b32 v124, v39, v35, s47
  v_perm_b32 v125, v47, v43, s47
  v_perm_b32 v126, v55, v51, s47
  v_perm_b32 v127, v63, v59, s47
  v_and_b32 v12, 7, v1
  v_lshlrev_b32 v13, 7, v1
  v_add_u32 v13, 133120, v13
  v_xor_b32 v14, 0, v12
  v_lshl_add_u32 v14, v14, 4, v13
  ds_write_b128 v14, v[96:99]
  v_xor_b32 v14, 1, v12
  v_lshl_add_u32 v14, v14, 4, v13
  ds_write_b128 v14, v[100:103]
  v_xor_b32 v14, 2, v12
  v_lshl_add_u32 v14, v14, 4, v13
  ds_write_b128 v14, v[104:107]
  v_xor_b32 v14, 3, v12
  v_lshl_add_u32 v14, v14, 4, v13
  ds_write_b128 v14, v[108:111]
  v_xor_b32 v14, 4, v12
  v_lshl_add_u32 v14, v14, 4, v13
  ds_write_b128 v14, v[112:115]
  v_xor_b32 v14, 5, v12
  v_lshl_add_u32 v14, v14, 4, v13
  ds_write_b128 v14, v[116:119]
  v_xor_b32 v14, 6, v12
  v_lshl_add_u32 v14, v14, 4, v13
  ds_write_b128 v14, v[120:123]
  v_xor_b32 v14, 7, v12
  v_lshl_add_u32 v14, v14, 4, v13
  ds_write_b128 v14, v[124:127]
  v_lshlrev_b32 v14, 2, v1
  v_add_u32 v14, 141312, v14
  ds_write_b32 v14, v15
  v_lshrrev_b32 v12, 3, v1
  v_and_b32 v13, 7, v1
  v_xor_b32 v14, v13, v12
  v_lshlrev_b32 v14, 4, v14
  v_lshl_add_u32 v14, v12, 7, v14
  v_add_u32 v14, 133120, v14
  v_lshlrev_b32 v12, 2, v12
  v_add_u32 v12, 141312, v12
  s_waitcnt lgkmcnt(0)
  ds_read_b128 v[96:99], v14 offset:0
  ds_read_b32 v32, v12 offset:0
  ds_read_b128 v[100:103], v14 offset:1024
  ds_read_b32 v33, v12 offset:32
  ds_read_b128 v[104:107], v14 offset:2048
  ds_read_b32 v34, v12 offset:64
  ds_read_b128 v[108:111], v14 offset:3072
  ds_read_b32 v35, v12 offset:96
  ds_read_b128 v[112:115], v14 offset:4096
  ds_read_b32 v36, v12 offset:128
  ds_read_b128 v[116:119], v14 offset:5120
  ds_read_b32 v37, v12 offset:160
  ds_read_b128 v[120:123], v14 offset:6144
  ds_read_b32 v38, v12 offset:192
  ds_read_b128 v[124:127], v14 offset:7168
  ds_read_b32 v39, v12 offset:224
  s_waitcnt lgkmcnt(0)
  v_lshl_add_u32 v32, v13, 4, v32
  v_lshl_add_u32 v33, v13, 4, v33
  v_lshl_add_u32 v34, v13, 4, v34
  v_lshl_add_u32 v35, v13, 4, v35
  v_lshl_add_u32 v36, v13, 4, v36
  v_lshl_add_u32 v37, v13, 4, v37
  v_lshl_add_u32 v38, v13, 4, v38
  v_lshl_add_u32 v39, v13, 4, v39
  buffer_store_dwordx4 v[96:99], v32, s[28:31], 0 offen sc1
  buffer_store_dwordx4 v[100:103], v33, s[28:31], 0 offen sc1
  buffer_store_dwordx4 v[104:107], v34, s[28:31], 0 offen sc1
  buffer_store_dwordx4 v[108:111], v35, s[28:31], 0 offen sc1
  buffer_store_dwordx4 v[112:115], v36, s[28:31], 0 offen sc1
  buffer_store_dwordx4 v[116:119], v37, s[28:31], 0 offen sc1
  buffer_store_dwordx4 v[120:123], v38, s[28:31], 0 offen sc1
  buffer_store_dwordx4 v[124:127], v39, s[28:31], 0 offen sc1
  s_nop 1
L_noj3_25:
  s_cmp_ge_u32 s2, 224
  s_cbranch_scc1 L_skipj4_23
  v_mov_b32 v11, 2147483632
  v_mov_b32 v15, 112
  v_cmp_gt_u32 s[50:51], v15, v0
  s_cmp_ge_u32 s3, 2
  s_cbranch_scc1 L_j4nomath_24
  v_mov_b32 v64, 0
  v_mov_b32 v65, 0
  v_mov_b32 v66, 0
  v_mov_b32 v67, 0
  v_mov_b32 v68, 0
  v_mov_b32 v69, 0
  v_mov_b32 v70, 0
  v_mov_b32 v71, 0
  v_mov_b32 v72, 0
  v_mov_b32 v73, 0
  v_mov_b32 v74, 0
  v_mov_b32 v75, 0
  v_mov_b32 v76, 0
  v_mov_b32 v77, 0
  v_mov_b32 v78, 0
  v_mov_b32 v79, 0
  v_pk_fma_f32 v[72:73], v[128:129], v[208:209], v[72:73] op_sel_hi:[1,0,1]
  v_pk_mul_f32 v[128:129], v[128:129], v[16:17] op_sel_hi:[1,0]
  v_pk_fma_f32 v[74:75], v[130:131], v[208:209], v[74:75] op_sel_hi:[1,0,1]
  v_pk_mul_f32 v[130:131], v[130:131], v[16:17] op_sel_hi:[1,0]
  v_pk_fma_f32 v[76:77], v[132:133], v[208:209], v[76:77] op_sel_hi:[1,0,1]
  v_pk_mul_f32 v[132:133], v[132:133], v[16:17] op_sel_hi:[1,0]
  v_pk_fma_f32 v[78:79], v[134:135], v[208:209], v[78:79] op_sel_hi:[1,0,1]
  v_pk_mul_f32 v[134:135], v[134:135], v[16:17] op_sel_hi:[1,0]
  s_nop 0
  v_pk_add_f32 v[64:65], v[64:65], v[128:129]
  v_pk_add_f32 v[66:67], v[66:67], v[130:131]
  v_pk_add_f32 v[68:69], v[68:69], v[132:133]
  v_pk_add_f32 v[70:71], v[70:71], v[134:135]
  v_pk_fma_f32 v[72:73], v[136:137], v[210:211], v[72:73] op_sel_hi:[1,0,1]
  v_pk_mul_f32 v[136:137], v[136:137], v[18:19] op_sel_hi:[1,0]
  v_pk_fma_f32 v[74:75], v[138:139], v[210:211], v[74:75] op_sel_hi:[1,0,1]
  v_pk_mul_f32 v[138:139], v[138:139], v[18:19] op_sel_hi:[1,0]
  v_pk_fma_f32 v[76:77], v[140:141], v[210:211], v[76:77] op_sel_hi:[1,0,1]
  v_pk_mul_f32 v[140:141], v[140:141], v[18:19] op_sel_hi:[1,0]
  v_pk_fma_f32 v[78:79], v[142:143], v[210:211], v[78:79] op_sel_hi:[1,0,1]
  v_pk_mul_f32 v[142:143], v[142:143], v[18:19] op_sel_hi:[1,0]
  s_nop 0
  v_pk_add_f32 v[64:65], v[64:65], v[136:137]
  v_pk_add_f32 v[66:67], v[66:67], v[138:139]
  v_pk_add_f32 v[68:69], v[68:69], v[140:141]
  v_pk_add_f32 v[70:71], v[70:71], v[142:143]
  v_pk_fma_f32 v[72:73], v[144:145], v[212:213], v[72:73] op_sel_hi:[1,0,1]
  v_pk_mul_f32 v[144:145], v[144:145], v[20:21] op_sel_hi:[1,0]
  v_pk_fma_f32 v[74:75], v[146:147], v[212:213], v[74:75] op_sel_hi:[1,0,1]
  v_pk_mul_f32 v[146:147], v[146:147], v[20:21] op_sel_hi:[1,0]
  v_pk_fma_f32 v[76:77], v[148:149], v[212:213], v[76:77] op_sel_hi:[1,0,1]
  v_pk_mul_f32 v[148:149], v[148:149], v[20:21] op_sel_hi:[1,0]
  v_pk_fma_f32 v[78:79], v[150:151], v[212:213], v[78:79] op_sel_hi:[1,0,1]
  v_pk_mul_f32 v[150:151], v[150:151], v[20:21] op_sel_hi:[1,0]
  s_nop 0
  v_pk_add_f32 v[64:65], v[64:65], v[144:145]
  v_pk_add_f32 v[66:67], v[66:67], v[146:147]
  v_pk_add_f32 v[68:69], v[68:69], v[148:149]
  v_pk_add_f32 v[70:71], v[70:71], v[150:151]
  v_pk_fma_f32 v[72:73], v[152:153], v[214:215], v[72:73] op_sel_hi:[1,0,1]
  v_pk_mul_f32 v[152:153], v[152:153], v[22:23] op_sel_hi:[1,0]
  v_pk_fma_f32 v[74:75], v[154:155], v[214:215], v[74:75] op_sel_hi:[1,0,1]
  v_pk_mul_f32 v[154:155], v[154:155], v[22:23] op_sel_hi:[1,0]
  v_pk_fma_f32 v[76:77], v[156:157], v[214:215], v[76:77] op_sel_hi:[1,0,1]
  v_pk_mul_f32 v[156:157], v[156:157], v[22:23] op_sel_hi:[1,0]
  v_pk_fma_f32 v[78:79], v[158:159], v[214:215], v[78:79] op_sel_hi:[1,0,1]
  v_pk_mul_f32 v[158:159], v[158:159], v[22:23] op_sel_hi:[1,0]
  s_nop 0
  v_pk_add_f32 v[64:65], v[64:65], v[152:153]
  v_pk_add_f32 v[66:67], v[66:67], v[154:155]
  v_pk_add_f32 v[68:69], v[68:69], v[156:157]
  v_pk_add_f32 v[70:71], v[70:71], v[158:159]
  v_pk_fma_f32 v[72:73], v[160:161], v[216:217], v[72:73] op_sel_hi:[1,0,1]
  v_pk_mul_f32 v[160:161], v[160:161], v[24:25] op_sel_hi:[1,0]
  v_pk_fma_f32 v[74:75], v[162:163], v[216:217], v[74:75] op_sel_hi:[1,0,1]
  v_pk_mul_f32 v[162:163], v[162:163], v[24:25] op_sel_hi:[1,0]
  v_pk_fma_f32 v[76:77], v[164:165], v[216:217], v[76:77] op_sel_hi:[1,0,1]
  v_pk_mul_f32 v[164:165], v[164:165], v[24:25] op_sel_hi:[1,0]
  v_pk_fma_f32 v[78:79], v[166:167], v[216:217], v[78:79] op_sel_hi:[1,0,1]
  v_pk_mul_f32 v[166:167], v[166:167], v[24:25] op_sel_hi:[1,0]
  s_nop 0
  v_pk_add_f32 v[64:65], v[64:65], v[160:161]
  v_pk_add_f32 v[66:67], v[66:67], v[162:163]
  v_pk_add_f32 v[68:69], v[68:69], v[164:165]
  v_pk_add_f32 v[70:71], v[70:71], v[166:167]
  v_pk_fma_f32 v[72:73], v[168:169], v[218:219], v[72:73] op_sel_hi:[1,0,1]
  v_pk_mul_f32 v[168:169], v[168:169], v[26:27] op_sel_hi:[1,0]
  v_pk_fma_f32 v[74:75], v[170:171], v[218:219], v[74:75] op_sel_hi:[1,0,1]
  v_pk_mul_f32 v[170:171], v[170:171], v[26:27] op_sel_hi:[1,0]
  v_pk_fma_f32 v[76:77], v[172:173], v[218:219], v[76:77] op_sel_hi:[1,0,1]
  v_pk_mul_f32 v[172:173], v[172:173], v[26:27] op_sel_hi:[1,0]
  v_pk_fma_f32 v[78:79], v[174:175], v[218:219], v[78:79] op_sel_hi:[1,0,1]
  v_pk_mul_f32 v[174:175], v[174:175], v[26:27] op_sel_hi:[1,0]
  s_nop 0
  v_pk_add_f32 v[64:65], v[64:65], v[168:169]
  v_pk_add_f32 v[66:67], v[66:67], v[170:171]
  v_pk_add_f32 v[68:69], v[68:69], v[172:173]
  v_pk_add_f32 v[70:71], v[70:71], v[174:175]
  v_pk_fma_f32 v[72:73], v[176:177], v[220:221], v[72:73] op_sel_hi:[1,0,1]
  v_pk_mul_f32 v[176:177], v[176:177], v[28:29] op_sel_hi:[1,0]
  v_pk_fma_f32 v[74:75], v[178:179], v[220:221], v[74:75] op_sel_hi:[1,0,1]
  v_pk_mul_f32 v[178:179], v[178:179], v[28:29] op_sel_hi:[1,0]
  v_pk_fma_f32 v[76:77], v[180:181], v[220:221], v[76:77] op_sel_hi:[1,0,1]
  v_pk_mul_f32 v[180:181], v[180:181], v[28:29] op_sel_hi:[1,0]
  v_pk_fma_f32 v[78:79], v[182:183], v[220:221], v[78:79] op_sel_hi:[1,0,1]
  v_pk_mul_f32 v[182:183], v[182:183], v[28:29] op_sel_hi:[1,0]
  s_nop 0
  v_pk_add_f32 v[64:65], v[64:65], v[176:177]
  v_pk_add_f32 v[66:67], v[66:67], v[178:179]
  v_pk_add_f32 v[68:69], v[68:69], v[180:181]
  v_pk_add_f32 v[70:71], v[70:71], v[182:183]
  v_pk_fma_f32 v[72:73], v[184:185], v[222:223], v[72:73] op_sel_hi:[1,0,1]
  v_pk_mul_f32 v[184:185], v[184:185], v[30:31] op_sel_hi:[1,0]
  v_pk_fma_f32 v[74:75], v[186:187], v[222:223], v[74:75] op_sel_hi:[1,0,1]
  v_pk_mul_f32 v[186:187], v[186:187], v[30:31] op_sel_hi:[1,0]
  v_pk_fma_f32 v[76:77], v[188:189], v[222:223], v[76:77] op_sel_hi:[1,0,1]
  v_pk_mul_f32 v[188:189], v[188:189], v[30:31] op_sel_hi:[1,0]
  v_pk_fma_f32 v[78:79], v[190:191], v[222:223], v[78:79] op_sel_hi:[1,0,1]
  v_pk_mul_f32 v[190:191], v[190:191], v[30:31] op_sel_hi:[1,0]
  s_nop 0
  v_pk_add_f32 v[64:65], v[64:65], v[184:185]
  v_pk_add_f32 v[66:67], v[66:67], v[186:187]
  v_pk_add_f32 v[68:69], v[68:69], v[188:189]
  v_pk_add_f32 v[70:71], v[70:71], v[190:191]
  v_cvt_pk_bf16_f32 v96, v128, v136
  v_cvt_pk_bf16_f32 v97, v144, v152
  v_cvt_pk_bf16_f32 v98, v160, v168
  v_cvt_pk_bf16_f32 v99, v176, v184
  v_cvt_pk_bf16_f32 v100, v129, v137
  v_cvt_pk_bf16_f32 v101, v145, v153
  v_cvt_pk_bf16_f32 v102, v161, v169
  v_cvt_pk_bf16_f32 v103, v177, v185
  v_cvt_pk_bf16_f32 v104, v130, v138
  v_cvt_pk_bf16_f32 v105, v146, v154
  v_cvt_pk_bf16_f32 v106, v162, v170
  v_cvt_pk_bf16_f32 v107, v178, v186
  v_cvt_pk_bf16_f32 v108, v131, v139
  v_cvt_pk_bf16_f32 v109, v147, v155
  v_cvt_pk_bf16_f32 v110, v163, v171
  v_cvt_pk_bf16_f32 v111, v179, v187
  v_cvt_pk_bf16_f32 v112, v132, v140
  v_cvt_pk_bf16_f32 v113, v148, v156
  v_cvt_pk_bf16_f32 v114, v164, v172
  v_cvt_pk_bf16_f32 v115, v180, v188
  v_cvt_pk_bf16_f32 v116, v133, v141
  v_cvt_pk_bf16_f32 v117, v149, v157
  v_cvt_pk_bf16_f32 v118, v165, v173
  v_cvt_pk_bf16_f32 v119, v181, v189
  v_cvt_pk_bf16_f32 v120, v134, v142
  v_cvt_pk_bf16_f32 v121, v150, v158
  v_cvt_pk_bf16_f32 v122, v166, v174
  v_cvt_pk_bf16_f32 v123, v182, v190
  v_cvt_pk_bf16_f32 v124, v135, v143
  v_cvt_pk_bf16_f32 v125, v151, v159
  v_cvt_pk_bf16_f32 v126, v167, v175
  v_cvt_pk_bf16_f32 v127, v183, v191
  v_and_b32 v12, 7, v0
  v_lshlrev_b32 v13, 7, v0
  v_add_u32 v13, 118784, v13
  s_and_saveexec_b64 s[52:53], s[50:51]
  v_xor_b32 v14, 0, v12
  v_lshl_add_u32 v14, v14, 4, v13
  ds_write_b128 v14, v[96:99]
  v_xor_b32 v14, 1, v12
  v_lshl_add_u32 v14, v14, 4, v13
  ds_write_b128 v14, v[100:103]
  v_xor_b32 v14, 2, v12
  v_lshl_add_u32 v14, v14, 4, v13
  ds_write_b128 v14, v[104:107]
  v_xor_b32 v14, 3, v12
  v_lshl_add_u32 v14, v14, 4, v13
  ds_write_b128 v14, v[108:111]
  v_xor_b32 v14, 4, v12
  v_lshl_add_u32 v14, v14, 4, v13
  ds_write_b128 v14, v[112:115]
  v_xor_b32 v14, 5, v12
  v_lshl_add_u32 v14, v14, 4, v13
  ds_write_b128 v14, v[116:119]
  v_xor_b32 v14, 6, v12
  v_lshl_add_u32 v14, v14, 4, v13
  ds_write_b128 v14, v[120:123]
  v_xor_b32 v14, 7, v12
  v_lshl_add_u32 v14, v14, 4, v13
  ds_write_b128 v14, v[124:127]
  s_mov_b64 exec, s[52:53]
  v_lshlrev_b32 v13, 6, v0
  v_add_u32 v13, 102400, v13
  ds_write_b128 v13, v[64:67] offset:0
  ds_write_b128 v13, v[68:71] offset:16
  ds_write_b128 v13, v[72:75] offset:32
  ds_write_b128 v13, v[76:79] offset:48
L_j4nomath_24:
  s_waitcnt lgkmcnt(0)
  s_barrier
  s_mov_b32 s44, s60
  s_mov_b32 s45, s59
  v_mov_b32 v11, 2147483632
  v_lshrrev_b32 v12, 3, v1
  v_and_b32 v13, 7, v1
  v_xor_b32 v13, v13, v12
  v_lshlrev_b32 v13, 4, v13
  v_lshl_add_u32 v13, v12, 7, v13
  s_lshl_b32 s52, s3, 10
  s_add_u32 s52, s52, 118784
  v_add_u32 v13, s52, v13
  v_lshrrev_b32 v12, 4, v1
  v_mul_u32_u24 v12, 28672, v12
  v_bfe_u32 v14, v1, 3, 1
  v_lshl_add_u32 v12, v14, 7, v12
  v_and_b32 v14, 7, v1
  v_lshl_add_u32 v12, v14, 4, v12
  s_mul_i32 s52, s44, 114688
  s_mul_i32 s56, s100, 7168
  s_add_u32 s52, s52, s56
  s_lshl_b32 s56, s45, 8
  s_add_u32 s52, s52, s56
  s_add_u32 s52, s52, 4521984
  s_lshl_b32 s56, s3, 9
  s_add_u32 s52, s52, s56
  ds_read_b128 v[192:195], v13 offset:0
  ds_read_b128 v[196:199], v13 offset:4096
  ds_read_b128 v[200:203], v13 offset:8192
  ds_read_b128 v[204:207], v13 offset:12288
  v_bfe_u32 v14, v0, 3, 3
  v_lshlrev_b32 v14, 6, v14
  v_bfe_u32 v15, v0, 6, 1
  v_lshl_add_u32 v14, v15, 5, v14
  v_and_b32 v15, 7, v0
  v_lshl_add_u32 v14, v15, 2, v14
  v_add_u32 v14, 102400, v14
  ds_read_b32 v32, v14 offset:0
  ds_read_b32 v33, v14 offset:512
  ds_read_b32 v34, v14 offset:1024
  ds_read_b32 v35, v14 offset:1536
  ds_read_b32 v36, v14 offset:2048
  ds_read_b32 v37, v14 offset:2560
  ds_read_b32 v38, v14 offset:3072
  ds_read_b32 v39, v14 offset:3584
  ds_read_b32 v40, v14 offset:4096
  ds_read_b32 v41, v14 offset:4608
  ds_read_b32 v42, v14 offset:5120
  ds_read_b32 v43, v14 offset:5632
  ds_read_b32 v44, v14 offset:6144
  ds_read_b32 v45, v14 offset:6656
  s_waitcnt lgkmcnt(0)
  buffer_store_dwordx4 v[192:195], v12, s[28:31], s52 offen sc1
  s_add_u32 s52, s52, 2048
  buffer_store_dwordx4 v[196:199], v12, s[28:31], s52 offen sc1
  s_add_u32 s52, s52, 2048
  buffer_store_dwordx4 v[200:203], v12, s[28:31], s52 offen sc1
  s_add_u32 s52, s52, 2048
  s_cmp_ge_u32 s3, 2
  s_cbranch_scc1 L_j4st_26
  buffer_store_dwordx4 v[204:207], v12, s[28:31], s52 offen sc1
  s_add_u32 s52, s52, 2048
L_j4st_26:
  v_add_f32 v32, v32, v33
  v_add_f32 v34, v34, v35
  v_add_f32 v36, v36, v37
  v_add_f32 v38, v38, v39
  v_add_f32 v40, v40, v41
  v_add_f32 v42, v42, v43
  v_add_f32 v44, v44, v45
  v_add_f32 v32, v32, v34
  v_add_f32 v36, v36, v38
  v_add_f32 v40, v40, v42
  v_add_f32 v32, v32, v36
  v_add_f32 v40, v40, v44
  v_add_f32 v46, v32, v40
  s_lshl_b32 s52, s44, 12
  s_lshl_b32 s56, s100, 8
  s_add_u32 s52, s52, s56
  s_lshl_b32 s56, s45, 6
  s_add_u32 s52, s52, s56
  s_add_u32 s52, s52, 25296896
  v_bfe_u32 v15, v0, 4, 2
  v_lshlrev_b32 v15, 10, v15
  v_bfe_u32 v16, v0, 6, 1
  v_lshl_add_u32 v15, v16, 7, v15
  v_and_b32 v16, 15, v0
  v_lshl_add_u32 v15, v16, 2, v15
  v_cmp_gt_u32 vcc, 128, v0
  s_nop 1
  v_cndmask_b32 v15, v11, v15, vcc
  buffer_store_dword v46, v15, s[28:31], s52 offen sc1
L_skipj4_23:
  s_xor_b32 s44, s3, 0
  s_lshl_b32 s44, s44, 11
  s_add_u32 s44, s44, 90112
  v_add_u32 v7, s44, v6
  ds_read_b128 a[224:227], v7
  ds_read_b128 a[228:231], v7 offset:1024
  s_xor_b32 s44, s3, 1
  s_lshl_b32 s44, s44, 11
  s_add_u32 s44, s44, 90112
  v_add_u32 v7, s44, v6
  ds_read_b128 a[232:235], v7
  ds_read_b128 a[236:239], v7 offset:1024
  s_xor_b32 s44, s3, 2
  s_lshl_b32 s44, s44, 11
  s_add_u32 s44, s44, 90112
  v_add_u32 v7, s44, v6
  ds_read_b128 a[240:243], v7
  ds_read_b128 a[244:247], v7 offset:1024
  s_xor_b32 s44, s3, 3
  s_lshl_b32 s44, s44, 11
  s_add_u32 s44, s44, 90112
  v_add_u32 v7, s44, v6
  ds_read_b128 a[248:251], v7
  ds_read_b128 a[252:255], v7 offset:1024
  s_lshl_b32 s44, s66, 12
  s_add_u32 s48, s44, 393216
  s_waitcnt lgkmcnt(0)
  s_cmp_lg_u32 s3, 0
  s_cbranch_scc1 L_wait_28
  v_min_u32 v8, 15, v1
  v_lshlrev_b32 v8, 8, v8
  s_mov_b32 s71, 0
L_poll_29:
  buffer_load_dword v9, v8, s[28:31], s48 offen sc1
  s_waitcnt vmcnt(0)
  v_cmp_ne_u32 vcc, s64, v9
  s_add_u32 s71, s71, 1
  s_cmp_gt_u32 s71, 400000
  s_cbranch_scc1 L_wait_28
  s_cbranch_vccnz L_poll_29
L_wait_28:
  s_barrier
  s_lshl_b32 s44, s66, 6
  s_add_u32 s44, s44, s3
  s_lshl_b32 s44, s44, 12
  s_add_u32 s73, s44, 7733248
  s_add_u32 s63, s65, 1
  s_and_b32 s63, s63, 15
  s_lshl_b32 s63, s63, 14
  s_add_u32 s72, s73, s63
  buffer_load_dwordx4 v[136:139], v6, s[28:31], s72 offen offset:0 sc1
  buffer_load_dwordx4 v[140:143], v6, s[28:31], s72 offen offset:1024 sc1
  buffer_load_dwordx4 v[144:147], v6, s[28:31], s72 offen offset:2048 sc1
  buffer_load_dwordx4 v[148:151], v6, s[28:31], s72 offen offset:3072 sc1
  s_add_u32 s63, s63, 16384
  s_and_b32 s63, s63, 262143
  s_add_u32 s72, s73, s63
  buffer_load_dwordx4 v[152:155], v6, s[28:31], s72 offen offset:0 sc1
  buffer_load_dwordx4 v[156:159], v6, s[28:31], s72 offen offset:1024 sc1
  buffer_load_dwordx4 v[160:163], v6, s[28:31], s72 offen offset:2048 sc1
  buffer_load_dwordx4 v[164:167], v6, s[28:31], s72 offen offset:3072 sc1
  s_add_u32 s63, s63, 16384
  s_and_b32 s63, s63, 262143
  s_add_u32 s72, s73, s63
  v_mov_b32 v120, v80
  v_mov_b32 v121, v81
  v_mov_b32 v122, v82
  v_mov_b32 v123, v83
  v_mov_b32 v124, v84
  v_mov_b32 v125, v85
  v_mov_b32 v126, v86
  v_mov_b32 v127, v87
  v_mov_b32 v128, v88
  v_mov_b32 v129, v89
  v_mov_b32 v130, v90
  v_mov_b32 v131, v91
  v_mov_b32 v132, v92
  v_mov_b32 v133, v93
  v_mov_b32 v134, v94
  v_mov_b32 v135, v95
  s_mul_i32 s44, s68, 36
  v_add_u32 v8, s44, v1
  v_lshlrev_b32 v8, 8, v8
  v_add_u32 v8, 851968, v8
  v_subrev_u32 v9, 36, v1
  v_min_u32 v9, 23, v9
  v_mul_u32_u24 v10, 0x5556, v9
  v_lshrrev_b32 v10, 18, v10
  v_mul_u32_u24 v11, 12, v10
  v_sub_u32 v9, v9, v11
  s_mul_i32 s44, s70, 7
  s_lshr_b32 s44, s44, 2
  v_lshrrev_b32 v11, 2, v9
  v_add_u32 v11, s44, v11
  v_min_u32 v11, 27, v11
  v_mul_u32_u24 v10, 28, v10
  v_add_u32 v10, v10, v11
  v_lshlrev_b32 v10, 2, v10
  v_and_b32 v9, 3, v9
  v_add_u32 v10, v10, v9
  v_lshlrev_b32 v10, 8, v10
  v_add_u32 v10, 720896, v10
  v_cmp_gt_u32 vcc, 36, v1
  s_nop 1
  v_cndmask_b32 v10, v10, v8, vcc
  s_lshr_b32 s44, s67, 1
  v_lshlrev_b32 v12, 4, v1
  v_add_u32 v12, s44, v12
  v_subrev_u32 v13, 16, v1
  v_min_u32 v13, 13, v13
  v_mul_u32_u24 v14, 0x2493, v13
  v_lshrrev_b32 v14, 16, v14
  v_mul_u32_u24 v15, 7, v14
  v_sub_u32 v13, v13, v15
  s_lshl_b32 s44, s69, 1
  v_add_u32 v14, s44, v14
  v_and_b32 v15, 3, v14
  v_mul_u32_u24 v15, 7, v15
  v_add_u32 v13, v13, v15
  v_lshrrev_b32 v14, 2, v14
  v_lshrrev_b32 v15, 1, v14
  v_lshlrev_b32 v15, 2, v15
  v_and_b32 v9, 3, v13
  v_add_u32 v15, v15, v9
  v_and_b32 v14, 1, v14
  v_lshlrev_b32 v14, 3, v14
  v_lshrrev_b32 v13, 2, v13
  v_add_u32 v14, v14, v13
  v_lshl_add_u32 v14, v15, 4, v14
  v_cmp_gt_u32 vcc, 16, v1
  s_nop 1
  v_cndmask_b32 v12, v14, v12, vcc
  v_lshlrev_b32 v12, 8, v12
  v_add_u32 v12, 393216, v12
  v_mov_b32 v16, 0
  v_mov_b32 v17, 0
  v_mov_b32 v18, 0
  v_mov_b32 v19, 0
  v_mov_b32 v20, 0
  v_mov_b32 v21, 0
  v_mov_b32 v22, 0
  v_mov_b32 v23, 0
  v_mov_b32 v24, 0
  v_mov_b32 v25, 0
  v_mov_b32 v26, 0
  v_mov_b32 v27, 0
  v_mov_b32 v28, 0
  v_mov_b32 v29, 0
  v_mov_b32 v30, 0
  v_mov_b32 v31, 0
  v_mov_b32 v32, 0
  v_mov_b32 v33, 0
  v_mov_b32 v34, 0
  v_mov_b32 v35, 0
  v_mov_b32 v36, 0
  v_mov_b32 v37, 0
  v_mov_b32 v38, 0
  v_mov_b32 v39, 0
  v_mov_b32 v40, 0
  v_mov_b32 v41, 0
  v_mov_b32 v42, 0
  v_mov_b32 v43, 0
  v_mov_b32 v44, 0
  v_mov_b32 v45, 0
  v_mov_b32 v46, 0
  v_mov_b32 v47, 0
  v_mov_b32 v48, 0
  v_mov_b32 v49, 0
  v_mov_b32 v50, 0
  v_mov_b32 v51, 0
  v_mov_b32 v52, 0
  v_mov_b32 v53, 0
  v_mov_b32 v54, 0
  v_mov_b32 v55, 0
  v_mov_b32 v56, 0
  v_mov_b32 v57, 0
  v_mov_b32 v58, 0
  v_mov_b32 v59, 0
  v_mov_b32 v60, 0
  v_mov_b32 v61, 0
  v_mov_b32 v62, 0
  v_mov_b32 v63, 0
  v_mov_b32 v64, 0
  v_mov_b32 v65, 0
  v_mov_b32 v66, 0
  v_mov_b32 v67, 0
  v_mov_b32 v68, 0
  v_mov_b32 v69, 0
  v_mov_b32 v70, 0
  v_mov_b32 v71, 0
  v_mov_b32 v72, 0
  v_mov_b32 v73, 0
  v_mov_b32 v74, 0
  v_mov_b32 v75, 0
  v_mov_b32 v76, 0
  v_mov_b32 v77, 0
  v_mov_b32 v78, 0
  v_mov_b32 v79, 0
  v_mov_b32 v116, 0
  v_mov_b32 v117, 0
  v_mov_b32 v118, 0
  v_mov_b32 v119, 0
  v_mov_b32 v180, 0
  v_mov_b32 v181, 0
  v_mov_b32 v182, 0
  v_mov_b32 v183, 0
  s_nop 1
  v_mfma_f32_32x32x16_bf16 v[80:95], v[120:123], a[224:227], 0
  v_mfma_f32_32x32x16_bf16 v[80:95], v[124:127], a[228:231], v[80:95]
  s_nop 11
  v_mfma_f32_32x32x16_bf16 v[96:111], v[120:123], a[232:235], 0
  v_exp_f32 v80, v80
  v_exp_f32 v81, v81
  v_exp_f32 v82, v82
  v_exp_f32 v83, v83
  v_cvt_pk_bf16_f32 v112, v80, v81
  v_cvt_pk_bf16_f32 v113, v82, v83
  v_mfma_f32_32x32x16_bf16 v[64:79], v[180:183], v[116:119], v[64:79]
  buffer_load_dwordx4 v[168:171], v6, s[28:31], s72 offen offset:0 sc1
  v_exp_f32 v84, v84
  v_exp_f32 v85, v85
  v_exp_f32 v86, v86
  v_exp_f32 v87, v87
  v_cvt_pk_bf16_f32 v114, v84, v85
  v_cvt_pk_bf16_f32 v115, v86, v87
  v_mfma_f32_32x32x16_bf16 v[96:111], v[124:127], a[236:239], v[96:111]
  v_exp_f32 v88, v88
  v_exp_f32 v89, v89
  v_exp_f32 v90, v90
  v_exp_f32 v91, v91
  v_cvt_pk_bf16_f32 v116, v88, v89
  v_cvt_pk_bf16_f32 v117, v90, v91
  v_mfma_f32_32x32x16_bf16 v[16:31], v[128:131], v[112:115], v[16:31]
  buffer_load_dwordx4 v[172:175], v6, s[28:31], s72 offen offset:1024 sc1
  v_exp_f32 v92, v92
  v_exp_f32 v93, v93
  v_exp_f32 v94, v94
  v_exp_f32 v95, v95
  v_cvt_pk_bf16_f32 v118, v92, v93
  v_cvt_pk_bf16_f32 v119, v94, v95
  v_mfma_f32_32x32x16_bf16 v[80:95], v[120:123], a[240:243], 0
  v_exp_f32 v96, v96
  v_exp_f32 v97, v97
  v_exp_f32 v98, v98
  v_exp_f32 v99, v99
  v_cvt_pk_bf16_f32 v112, v96, v97
  v_cvt_pk_bf16_f32 v113, v98, v99
  v_mfma_f32_32x32x16_bf16 v[16:31], v[132:135], v[116:119], v[16:31]
  buffer_load_dwordx4 v[176:179], v6, s[28:31], s72 offen offset:2048 sc1
  v_exp_f32 v100, v100
  v_exp_f32 v101, v101
  v_exp_f32 v102, v102
  v_exp_f32 v103, v103
  v_cvt_pk_bf16_f32 v114, v100, v101
  v_cvt_pk_bf16_f32 v115, v102, v103
  v_mfma_f32_32x32x16_bf16 v[80:95], v[124:127], a[244:247], v[80:95]
  v_exp_f32 v104, v104
  v_exp_f32 v105, v105
  v_exp_f32 v106, v106
  v_exp_f32 v107, v107
  v_cvt_pk_bf16_f32 v116, v104, v105
  v_cvt_pk_bf16_f32 v117, v106, v107
  v_mfma_f32_32x32x16_bf16 v[32:47], v[128:131], v[112:115], v[32:47]
  buffer_load_dwordx4 v[180:183], v6, s[28:31], s72 offen offset:3072 sc1
  v_exp_f32 v108, v108
  v_exp_f32 v109, v109
  v_exp_f32 v110, v110
  v_exp_f32 v111, v111
  v_cvt_pk_bf16_f32 v118, v108, v109
  v_cvt_pk_bf16_f32 v119, v110, v111
  v_mfma_f32_32x32x16_bf16 v[96:111], v[120:123], a[248:251], 0
  s_add_u32 s63, s63, 16384
  v_exp_f32 v80, v80
  v_exp_f32 v81, v81
  v_exp_f32 v82, v82
  v_exp_f32 v83, v83
  v_cvt_pk_bf16_f32 v112, v80, v81
  v_cvt_pk_bf16_f32 v113, v82, v83
  v_mfma_f32_32x32x16_bf16 v[32:47], v[132:135], v[116:119], v[32:47]
  v_exp_f32 v84, v84
  v_exp_f32 v85, v85
  v_exp_f32 v86, v86
  v_exp_f32 v87, v87
  v_cvt_pk_bf16_f32 v114, v84, v85
  v_cvt_pk_bf16_f32 v115, v86, v87
  v_mfma_f32_32x32x16_bf16 v[96:111], v[124:127], a[252:255], v[96:111]
  s_and_b32 s63, s63, 262143
  s_add_u32 s72, s73, s63
  v_exp_f32 v88, v88
  v_exp_f32 v89, v89
  v_exp_f32 v90, v90
  v_exp_f32 v91, v91
  v_cvt_pk_bf16_f32 v116, v88, v89
  v_cvt_pk_bf16_f32 v117, v90, v91
  v_mfma_f32_32x32x16_bf16 v[48:63], v[128:131], v[112:115], v[48:63]
  v_exp_f32 v92, v92
  v_exp_f32 v93, v93
  v_exp_f32 v94, v94
  v_exp_f32 v95, v95
  v_cvt_pk_bf16_f32 v118, v92, v93
  v_cvt_pk_bf16_f32 v119, v94, v95
  s_waitcnt vmcnt(12)
  s_barrier
  s_mul_i32 s44, s59, 28
  s_add_u32 s44, s44, s60
  s_lshl_b32 s44, s44, 2
  s_add_u32 s44, s44, s100
  s_cmp_ge_u32 s2, 224
  s_cselect_b32 s44, 255, s44
  s_lshl_b32 s44, s44, 8
  s_add_u32 s48, s44, 720896
  s_cmp_lg_u32 s3, 0
  s_cbranch_scc1 L_pub_30
  v_mov_b32 v14, s64
  v_mov_b32 v15, 0
  s_mov_b64 exec, 1
  buffer_store_dword v14, v15, s[28:31], s48 offen sc1
  s_mov_b64 exec, -1
L_pub_30:
  s_lshl_b32 s44, s2, 8
  s_add_u32 s48, s44, 851968
  s_cmp_lg_u32 s3, 0
  s_cbranch_scc1 L_pub_31
  v_mov_b32 v14, s64
  v_mov_b32 v15, 0
  s_mov_b64 exec, 1
  buffer_store_dword v14, v15, s[28:31], s48 offen sc1
  s_mov_b64 exec, -1
L_pub_31:
  s_waitcnt vmcnt(8)
  v_mfma_f32_32x32x16_bf16 v[80:95], v[136:139], a[224:227], 0
  v_exp_f32 v96, v96
  v_exp_f32 v97, v97
  v_exp_f32 v98, v98
  v_exp_f32 v99, v99
  v_cvt_pk_bf16_f32 v112, v96, v97
  v_cvt_pk_bf16_f32 v113, v98, v99
  v_mfma_f32_32x32x16_bf16 v[48:63], v[132:135], v[116:119], v[48:63]
  v_exp_f32 v100, v100
  v_exp_f32 v101, v101
  v_exp_f32 v102, v102
  v_exp_f32 v103, v103
  v_cvt_pk_bf16_f32 v114, v100, v101
  v_cvt_pk_bf16_f32 v115, v102, v103
  v_mfma_f32_32x32x16_bf16 v[80:95], v[140:143], a[228:231], v[80:95]
  v_exp_f32 v104, v104
  v_exp_f32 v105, v105
  v_exp_f32 v106, v106
  v_exp_f32 v107, v107
  v_cvt_pk_bf16_f32 v116, v104, v105
  v_cvt_pk_bf16_f32 v117, v106, v107
  v_mfma_f32_32x32x16_bf16 v[64:79], v[128:131], v[112:115], v[64:79]
  v_exp_f32 v108, v108
  v_exp_f32 v109, v109
  v_exp_f32 v110, v110
  v_exp_f32 v111, v111
  v_cvt_pk_bf16_f32 v118, v108, v109
  v_cvt_pk_bf16_f32 v119, v110, v111
  v_mfma_f32_32x32x16_bf16 v[96:111], v[136:139], a[232:235], 0
  v_exp_f32 v80, v80
  v_exp_f32 v81, v81
  v_exp_f32 v82, v82
  v_exp_f32 v83, v83
  v_cvt_pk_bf16_f32 v112, v80, v81
  v_cvt_pk_bf16_f32 v113, v82, v83
  v_mfma_f32_32x32x16_bf16 v[64:79], v[132:135], v[116:119], v[64:79]
  buffer_load_dwordx4 v[120:123], v6, s[28:31], s72 offen offset:0 sc1
  v_exp_f32 v84, v84
  v_exp_f32 v85, v85
  v_exp_f32 v86, v86
  v_exp_f32 v87, v87
  v_cvt_pk_bf16_f32 v114, v84, v85
  v_cvt_pk_bf16_f32 v115, v86, v87
  v_mfma_f32_32x32x16_bf16 v[96:111], v[140:143], a[236:239], v[96:111]
  v_exp_f32 v88, v88
  v_exp_f32 v89, v89
  v_exp_f32 v90, v90
  v_exp_f32 v91, v91
  v_cvt_pk_bf16_f32 v116, v88, v89
  v_cvt_pk_bf16_f32 v117, v90, v91
  v_mfma_f32_32x32x16_bf16 v[16:31], v[144:147], v[112:115], v[16:31]
  buffer_load_dwordx4 v[124:127], v6, s[28:31], s72 offen offset:1024 sc1
  v_exp_f32 v92, v92
  v_exp_f32 v93, v93
  v_exp_f32 v94, v94
  v_exp_f32 v95, v95
  v_cvt_pk_bf16_f32 v118, v92, v93
  v_cvt_pk_bf16_f32 v119, v94, v95
  v_mfma_f32_32x32x16_bf16 v[80:95], v[136:139], a[240:243], 0
  v_exp_f32 v96, v96
  v_exp_f32 v97, v97
  v_exp_f32 v98, v98
  v_exp_f32 v99, v99
  v_cvt_pk_bf16_f32 v112, v96, v97
  v_cvt_pk_bf16_f32 v113, v98, v99
  v_mfma_f32_32x32x16_bf16 v[16:31], v[148:151], v[116:119], v[16:31]
  buffer_load_dwordx4 v[128:131], v6, s[28:31], s72 offen offset:2048 sc1
  v_exp_f32 v100, v100
  v_exp_f32 v101, v101
  v_exp_f32 v102, v102
  v_exp_f32 v103, v103
  v_cvt_pk_bf16_f32 v114, v100, v101
  v_cvt_pk_bf16_f32 v115, v102, v103
  v_mfma_f32_32x32x16_bf16 v[80:95], v[140:143], a[244:247], v[80:95]
  v_exp_f32 v104, v104
  v_exp_f32 v105, v105
  v_exp_f32 v106, v106
  v_exp_f32 v107, v107
  v_cvt_pk_bf16_f32 v116, v104, v105
  v_cvt_pk_bf16_f32 v117, v106, v107
  v_mfma_f32_32x32x16_bf16 v[32:47], v[144:147], v[112:115], v[32:47]
  buffer_load_dwordx4 v[132:135], v6, s[28:31], s72 offen offset:3072 sc1
  v_exp_f32 v108, v108
  v_exp_f32 v109, v109
  v_exp_f32 v110, v110
  v_exp_f32 v111, v111
  v_cvt_pk_bf16_f32 v118, v108, v109
  v_cvt_pk_bf16_f32 v119, v110, v111
  v_mfma_f32_32x32x16_bf16 v[96:111], v[136:139], a[248:251], 0
  s_add_u32 s63, s63, 16384
  v_exp_f32 v80, v80
  v_exp_f32 v81, v81
  v_exp_f32 v82, v82
  v_exp_f32 v83, v83
  v_cvt_pk_bf16_f32 v112, v80, v81
  v_cvt_pk_bf16_f32 v113, v82, v83
  v_mfma_f32_32x32x16_bf16 v[32:47], v[148:151], v[116:119], v[32:47]
  v_exp_f32 v84, v84
  v_exp_f32 v85, v85
  v_exp_f32 v86, v86
  v_exp_f32 v87, v87
  v_cvt_pk_bf16_f32 v114, v84, v85
  v_cvt_pk_bf16_f32 v115, v86, v87
  v_mfma_f32_32x32x16_bf16 v[96:111], v[140:143], a[252:255], v[96:111]
  s_and_b32 s63, s63, 262143
  s_add_u32 s72, s73, s63
  v_exp_f32 v88, v88
  v_exp_f32 v89, v89
  v_exp_f32 v90, v90
  v_exp_f32 v91, v91
  v_cvt_pk_bf16_f32 v116, v88, v89
  v_cvt_pk_bf16_f32 v117, v90, v91
  v_mfma_f32_32x32x16_bf16 v[48:63], v[144:147], v[112:115], v[48:63]
  v_exp_f32 v92, v92
  v_exp_f32 v93, v93
  v_exp_f32 v94, v94
  v_exp_f32 v95, v95
  v_cvt_pk_bf16_f32 v118, v92, v93
  v_cvt_pk_bf16_f32 v119, v94, v95
  s_waitcnt vmcnt(8)
  v_mfma_f32_32x32x16_bf16 v[80:95], v[152:155], a[224:227], 0
  v_exp_f32 v96, v96
  v_exp_f32 v97, v97
  v_exp_f32 v98, v98
  v_exp_f32 v99, v99
  v_cvt_pk_bf16_f32 v112, v96, v97
  v_cvt_pk_bf16_f32 v113, v98, v99
  v_mfma_f32_32x32x16_bf16 v[48:63], v[148:151], v[116:119], v[48:63]
  v_exp_f32 v100, v100
  v_exp_f32 v101, v101
  v_exp_f32 v102, v102
  v_exp_f32 v103, v103
  v_cvt_pk_bf16_f32 v114, v100, v101
  v_cvt_pk_bf16_f32 v115, v102, v103
  v_mfma_f32_32x32x16_bf16 v[80:95], v[156:159], a[228:231], v[80:95]
  v_exp_f32 v104, v104
  v_exp_f32 v105, v105
  v_exp_f32 v106, v106
  v_exp_f32 v107, v107
  v_cvt_pk_bf16_f32 v116, v104, v105
  v_cvt_pk_bf16_f32 v117, v106, v107
  v_mfma_f32_32x32x16_bf16 v[64:79], v[144:147], v[112:115], v[64:79]
  v_exp_f32 v108, v108
  v_exp_f32 v109, v109
  v_exp_f32 v110, v110
  v_exp_f32 v111, v111
  v_cvt_pk_bf16_f32 v118, v108, v109
  v_cvt_pk_bf16_f32 v119, v110, v111
  v_mfma_f32_32x32x16_bf16 v[96:111], v[152:155], a[232:235], 0
  v_exp_f32 v80, v80
  v_exp_f32 v81, v81
  v_exp_f32 v82, v82
  v_exp_f32 v83, v83
  v_cvt_pk_bf16_f32 v112, v80, v81
  v_cvt_pk_bf16_f32 v113, v82, v83
  v_mfma_f32_32x32x16_bf16 v[64:79], v[148:151], v[116:119], v[64:79]
  buffer_load_dwordx4 v[136:139], v6, s[28:31], s72 offen offset:0 sc1
  v_exp_f32 v84, v84
  v_exp_f32 v85, v85
  v_exp_f32 v86, v86
  v_exp_f32 v87, v87
  v_cvt_pk_bf16_f32 v114, v84, v85
  v_cvt_pk_bf16_f32 v115, v86, v87
  v_mfma_f32_32x32x16_bf16 v[96:111], v[156:159], a[236:239], v[96:111]
  v_exp_f32 v88, v88
  v_exp_f32 v89, v89
  v_exp_f32 v90, v90
  v_exp_f32 v91, v91
  v_cvt_pk_bf16_f32 v116, v88, v89
  v_cvt_pk_bf16_f32 v117, v90, v91
  v_mfma_f32_32x32x16_bf16 v[16:31], v[160:163], v[112:115], v[16:31]
  buffer_load_dwordx4 v[140:143], v6, s[28:31], s72 offen offset:1024 sc1
  v_exp_f32 v92, v92
  v_exp_f32 v93, v93
  v_exp_f32 v94, v94
  v_exp_f32 v95, v95
  v_cvt_pk_bf16_f32 v118, v92, v93
  v_cvt_pk_bf16_f32 v119, v94, v95
  v_mfma_f32_32x32x16_bf16 v[80:95], v[152:155], a[240:243], 0
  v_exp_f32 v96, v96
  v_exp_f32 v97, v97
  v_exp_f32 v98, v98
  v_exp_f32 v99, v99
  v_cvt_pk_bf16_f32 v112, v96, v97
  v_cvt_pk_bf16_f32 v113, v98, v99
  v_mfma_f32_32x32x16_bf16 v[16:31], v[164:167], v[116:119], v[16:31]
  buffer_load_dwordx4 v[144:147], v6, s[28:31], s72 offen offset:2048 sc1
  v_exp_f32 v100, v100
  v_exp_f32 v101, v101
  v_exp_f32 v102, v102
  v_exp_f32 v103, v103
  v_cvt_pk_bf16_f32 v114, v100, v101
  v_cvt_pk_bf16_f32 v115, v102, v103
  v_mfma_f32_32x32x16_bf16 v[80:95], v[156:159], a[244:247], v[80:95]
  v_exp_f32 v104, v104
  v_exp_f32 v105, v105
  v_exp_f32 v106, v106
  v_exp_f32 v107, v107
  v_cvt_pk_bf16_f32 v116, v104, v105
  v_cvt_pk_bf16_f32 v117, v106, v107
  v_mfma_f32_32x32x16_bf16 v[32:47], v[160:163], v[112:115], v[32:47]
  buffer_load_dwordx4 v[148:151], v6, s[28:31], s72 offen offset:3072 sc1
  v_exp_f32 v108, v108
  v_exp_f32 v109, v109
  v_exp_f32 v110, v110
  v_exp_f32 v111, v111
  v_cvt_pk_bf16_f32 v118, v108, v109
  v_cvt_pk_bf16_f32 v119, v110, v111
  v_mfma_f32_32x32x16_bf16 v[96:111], v[152:155], a[248:251], 0
  s_add_u32 s63, s63, 16384
  v_exp_f32 v80, v80
  v_exp_f32 v81, v81
  v_exp_f32 v82, v82
  v_exp_f32 v83, v83
  v_cvt_pk_bf16_f32 v112, v80, v81
  v_cvt_pk_bf16_f32 v113, v82, v83
  v_mfma_f32_32x32x16_bf16 v[32:47], v[164:167], v[116:119], v[32:47]
  v_exp_f32 v84, v84
  v_exp_f32 v85, v85
  v_exp_f32 v86, v86
  v_exp_f32 v87, v87
  v_cvt_pk_bf16_f32 v114, v84, v85
  v_cvt_pk_bf16_f32 v115, v86, v87
  v_mfma_f32_32x32x16_bf16 v[96:111], v[156:159], a[252:255], v[96:111]
  s_and_b32 s63, s63, 262143
  s_add_u32 s72, s73, s63
  v_exp_f32 v88, v88
  v_exp_f32 v89, v89
  v_exp_f32 v90, v90
  v_exp_f32 v91, v91
  v_cvt_pk_bf16_f32 v116, v88, v89
  v_cvt_pk_bf16_f32 v117, v90, v91
  v_mfma_f32_32x32x16_bf16 v[48:63], v[160:163], v[112:115], v[48:63]
  v_exp_f32 v92, v92
  v_exp_f32 v93, v93
  v_exp_f32 v94, v94
  v_exp_f32 v95, v95
  v_cvt_pk_bf16_f32 v118, v92, v93
  v_cvt_pk_bf16_f32 v119, v94, v95
  s_waitcnt vmcnt(8)
  v_mfma_f32_32x32x16_bf16 v[80:95], v[168:171], a[224:227], 0
  v_exp_f32 v96, v96
  v_exp_f32 v97, v97
  v_exp_f32 v98, v98
  v_exp_f32 v99, v99
  v_cvt_pk_bf16_f32 v112, v96, v97
  v_cvt_pk_bf16_f32 v113, v98, v99
  v_mfma_f32_32x32x16_bf16 v[48:63], v[164:167], v[116:119], v[48:63]
  v_exp_f32 v100, v100
  v_exp_f32 v101, v101
  v_exp_f32 v102, v102
  v_exp_f32 v103, v103
  v_cvt_pk_bf16_f32 v114, v100, v101
  v_cvt_pk_bf16_f32 v115, v102, v103
  v_mfma_f32_32x32x16_bf16 v[80:95], v[172:175], a[228:231], v[80:95]
  v_exp_f32 v104, v104
  v_exp_f32 v105, v105
  v_exp_f32 v106, v106
  v_exp_f32 v107, v107
  v_cvt_pk_bf16_f32 v116, v104, v105
  v_cvt_pk_bf16_f32 v117, v106, v107
  v_mfma_f32_32x32x16_bf16 v[64:79], v[160:163], v[112:115], v[64:79]
  v_exp_f32 v108, v108
  v_exp_f32 v109, v109
  v_exp_f32 v110, v110
  v_exp_f32 v111, v111
  v_cvt_pk_bf16_f32 v118, v108, v109
  v_cvt_pk_bf16_f32 v119, v110, v111
  v_mfma_f32_32x32x16_bf16 v[96:111], v[168:171], a[232:235], 0
  v_exp_f32 v80, v80
  v_exp_f32 v81, v81
  v_exp_f32 v82, v82
  v_exp_f32 v83, v83
  v_cvt_pk_bf16_f32 v112, v80, v81
  v_cvt_pk_bf16_f32 v113, v82, v83
  v_mfma_f32_32x32x16_bf16 v[64:79], v[164:167], v[116:119], v[64:79]
  buffer_load_dwordx4 v[152:155], v6, s[28:31], s72 offen offset:0 sc1
  v_exp_f32 v84, v84
  v_exp_f32 v85, v85
  v_exp_f32 v86, v86
  v_exp_f32 v87, v87
  v_cvt_pk_bf16_f32 v114, v84, v85
  v_cvt_pk_bf16_f32 v115, v86, v87
  v_mfma_f32_32x32x16_bf16 v[96:111], v[172:175], a[236:239], v[96:111]
  v_exp_f32 v88, v88
  v_exp_f32 v89, v89
  v_exp_f32 v90, v90
  v_exp_f32 v91, v91
  v_cvt_pk_bf16_f32 v116, v88, v89
  v_cvt_pk_bf16_f32 v117, v90, v91
  v_mfma_f32_32x32x16_bf16 v[16:31], v[176:179], v[112:115], v[16:31]
  buffer_load_dwordx4 v[156:159], v6, s[28:31], s72 offen offset:1024 sc1
  v_exp_f32 v92, v92
  v_exp_f32 v93, v93
  v_exp_f32 v94, v94
  v_exp_f32 v95, v95
  v_cvt_pk_bf16_f32 v118, v92, v93
  v_cvt_pk_bf16_f32 v119, v94, v95
  v_mfma_f32_32x32x16_bf16 v[80:95], v[168:171], a[240:243], 0
  v_exp_f32 v96, v96
  v_exp_f32 v97, v97
  v_exp_f32 v98, v98
  v_exp_f32 v99, v99
  v_cvt_pk_bf16_f32 v112, v96, v97
  v_cvt_pk_bf16_f32 v113, v98, v99
  v_mfma_f32_32x32x16_bf16 v[16:31], v[180:183], v[116:119], v[16:31]
  buffer_load_dwordx4 v[160:163], v6, s[28:31], s72 offen offset:2048 sc1
  v_exp_f32 v100, v100
  v_exp_f32 v101, v101
  v_exp_f32 v102, v102
  v_exp_f32 v103, v103
  v_cvt_pk_bf16_f32 v114, v100, v101
  v_cvt_pk_bf16_f32 v115, v102, v103
  v_mfma_f32_32x32x16_bf16 v[80:95], v[172:175], a[244:247], v[80:95]
  v_exp_f32 v104, v104
  v_exp_f32 v105, v105
  v_exp_f32 v106, v106
  v_exp_f32 v107, v107
  v_cvt_pk_bf16_f32 v116, v104, v105
  v_cvt_pk_bf16_f32 v117, v106, v107
  v_mfma_f32_32x32x16_bf16 v[32:47], v[176:179], v[112:115], v[32:47]
  buffer_load_dwordx4 v[164:167], v6, s[28:31], s72 offen offset:3072 sc1
  v_exp_f32 v108, v108
  v_exp_f32 v109, v109
  v_exp_f32 v110, v110
  v_exp_f32 v111, v111
  v_cvt_pk_bf16_f32 v118, v108, v109
  v_cvt_pk_bf16_f32 v119, v110, v111
  v_mfma_f32_32x32x16_bf16 v[96:111], v[168:171], a[248:251], 0
  s_add_u32 s63, s63, 16384
  v_exp_f32 v80, v80
  v_exp_f32 v81, v81
  v_exp_f32 v82, v82
  v_exp_f32 v83, v83
  v_cvt_pk_bf16_f32 v112, v80, v81
  v_cvt_pk_bf16_f32 v113, v82, v83
  v_mfma_f32_32x32x16_bf16 v[32:47], v[180:183], v[116:119], v[32:47]
  buffer_load_dword v11, v10, s[28:31], 0 offen sc1
  v_exp_f32 v84, v84
  v_exp_f32 v85, v85
  v_exp_f32 v86, v86
  v_exp_f32 v87, v87
  v_cvt_pk_bf16_f32 v114, v84, v85
  v_cvt_pk_bf16_f32 v115, v86, v87
  v_mfma_f32_32x32x16_bf16 v[96:111], v[172:175], a[252:255], v[96:111]
  s_and_b32 s63, s63, 262143
  s_add_u32 s72, s73, s63
  v_exp_f32 v88, v88
  v_exp_f32 v89, v89
  v_exp_f32 v90, v90
  v_exp_f32 v91, v91
  v_cvt_pk_bf16_f32 v116, v88, v89
  v_cvt_pk_bf16_f32 v117, v90, v91
  v_mfma_f32_32x32x16_bf16 v[48:63], v[176:179], v[112:115], v[48:63]
  buffer_load_dword v13, v12, s[28:31], 0 offen sc1
  v_exp_f32 v92, v92
  v_exp_f32 v93, v93
  v_exp_f32 v94, v94
  v_exp_f32 v95, v95
  v_cvt_pk_bf16_f32 v118, v92, v93
  v_cvt_pk_bf16_f32 v119, v94, v95
  s_waitcnt vmcnt(10)
  v_mfma_f32_32x32x16_bf16 v[80:95], v[120:123], a[224:227], 0
  v_exp_f32 v96, v96
  v_exp_f32 v97, v97
  v_exp_f32 v98, v98
  v_exp_f32 v99, v99
  v_cvt_pk_bf16_f32 v112, v96, v97
  v_cvt_pk_bf16_f32 v113, v98, v99
  v_mfma_f32_32x32x16_bf16 v[48:63], v[180:183], v[116:119], v[48:63]
  v_exp_f32 v100, v100
  v_exp_f32 v101, v101
  v_exp_f32 v102, v102
  v_exp_f32 v103, v103
  v_cvt_pk_bf16_f32 v114, v100, v101
  v_cvt_pk_bf16_f32 v115, v102, v103
  v_mfma_f32_32x32x16_bf16 v[80:95], v[124:127], a[228:231], v[80:95]
  v_exp_f32 v104, v104
  v_exp_f32 v105, v105
  v_exp_f32 v106, v106
  v_exp_f32 v107, v107
  v_cvt_pk_bf16_f32 v116, v104, v105
  v_cvt_pk_bf16_f32 v117, v106, v107
  v_mfma_f32_32x32x16_bf16 v[64:79], v[176:179], v[112:115], v[64:79]
  v_exp_f32 v108, v108
  v_exp_f32 v109, v109
  v_exp_f32 v110, v110
  v_exp_f32 v111, v111
  v_cvt_pk_bf16_f32 v118, v108, v109
  v_cvt_pk_bf16_f32 v119, v110, v111
  s_waitcnt vmcnt(0)
  s_mov_b32 s71, 0
L_flp_33:
  v_cmp_ne_u32 vcc, s64, v11
  v_cmp_ne_u32 s[50:51], s64, v13
  s_or_b64 vcc, vcc, s[50:51]
  s_cbranch_vccz L_flok_32
  s_add_u32 s71, s71, 1
  s_cmp_gt_u32 s71, 400000
  s_cbranch_scc1 L_flok_32
  buffer_load_dword v11, v10, s[28:31], 0 offen sc1
  buffer_load_dword v13, v12, s[28:31], 0 offen sc1
  s_waitcnt vmcnt(0)
  s_branch L_flp_33
L_flok_32:
  v_mfma_f32_32x32x16_bf16 v[96:111], v[120:123], a[232:235], 0
  s_add_u32 s56, s11, 0
  s_and_b32 s56, s56, 3
  s_mul_i32 s56, s56, 28672
  s_mul_i32 s74, s3, 7168
  s_add_u32 s74, s74, s56
  s_add_u32 m0, s74, 49152
  s_add_u32 s74, s74, s78
  buffer_load_dwordx4 v6, s[28:31], s74 offen offset:0 sc1 lds
  v_exp_f32 v80, v80
  v_exp_f32 v81, v81
  v_exp_f32 v82, v82
  v_exp_f32 v83, v83
  v_cvt_pk_bf16_f32 v112, v80, v81
  v_cvt_pk_bf16_f32 v113, v82, v83
  v_mfma_f32_32x32x16_bf16 v[64:79], v[180:183], v[116:119], v[64:79]
  buffer_load_dwordx4 v[168:171], v6, s[28:31], s72 offen offset:0 sc1
  v_exp_f32 v84, v84
  v_exp_f32 v85, v85
  v_exp_f32 v86, v86
  v_exp_f32 v87, v87
  v_cvt_pk_bf16_f32 v114, v84, v85
  v_cvt_pk_bf16_f32 v115, v86, v87
  v_mfma_f32_32x32x16_bf16 v[96:111], v[124:127], a[236:239], v[96:111]
  v_exp_f32 v88, v88
  v_exp_f32 v89, v89
  v_exp_f32 v90, v90
  v_exp_f32 v91, v91
  v_cvt_pk_bf16_f32 v116, v88, v89
  v_cvt_pk_bf16_f32 v117, v90, v91
  v_mfma_f32_32x32x16_bf16 v[16:31], v[128:131], v[112:115], v[16:31]
  buffer_load_dwordx4 v[172:175], v6, s[28:31], s72 offen offset:1024 sc1
  v_exp_f32 v92, v92
  v_exp_f32 v93, v93
  v_exp_f32 v94, v94
  v_exp_f32 v95, v95
  v_cvt_pk_bf16_f32 v118, v92, v93
  v_cvt_pk_bf16_f32 v119, v94, v95
  v_mfma_f32_32x32x16_bf16 v[80:95], v[120:123], a[240:243], 0
  v_exp_f32 v96, v96
  v_exp_f32 v97, v97
  v_exp_f32 v98, v98
  v_exp_f32 v99, v99
  v_cvt_pk_bf16_f32 v112, v96, v97
  v_cvt_pk_bf16_f32 v113, v98, v99
  v_mfma_f32_32x32x16_bf16 v[16:31], v[132:135], v[116:119], v[16:31]
  buffer_load_dwordx4 v[176:179], v6, s[28:31], s72 offen offset:2048 sc1
  v_exp_f32 v100, v100
  v_exp_f32 v101, v101
  v_exp_f32 v102, v102
  v_exp_f32 v103, v103
  v_cvt_pk_bf16_f32 v114, v100, v101
  v_cvt_pk_bf16_f32 v115, v102, v103
  v_mfma_f32_32x32x16_bf16 v[80:95], v[124:127], a[244:247], v[80:95]
  v_exp_f32 v104, v104
  v_exp_f32 v105, v105
  v_exp_f32 v106, v106
  v_exp_f32 v107, v107
  v_cvt_pk_bf16_f32 v116, v104, v105
  v_cvt_pk_bf16_f32 v117, v106, v107
  v_mfma_f32_32x32x16_bf16 v[32:47], v[128:131], v[112:115], v[32:47]
  buffer_load_dwordx4 v[180:183], v6, s[28:31], s72 offen offset:3072 sc1
  v_exp_f32 v108, v108
  v_exp_f32 v109, v109
  v_exp_f32 v110, v110
  v_exp_f32 v111, v111
  v_cvt_pk_bf16_f32 v118, v108, v109
  v_cvt_pk_bf16_f32 v119, v110, v111
  v_mfma_f32_32x32x16_bf16 v[96:111], v[120:123], a[248:251], 0
  s_add_u32 s63, s63, 16384
  v_exp_f32 v80, v80
  v_exp_f32 v81, v81
  v_exp_f32 v82, v82
  v_exp_f32 v83, v83
  v_cvt_pk_bf16_f32 v112, v80, v81
  v_cvt_pk_bf16_f32 v113, v82, v83
  v_mfma_f32_32x32x16_bf16 v[32:47], v[132:135], v[116:119], v[32:47]
  buffer_load_dwordx4 v6, s[28:31], s74 offen offset:1024 sc1 lds
  v_exp_f32 v84, v84
  v_exp_f32 v85, v85
  v_exp_f32 v86, v86
  v_exp_f32 v87, v87
  v_cvt_pk_bf16_f32 v114, v84, v85
  v_cvt_pk_bf16_f32 v115, v86, v87
  v_mfma_f32_32x32x16_bf16 v[96:111], v[124:127], a[252:255], v[96:111]
  s_and_b32 s63, s63, 262143
  s_add_u32 s72, s73, s63
  v_exp_f32 v88, v88
  v_exp_f32 v89, v89
  v_exp_f32 v90, v90
  v_exp_f32 v91, v91
  v_cvt_pk_bf16_f32 v116, v88, v89
  v_cvt_pk_bf16_f32 v117, v90, v91
  v_mfma_f32_32x32x16_bf16 v[48:63], v[128:131], v[112:115], v[48:63]
  buffer_load_dwordx4 v6, s[28:31], s74 offen offset:2048 sc1 lds
  v_exp_f32 v92, v92
  v_exp_f32 v93, v93
  v_exp_f32 v94, v94
  v_exp_f32 v95, v95
  v_cvt_pk_bf16_f32 v118, v92, v93
  v_cvt_pk_bf16_f32 v119, v94, v95
  v_mfma_f32_32x32x16_bf16 v[80:95], v[136:139], a[224:227], 0
  v_exp_f32 v96, v96
  v_exp_f32 v97, v97
  v_exp_f32 v98, v98
  v_exp_f32 v99, v99
  v_cvt_pk_bf16_f32 v112, v96, v97
  v_cvt_pk_bf16_f32 v113, v98, v99
  v_mfma_f32_32x32x16_bf16 v[48:63], v[132:135], v[116:119], v[48:63]
  buffer_load_dwordx4 v6, s[28:31], s74 offen offset:3072 sc1 lds
  v_exp_f32 v100, v100
  v_exp_f32 v101, v101
  v_exp_f32 v102, v102
  v_exp_f32 v103, v103
  v_cvt_pk_bf16_f32 v114, v100, v101
  v_cvt_pk_bf16_f32 v115, v102, v103
  v_mfma_f32_32x32x16_bf16 v[80:95], v[140:143], a[228:231], v[80:95]
  v_exp_f32 v104, v104
  v_exp_f32 v105, v105
  v_exp_f32 v106, v106
  v_exp_f32 v107, v107
  v_cvt_pk_bf16_f32 v116, v104, v105
  v_cvt_pk_bf16_f32 v117, v106, v107
  v_mfma_f32_32x32x16_bf16 v[64:79], v[128:131], v[112:115], v[64:79]
  s_add_u32 m0, m0, 4096
  s_add_u32 s74, s74, 4096
  buffer_load_dwordx4 v6, s[28:31], s74 offen offset:0 sc1 lds
  v_exp_f32 v108, v108
  v_exp_f32 v109, v109
  v_exp_f32 v110, v110
  v_exp_f32 v111, v111
  v_cvt_pk_bf16_f32 v118, v108, v109
  v_cvt_pk_bf16_f32 v119, v110, v111
  v_mfma_f32_32x32x16_bf16 v[96:111], v[136:139], a[232:235], 0
  buffer_load_dwordx4 v6, s[28:31], s74 offen offset:1024 sc1 lds
  v_exp_f32 v80, v80
  v_exp_f32 v81, v81
  v_exp_f32 v82, v82
  v_exp_f32 v83, v83
  v_cvt_pk_bf16_f32 v112, v80, v81
  v_cvt_pk_bf16_f32 v113, v82, v83
  v_mfma_f32_32x32x16_bf16 v[64:79], v[132:135], v[116:119], v[64:79]
  buffer_load_dwordx4 v[120:123], v6, s[28:31], s72 offen offset:0 sc1
  v_exp_f32 v84, v84
  v_exp_f32 v85, v85
  v_exp_f32 v86, v86
  v_exp_f32 v87, v87
  v_cvt_pk_bf16_f32 v114, v84, v85
  v_cvt_pk_bf16_f32 v115, v86, v87
  v_mfma_f32_32x32x16_bf16 v[96:111], v[140:143], a[236:239], v[96:111]
  v_exp_f32 v88, v88
  v_exp_f32 v89, v89
  v_exp_f32 v90, v90
  v_exp_f32 v91, v91
  v_cvt_pk_bf16_f32 v116, v88, v89
  v_cvt_pk_bf16_f32 v117, v90, v91
  v_mfma_f32_32x32x16_bf16 v[16:31], v[144:147], v[112:115], v[16:31]
  buffer_load_dwordx4 v[124:127], v6, s[28:31], s72 offen offset:1024 sc1
  v_exp_f32 v92, v92
  v_exp_f32 v93, v93
  v_exp_f32 v94, v94
  v_exp_f32 v95, v95
  v_cvt_pk_bf16_f32 v118, v92, v93
  v_cvt_pk_bf16_f32 v119, v94, v95
  v_mfma_f32_32x32x16_bf16 v[80:95], v[136:139], a[240:243], 0
  v_exp_f32 v96, v96
  v_exp_f32 v97, v97
  v_exp_f32 v98, v98
  v_exp_f32 v99, v99
  v_cvt_pk_bf16_f32 v112, v96, v97
  v_cvt_pk_bf16_f32 v113, v98, v99
  v_mfma_f32_32x32x16_bf16 v[16:31], v[148:151], v[116:119], v[16:31]
  buffer_load_dwordx4 v[128:131], v6, s[28:31], s72 offen offset:2048 sc1
  v_exp_f32 v100, v100
  v_exp_f32 v101, v101
  v_exp_f32 v102, v102
  v_exp_f32 v103, v103
  v_cvt_pk_bf16_f32 v114, v100, v101
  v_cvt_pk_bf16_f32 v115, v102, v103
  v_mfma_f32_32x32x16_bf16 v[80:95], v[140:143], a[244:247], v[80:95]
  v_exp_f32 v104, v104
  v_exp_f32 v105, v105
  v_exp_f32 v106, v106
  v_exp_f32 v107, v107
  v_cvt_pk_bf16_f32 v116, v104, v105
  v_cvt_pk_bf16_f32 v117, v106, v107
  v_mfma_f32_32x32x16_bf16 v[32:47], v[144:147], v[112:115], v[32:47]
  buffer_load_dwordx4 v[132:135], v6, s[28:31], s72 offen offset:3072 sc1
  v_exp_f32 v108, v108
  v_exp_f32 v109, v109
  v_exp_f32 v110, v110
  v_exp_f32 v111, v111
  v_cvt_pk_bf16_f32 v118, v108, v109
  v_cvt_pk_bf16_f32 v119, v110, v111
  v_mfma_f32_32x32x16_bf16 v[96:111], v[136:139], a[248:251], 0
  s_add_u32 s63, s63, 16384
  v_exp_f32 v80, v80
  v_exp_f32 v81, v81
  v_exp_f32 v82, v82
  v_exp_f32 v83, v83
  v_cvt_pk_bf16_f32 v112, v80, v81
  v_cvt_pk_bf16_f32 v113, v82, v83
  v_mfma_f32_32x32x16_bf16 v[32:47], v[148:151], v[116:119], v[32:47]
  buffer_load_dwordx4 v6, s[28:31], s74 offen offset:2048 sc1 lds
  v_exp_f32 v84, v84
  v_exp_f32 v85, v85
  v_exp_f32 v86, v86
  v_exp_f32 v87, v87
  v_cvt_pk_bf16_f32 v114, v84, v85
  v_cvt_pk_bf16_f32 v115, v86, v87
  v_mfma_f32_32x32x16_bf16 v[96:111], v[140:143], a[252:255], v[96:111]
  s_and_b32 s63, s63, 262143
  s_add_u32 s72, s73, s63
  v_exp_f32 v88, v88
  v_exp_f32 v89, v89
  v_exp_f32 v90, v90
  v_exp_f32 v91, v91
  v_cvt_pk_bf16_f32 v116, v88, v89
  v_cvt_pk_bf16_f32 v117, v90, v91
  v_mfma_f32_32x32x16_bf16 v[48:63], v[144:147], v[112:115], v[48:63]
  s_add_u32 s56, s11, 1
  s_and_b32 s56, s56, 3
  s_mul_i32 s56, s56, 28672
  s_mul_i32 s74, s3, 7168
  s_add_u32 s74, s74, s56
  s_add_u32 m0, s74, 49152
  s_add_u32 s74, s74, s78
  buffer_load_dwordx4 v6, s[28:31], s74 offen offset:0 sc1 lds
  v_exp_f32 v92, v92
  v_exp_f32 v93, v93
  v_exp_f32 v94, v94
  v_exp_f32 v95, v95
  v_cvt_pk_bf16_f32 v118, v92, v93
  v_cvt_pk_bf16_f32 v119, v94, v95
  v_mfma_f32_32x32x16_bf16 v[80:95], v[152:155], a[224:227], 0
  v_exp_f32 v96, v96
  v_exp_f32 v97, v97
  v_exp_f32 v98, v98
  v_exp_f32 v99, v99
  v_cvt_pk_bf16_f32 v112, v96, v97
  v_cvt_pk_bf16_f32 v113, v98, v99
  v_mfma_f32_32x32x16_bf16 v[48:63], v[148:151], v[116:119], v[48:63]
  buffer_load_dwordx4 v6, s[28:31], s74 offen offset:1024 sc1 lds
  v_exp_f32 v100, v100
  v_exp_f32 v101, v101
  v_exp_f32 v102, v102
  v_exp_f32 v103, v103
  v_cvt_pk_bf16_f32 v114, v100, v101
  v_cvt_pk_bf16_f32 v115, v102, v103
  v_mfma_f32_32x32x16_bf16 v[80:95], v[156:159], a[228:231], v[80:95]
  v_exp_f32 v104, v104
  v_exp_f32 v105, v105
  v_exp_f32 v106, v106
  v_exp_f32 v107, v107
  v_cvt_pk_bf16_f32 v116, v104, v105
  v_cvt_pk_bf16_f32 v117, v106, v107
  v_mfma_f32_32x32x16_bf16 v[64:79], v[144:147], v[112:115], v[64:79]
  buffer_load_dwordx4 v6, s[28:31], s74 offen offset:2048 sc1 lds
  v_exp_f32 v108, v108
  v_exp_f32 v109, v109
  v_exp_f32 v110, v110
  v_exp_f32 v111, v111
  v_cvt_pk_bf16_f32 v118, v108, v109
  v_cvt_pk_bf16_f32 v119, v110, v111
  v_mfma_f32_32x32x16_bf16 v[96:111], v[152:155], a[232:235], 0
  buffer_load_dwordx4 v6, s[28:31], s74 offen offset:3072 sc1 lds
  v_exp_f32 v80, v80
  v_exp_f32 v81, v81
  v_exp_f32 v82, v82
  v_exp_f32 v83, v83
  v_cvt_pk_bf16_f32 v112, v80, v81
  v_cvt_pk_bf16_f32 v113, v82, v83
  v_mfma_f32_32x32x16_bf16 v[64:79], v[148:151], v[116:119], v[64:79]
  buffer_load_dwordx4 v[136:139], v6, s[28:31], s72 offen offset:0 sc1
  v_exp_f32 v84, v84
  v_exp_f32 v85, v85
  v_exp_f32 v86, v86
  v_exp_f32 v87, v87
  v_cvt_pk_bf16_f32 v114, v84, v85
  v_cvt_pk_bf16_f32 v115, v86, v87
  v_mfma_f32_32x32x16_bf16 v[96:111], v[156:159], a[236:239], v[96:111]
  v_exp_f32 v88, v88
  v_exp_f32 v89, v89
  v_exp_f32 v90, v90
  v_exp_f32 v91, v91
  v_cvt_pk_bf16_f32 v116, v88, v89
  v_cvt_pk_bf16_f32 v117, v90, v91
  v_mfma_f32_32x32x16_bf16 v[16:31], v[160:163], v[112:115], v[16:31]
  buffer_load_dwordx4 v[140:143], v6, s[28:31], s72 offen offset:1024 sc1
  v_exp_f32 v92, v92
  v_exp_f32 v93, v93
  v_exp_f32 v94, v94
  v_exp_f32 v95, v95
  v_cvt_pk_bf16_f32 v118, v92, v93
  v_cvt_pk_bf16_f32 v119, v94, v95
  v_mfma_f32_32x32x16_bf16 v[80:95], v[152:155], a[240:243], 0
  v_exp_f32 v96, v96
  v_exp_f32 v97, v97
  v_exp_f32 v98, v98
  v_exp_f32 v99, v99
  v_cvt_pk_bf16_f32 v112, v96, v97
  v_cvt_pk_bf16_f32 v113, v98, v99
  v_mfma_f32_32x32x16_bf16 v[16:31], v[164:167], v[116:119], v[16:31]
  buffer_load_dwordx4 v[144:147], v6, s[28:31], s72 offen offset:2048 sc1
  v_exp_f32 v100, v100
  v_exp_f32 v101, v101
  v_exp_f32 v102, v102
  v_exp_f32 v103, v103
  v_cvt_pk_bf16_f32 v114, v100, v101
  v_cvt_pk_bf16_f32 v115, v102, v103
  v_mfma_f32_32x32x16_bf16 v[80:95], v[156:159], a[244:247], v[80:95]
  v_exp_f32 v104, v104
  v_exp_f32 v105, v105
  v_exp_f32 v106, v106
  v_exp_f32 v107, v107
  v_cvt_pk_bf16_f32 v116, v104, v105
  v_cvt_pk_bf16_f32 v117, v106, v107
  v_mfma_f32_32x32x16_bf16 v[32:47], v[160:163], v[112:115], v[32:47]
  buffer_load_dwordx4 v[148:151], v6, s[28:31], s72 offen offset:3072 sc1
  v_exp_f32 v108, v108
  v_exp_f32 v109, v109
  v_exp_f32 v110, v110
  v_exp_f32 v111, v111
  v_cvt_pk_bf16_f32 v118, v108, v109
  v_cvt_pk_bf16_f32 v119, v110, v111
  v_mfma_f32_32x32x16_bf16 v[96:111], v[152:155], a[248:251], 0
  s_add_u32 s63, s63, 16384
  v_exp_f32 v80, v80
  v_exp_f32 v81, v81
  v_exp_f32 v82, v82
  v_exp_f32 v83, v83
  v_cvt_pk_bf16_f32 v112, v80, v81
  v_cvt_pk_bf16_f32 v113, v82, v83
  v_mfma_f32_32x32x16_bf16 v[32:47], v[164:167], v[116:119], v[32:47]
  s_add_u32 m0, m0, 4096
  s_add_u32 s74, s74, 4096
  buffer_load_dwordx4 v6, s[28:31], s74 offen offset:0 sc1 lds
  v_exp_f32 v84, v84
  v_exp_f32 v85, v85
  v_exp_f32 v86, v86
  v_exp_f32 v87, v87
  v_cvt_pk_bf16_f32 v114, v84, v85
  v_cvt_pk_bf16_f32 v115, v86, v87
  v_mfma_f32_32x32x16_bf16 v[96:111], v[156:159], a[252:255], v[96:111]
  s_and_b32 s63, s63, 262143
  s_add_u32 s72, s73, s63
  v_exp_f32 v88, v88
  v_exp_f32 v89, v89
  v_exp_f32 v90, v90
  v_exp_f32 v91, v91
  v_cvt_pk_bf16_f32 v116, v88, v89
  v_cvt_pk_bf16_f32 v117, v90, v91
  v_mfma_f32_32x32x16_bf16 v[48:63], v[160:163], v[112:115], v[48:63]
  buffer_load_dwordx4 v6, s[28:31], s74 offen offset:1024 sc1 lds
  v_exp_f32 v92, v92
  v_exp_f32 v93, v93
  v_exp_f32 v94, v94
  v_exp_f32 v95, v95
  v_cvt_pk_bf16_f32 v118, v92, v93
  v_cvt_pk_bf16_f32 v119, v94, v95
  s_waitcnt vmcnt(20)
  v_mfma_f32_32x32x16_bf16 v[80:95], v[168:171], a[224:227], 0
  v_exp_f32 v96, v96
  v_exp_f32 v97, v97
  v_exp_f32 v98, v98
  v_exp_f32 v99, v99
  v_cvt_pk_bf16_f32 v112, v96, v97
  v_cvt_pk_bf16_f32 v113, v98, v99
  v_mfma_f32_32x32x16_bf16 v[48:63], v[164:167], v[116:119], v[48:63]
  buffer_load_dwordx4 v6, s[28:31], s74 offen offset:2048 sc1 lds
  v_exp_f32 v100, v100
  v_exp_f32 v101, v101
  v_exp_f32 v102, v102
  v_exp_f32 v103, v103
  v_cvt_pk_bf16_f32 v114, v100, v101
  v_cvt_pk_bf16_f32 v115, v102, v103
  v_mfma_f32_32x32x16_bf16 v[80:95], v[172:175], a[228:231], v[80:95]
  v_exp_f32 v104, v104
  v_exp_f32 v105, v105
  v_exp_f32 v106, v106
  v_exp_f32 v107, v107
  v_cvt_pk_bf16_f32 v116, v104, v105
  v_cvt_pk_bf16_f32 v117, v106, v107
  v_mfma_f32_32x32x16_bf16 v[64:79], v[160:163], v[112:115], v[64:79]
  s_add_u32 s56, s11, 2
  s_and_b32 s56, s56, 3
  s_mul_i32 s56, s56, 28672
  s_mul_i32 s74, s3, 7168
  s_add_u32 s74, s74, s56
  s_add_u32 m0, s74, 49152
  s_add_u32 s74, s74, s78
  buffer_load_dwordx4 v6, s[28:31], s74 offen offset:0 sc1 lds
  v_exp_f32 v108, v108
  v_exp_f32 v109, v109
  v_exp_f32 v110, v110
  v_exp_f32 v111, v111
  v_cvt_pk_bf16_f32 v118, v108, v109
  v_cvt_pk_bf16_f32 v119, v110, v111
  v_mfma_f32_32x32x16_bf16 v[96:111], v[168:171], a[232:235], 0
  buffer_load_dwordx4 v6, s[28:31], s74 offen offset:1024 sc1 lds
  v_exp_f32 v80, v80
  v_exp_f32 v81, v81
  v_exp_f32 v82, v82
  v_exp_f32 v83, v83
  v_cvt_pk_bf16_f32 v112, v80, v81
  v_cvt_pk_bf16_f32 v113, v82, v83
  v_mfma_f32_32x32x16_bf16 v[64:79], v[164:167], v[116:119], v[64:79]
  buffer_load_dwordx4 v[152:155], v6, s[28:31], s72 offen offset:0 sc1
  v_exp_f32 v84, v84
  v_exp_f32 v85, v85
  v_exp_f32 v86, v86
  v_exp_f32 v87, v87
  v_cvt_pk_bf16_f32 v114, v84, v85
  v_cvt_pk_bf16_f32 v115, v86, v87
  v_mfma_f32_32x32x16_bf16 v[96:111], v[172:175], a[236:239], v[96:111]
  v_exp_f32 v88, v88
  v_exp_f32 v89, v89
  v_exp_f32 v90, v90
  v_exp_f32 v91, v91
  v_cvt_pk_bf16_f32 v116, v88, v89
  v_cvt_pk_bf16_f32 v117, v90, v91
  v_mfma_f32_32x32x16_bf16 v[16:31], v[176:179], v[112:115], v[16:31]
  buffer_load_dwordx4 v[156:159], v6, s[28:31], s72 offen offset:1024 sc1
  v_exp_f32 v92, v92
  v_exp_f32 v93, v93
  v_exp_f32 v94, v94
  v_exp_f32 v95, v95
  v_cvt_pk_bf16_f32 v118, v92, v93
  v_cvt_pk_bf16_f32 v119, v94, v95
  v_mfma_f32_32x32x16_bf16 v[80:95], v[168:171], a[240:243], 0
  v_exp_f32 v96, v96
  v_exp_f32 v97, v97
  v_exp_f32 v98, v98
  v_exp_f32 v99, v99
  v_cvt_pk_bf16_f32 v112, v96, v97
  v_cvt_pk_bf16_f32 v113, v98, v99
  v_mfma_f32_32x32x16_bf16 v[16:31], v[180:183], v[116:119], v[16:31]
  buffer_load_dwordx4 v[160:163], v6, s[28:31], s72 offen offset:2048 sc1
  v_exp_f32 v100, v100
  v_exp_f32 v101, v101
  v_exp_f32 v102, v102
  v_exp_f32 v103, v103
  v_cvt_pk_bf16_f32 v114, v100, v101
  v_cvt_pk_bf16_f32 v115, v102, v103
  v_mfma_f32_32x32x16_bf16 v[80:95], v[172:175], a[244:247], v[80:95]
  v_exp_f32 v104, v104
  v_exp_f32 v105, v105
  v_exp_f32 v106, v106
  v_exp_f32 v107, v107
  v_cvt_pk_bf16_f32 v116, v104, v105
  v_cvt_pk_bf16_f32 v117, v106, v107
  v_mfma_f32_32x32x16_bf16 v[32:47], v[176:179], v[112:115], v[32:47]
  buffer_load_dwordx4 v[164:167], v6, s[28:31], s72 offen offset:3072 sc1
  v_exp_f32 v108, v108
  v_exp_f32 v109, v109
  v_exp_f32 v110, v110
  v_exp_f32 v111, v111
  v_cvt_pk_bf16_f32 v118, v108, v109
  v_cvt_pk_bf16_f32 v119, v110, v111
  v_mfma_f32_32x32x16_bf16 v[96:111], v[168:171], a[248:251], 0
  s_add_u32 s63, s63, 16384
  v_exp_f32 v80, v80
  v_exp_f32 v81, v81
  v_exp_f32 v82, v82
  v_exp_f32 v83, v83
  v_cvt_pk_bf16_f32 v112, v80, v81
  v_cvt_pk_bf16_f32 v113, v82, v83
  v_mfma_f32_32x32x16_bf16 v[32:47], v[180:183], v[116:119], v[32:47]
  buffer_load_dwordx4 v6, s[28:31], s74 offen offset:2048 sc1 lds
  v_exp_f32 v84, v84
  v_exp_f32 v85, v85
  v_exp_f32 v86, v86
  v_exp_f32 v87, v87
  v_cvt_pk_bf16_f32 v114, v84, v85
  v_cvt_pk_bf16_f32 v115, v86, v87
  v_mfma_f32_32x32x16_bf16 v[96:111], v[172:175], a[252:255], v[96:111]
  s_and_b32 s63, s63, 262143
  s_add_u32 s72, s73, s63
  v_exp_f32 v88, v88
  v_exp_f32 v89, v89
  v_exp_f32 v90, v90
  v_exp_f32 v91, v91
  v_cvt_pk_bf16_f32 v116, v88, v89
  v_cvt_pk_bf16_f32 v117, v90, v91
  v_mfma_f32_32x32x16_bf16 v[48:63], v[176:179], v[112:115], v[48:63]
  buffer_load_dwordx4 v6, s[28:31], s74 offen offset:3072 sc1 lds
  v_exp_f32 v92, v92
  v_exp_f32 v93, v93
  v_exp_f32 v94, v94
  v_exp_f32 v95, v95
  v_cvt_pk_bf16_f32 v118, v92, v93
  v_cvt_pk_bf16_f32 v119, v94, v95
  s_waitcnt vmcnt(20)
  v_mfma_f32_32x32x16_bf16 v[80:95], v[120:123], a[224:227], 0
  v_exp_f32 v96, v96
  v_exp_f32 v97, v97
  v_exp_f32 v98, v98
  v_exp_f32 v99, v99
  v_cvt_pk_bf16_f32 v112, v96, v97
  v_cvt_pk_bf16_f32 v113, v98, v99
  v_mfma_f32_32x32x16_bf16 v[48:63], v[180:183], v[116:119], v[48:63]
  s_add_u32 m0, m0, 4096
  s_add_u32 s74, s74, 4096
  buffer_load_dwordx4 v6, s[28:31], s74 offen offset:0 sc1 lds
  v_exp_f32 v100, v100
  v_exp_f32 v101, v101
  v_exp_f32 v102, v102
  v_exp_f32 v103, v103
  v_cvt_pk_bf16_f32 v114, v100, v101
  v_cvt_pk_bf16_f32 v115, v102, v103
  v_mfma_f32_32x32x16_bf16 v[80:95], v[124:127], a[228:231], v[80:95]
  v_exp_f32 v104, v104
  v_exp_f32 v105, v105
  v_exp_f32 v106, v106
  v_exp_f32 v107, v107
  v_cvt_pk_bf16_f32 v116, v104, v105
  v_cvt_pk_bf16_f32 v117, v106, v107
  v_mfma_f32_32x32x16_bf16 v[64:79], v[176:179], v[112:115], v[64:79]
  buffer_load_dwordx4 v6, s[28:31], s74 offen offset:1024 sc1 lds
  v_exp_f32 v108, v108
  v_exp_f32 v109, v109
  v_exp_f32 v110, v110
  v_exp_f32 v111, v111
  v_cvt_pk_bf16_f32 v118, v108, v109
  v_cvt_pk_bf16_f32 v119, v110, v111
  v_mfma_f32_32x32x16_bf16 v[96:111], v[120:123], a[232:235], 0
  buffer_load_dwordx4 v6, s[28:31], s74 offen offset:2048 sc1 lds
  v_exp_f32 v80, v80
  v_exp_f32 v81, v81
  v_exp_f32 v82, v82
  v_exp_f32 v83, v83
  v_cvt_pk_bf16_f32 v112, v80, v81
  v_cvt_pk_bf16_f32 v113, v82, v83
  v_mfma_f32_32x32x16_bf16 v[64:79], v[180:183], v[116:119], v[64:79]
  buffer_load_dwordx4 v[168:171], v6, s[28:31], s72 offen offset:0 sc1
  v_exp_f32 v84, v84
  v_exp_f32 v85, v85
  v_exp_f32 v86, v86
  v_exp_f32 v87, v87
  v_cvt_pk_bf16_f32 v114, v84, v85
  v_cvt_pk_bf16_f32 v115, v86, v87
  v_mfma_f32_32x32x16_bf16 v[96:111], v[124:127], a[236:239], v[96:111]
  v_exp_f32 v88, v88
  v_exp_f32 v89, v89
  v_exp_f32 v90, v90
  v_exp_f32 v91, v91
  v_cvt_pk_bf16_f32 v116, v88, v89
  v_cvt_pk_bf16_f32 v117, v90, v91
  v_mfma_f32_32x32x16_bf16 v[16:31], v[128:131], v[112:115], v[16:31]
  buffer_load_dwordx4 v[172:175], v6, s[28:31], s72 offen offset:1024 sc1
  v_exp_f32 v92, v92
  v_exp_f32 v93, v93
  v_exp_f32 v94, v94
  v_exp_f32 v95, v95
  v_cvt_pk_bf16_f32 v118, v92, v93
  v_cvt_pk_bf16_f32 v119, v94, v95
  v_mfma_f32_32x32x16_bf16 v[80:95], v[120:123], a[240:243], 0
  v_exp_f32 v96, v96
  v_exp_f32 v97, v97
  v_exp_f32 v98, v98
  v_exp_f32 v99, v99
  v_cvt_pk_bf16_f32 v112, v96, v97
  v_cvt_pk_bf16_f32 v113, v98, v99
  v_mfma_f32_32x32x16_bf16 v[16:31], v[132:135], v[116:119], v[16:31]
  buffer_load_dwordx4 v[176:179], v6, s[28:31], s72 offen offset:2048 sc1
  v_exp_f32 v100, v100
  v_exp_f32 v101, v101
  v_exp_f32 v102, v102
  v_exp_f32 v103, v103
  v_cvt_pk_bf16_f32 v114, v100, v101
  v_cvt_pk_bf16_f32 v115, v102, v103
  v_mfma_f32_32x32x16_bf16 v[80:95], v[124:127], a[244:247], v[80:95]
  v_exp_f32 v104, v104
  v_exp_f32 v105, v105
  v_exp_f32 v106, v106
  v_exp_f32 v107, v107
  v_cvt_pk_bf16_f32 v116, v104, v105
  v_cvt_pk_bf16_f32 v117, v106, v107
  v_mfma_f32_32x32x16_bf16 v[32:47], v[128:131], v[112:115], v[32:47]
  buffer_load_dwordx4 v[180:183], v6, s[28:31], s72 offen offset:3072 sc1
  v_exp_f32 v108, v108
  v_exp_f32 v109, v109
  v_exp_f32 v110, v110
  v_exp_f32 v111, v111
  v_cvt_pk_bf16_f32 v118, v108, v109
  v_cvt_pk_bf16_f32 v119, v110, v111
  v_mfma_f32_32x32x16_bf16 v[96:111], v[120:123], a[248:251], 0
  s_add_u32 s63, s63, 16384
  v_exp_f32 v80, v80
  v_exp_f32 v81, v81
  v_exp_f32 v82, v82
  v_exp_f32 v83, v83
  v_cvt_pk_bf16_f32 v112, v80, v81
  v_cvt_pk_bf16_f32 v113, v82, v83
  v_mfma_f32_32x32x16_bf16 v[32:47], v[132:135], v[116:119], v[32:47]
  s_add_u32 s56, s11, 3
  s_and_b32 s56, s56, 3
  s_mul_i32 s56, s56, 28672
  s_mul_i32 s74, s3, 7168
  s_add_u32 s74, s74, s56
  s_add_u32 m0, s74, 49152
  s_add_u32 s74, s74, s78
  buffer_load_dwordx4 v6, s[28:31], s74 offen offset:0 sc1 lds
  v_exp_f32 v84, v84
  v_exp_f32 v85, v85
  v_exp_f32 v86, v86
  v_exp_f32 v87, v87
  v_cvt_pk_bf16_f32 v114, v84, v85
  v_cvt_pk_bf16_f32 v115, v86, v87
  v_mfma_f32_32x32x16_bf16 v[96:111], v[124:127], a[252:255], v[96:111]
  s_and_b32 s63, s63, 262143
  s_add_u32 s72, s73, s63
  v_exp_f32 v88, v88
  v_exp_f32 v89, v89
  v_exp_f32 v90, v90
  v_exp_f32 v91, v91
  v_cvt_pk_bf16_f32 v116, v88, v89
  v_cvt_pk_bf16_f32 v117, v90, v91
  v_mfma_f32_32x32x16_bf16 v[48:63], v[128:131], v[112:115], v[48:63]
  buffer_load_dwordx4 v6, s[28:31], s74 offen offset:1024 sc1 lds
  v_exp_f32 v92, v92
  v_exp_f32 v93, v93
  v_exp_f32 v94, v94
  v_exp_f32 v95, v95
  v_cvt_pk_bf16_f32 v118, v92, v93
  v_cvt_pk_bf16_f32 v119, v94, v95
  s_waitcnt vmcnt(20)
  v_mfma_f32_32x32x16_bf16 v[80:95], v[136:139], a[224:227], 0
  v_exp_f32 v96, v96
  v_exp_f32 v97, v97
  v_exp_f32 v98, v98
  v_exp_f32 v99, v99
  v_cvt_pk_bf16_f32 v112, v96, v97
  v_cvt_pk_bf16_f32 v113, v98, v99
  v_mfma_f32_32x32x16_bf16 v[48:63], v[132:135], v[116:119], v[48:63]
  buffer_load_dwordx4 v6, s[28:31], s74 offen offset:2048 sc1 lds
  v_exp_f32 v100, v100
  v_exp_f32 v101, v101
  v_exp_f32 v102, v102
  v_exp_f32 v103, v103
  v_cvt_pk_bf16_f32 v114, v100, v101
  v_cvt_pk_bf16_f32 v115, v102, v103
  v_mfma_f32_32x32x16_bf16 v[80:95], v[140:143], a[228:231], v[80:95]
  v_exp_f32 v104, v104
  v_exp_f32 v105, v105
  v_exp_f32 v106, v106
  v_exp_f32 v107, v107
  v_cvt_pk_bf16_f32 v116, v104, v105
  v_cvt_pk_bf16_f32 v117, v106, v107
  v_mfma_f32_32x32x16_bf16 v[64:79], v[128:131], v[112:115], v[64:79]
  buffer_load_dwordx4 v6, s[28:31], s74 offen offset:3072 sc1 lds
  v_exp_f32 v108, v108
  v_exp_f32 v109, v109
  v_exp_f32 v110, v110
  v_exp_f32 v111, v111
  v_cvt_pk_bf16_f32 v118, v108, v109
  v_cvt_pk_bf16_f32 v119, v110, v111
  v_mfma_f32_32x32x16_bf16 v[96:111], v[136:139], a[232:235], 0
  s_add_u32 m0, m0, 4096
  s_add_u32 s74, s74, 4096
  buffer_load_dwordx4 v6, s[28:31], s74 offen offset:0 sc1 lds
  v_exp_f32 v80, v80
  v_exp_f32 v81, v81
  v_exp_f32 v82, v82
  v_exp_f32 v83, v83
  v_cvt_pk_bf16_f32 v112, v80, v81
  v_cvt_pk_bf16_f32 v113, v82, v83
  v_mfma_f32_32x32x16_bf16 v[64:79], v[132:135], v[116:119], v[64:79]
  buffer_load_dwordx4 v[120:123], v6, s[28:31], s72 offen offset:0 sc1
  v_exp_f32 v84, v84
  v_exp_f32 v85, v85
  v_exp_f32 v86, v86
  v_exp_f32 v87, v87
  v_cvt_pk_bf16_f32 v114, v84, v85
  v_cvt_pk_bf16_f32 v115, v86, v87
  v_mfma_f32_32x32x16_bf16 v[96:111], v[140:143], a[236:239], v[96:111]
  v_exp_f32 v88, v88
  v_exp_f32 v89, v89
  v_exp_f32 v90, v90
  v_exp_f32 v91, v91
  v_cvt_pk_bf16_f32 v116, v88, v89
  v_cvt_pk_bf16_f32 v117, v90, v91
  v_mfma_f32_32x32x16_bf16 v[16:31], v[144:147], v[112:115], v[16:31]
  buffer_load_dwordx4 v[124:127], v6, s[28:31], s72 offen offset:1024 sc1
  v_exp_f32 v92, v92
  v_exp_f32 v93, v93
  v_exp_f32 v94, v94
  v_exp_f32 v95, v95
  v_cvt_pk_bf16_f32 v118, v92, v93
  v_cvt_pk_bf16_f32 v119, v94, v95
  v_mfma_f32_32x32x16_bf16 v[80:95], v[136:139], a[240:243], 0
  v_exp_f32 v96, v96
  v_exp_f32 v97, v97
  v_exp_f32 v98, v98
  v_exp_f32 v99, v99
  v_cvt_pk_bf16_f32 v112, v96, v97
  v_cvt_pk_bf16_f32 v113, v98, v99
  v_mfma_f32_32x32x16_bf16 v[16:31], v[148:151], v[116:119], v[16:31]
  buffer_load_dwordx4 v[128:131], v6, s[28:31], s72 offen offset:2048 sc1
  v_exp_f32 v100, v100
  v_exp_f32 v101, v101
  v_exp_f32 v102, v102
  v_exp_f32 v103, v103
  v_cvt_pk_bf16_f32 v114, v100, v101
  v_cvt_pk_bf16_f32 v115, v102, v103
  v_mfma_f32_32x32x16_bf16 v[80:95], v[140:143], a[244:247], v[80:95]
  v_exp_f32 v104, v104
  v_exp_f32 v105, v105
  v_exp_f32 v106, v106
  v_exp_f32 v107, v107
  v_cvt_pk_bf16_f32 v116, v104, v105
  v_cvt_pk_bf16_f32 v117, v106, v107
  v_mfma_f32_32x32x16_bf16 v[32:47], v[144:147], v[112:115], v[32:47]
  buffer_load_dwordx4 v[132:135], v6, s[28:31], s72 offen offset:3072 sc1
  v_exp_f32 v108, v108
  v_exp_f32 v109, v109
  v_exp_f32 v110, v110
  v_exp_f32 v111, v111
  v_cvt_pk_bf16_f32 v118, v108, v109
  v_cvt_pk_bf16_f32 v119, v110, v111
  v_mfma_f32_32x32x16_bf16 v[96:111], v[136:139], a[248:251], 0
  s_add_u32 s63, s63, 16384
  v_exp_f32 v80, v80
  v_exp_f32 v81, v81
  v_exp_f32 v82, v82
  v_exp_f32 v83, v83
  v_cvt_pk_bf16_f32 v112, v80, v81
  v_cvt_pk_bf16_f32 v113, v82, v83
  v_mfma_f32_32x32x16_bf16 v[32:47], v[148:151], v[116:119], v[32:47]
  buffer_load_dwordx4 v6, s[28:31], s74 offen offset:1024 sc1 lds
  v_exp_f32 v84, v84
  v_exp_f32 v85, v85
  v_exp_f32 v86, v86
  v_exp_f32 v87, v87
  v_cvt_pk_bf16_f32 v114, v84, v85
  v_cvt_pk_bf16_f32 v115, v86, v87
  v_mfma_f32_32x32x16_bf16 v[96:111], v[140:143], a[252:255], v[96:111]
  s_and_b32 s63, s63, 262143
  s_add_u32 s72, s73, s63
  v_exp_f32 v88, v88
  v_exp_f32 v89, v89
  v_exp_f32 v90, v90
  v_exp_f32 v91, v91
  v_cvt_pk_bf16_f32 v116, v88, v89
  v_cvt_pk_bf16_f32 v117, v90, v91
  v_mfma_f32_32x32x16_bf16 v[48:63], v[144:147], v[112:115], v[48:63]
  buffer_load_dwordx4 v6, s[28:31], s74 offen offset:2048 sc1 lds
  v_exp_f32 v92, v92
  v_exp_f32 v93, v93
  v_exp_f32 v94, v94
  v_exp_f32 v95, v95
  v_cvt_pk_bf16_f32 v118, v92, v93
  v_cvt_pk_bf16_f32 v119, v94, v95
  s_waitcnt vmcnt(20)
  v_mfma_f32_32x32x16_bf16 v[80:95], v[152:155], a[224:227], 0
  v_exp_f32 v96, v96
  v_exp_f32 v97, v97
  v_exp_f32 v98, v98
  v_exp_f32 v99, v99
  v_cvt_pk_bf16_f32 v112, v96, v97
  v_cvt_pk_bf16_f32 v113, v98, v99
  v_mfma_f32_32x32x16_bf16 v[48:63], v[148:151], v[116:119], v[48:63]
  s_xor_b32 s74, s75, 0
  s_lshl_b32 s74, s74, 2
  s_add_u32 s74, s74, s3
  s_lshl_b32 s74, s74, 13
  s_add_u32 s74, s74, 2424832
  buffer_load_dwordx4 v[184:187], v6, s[28:31], s74 offen offset:0 sc1
  v_exp_f32 v100, v100
  v_exp_f32 v101, v101
  v_exp_f32 v102, v102
  v_exp_f32 v103, v103
  v_cvt_pk_bf16_f32 v114, v100, v101
  v_cvt_pk_bf16_f32 v115, v102, v103
  v_mfma_f32_32x32x16_bf16 v[80:95], v[156:159], a[228:231], v[80:95]
  v_exp_f32 v104, v104
  v_exp_f32 v105, v105
  v_exp_f32 v106, v106
  v_exp_f32 v107, v107
  v_cvt_pk_bf16_f32 v116, v104, v105
  v_cvt_pk_bf16_f32 v117, v106, v107
  v_mfma_f32_32x32x16_bf16 v[64:79], v[144:147], v[112:115], v[64:79]
  buffer_load_dwordx4 v[188:191], v6, s[28:31], s74 offen offset:1024 sc1
  v_exp_f32 v108, v108
  v_exp_f32 v109, v109
  v_exp_f32 v110, v110
  v_exp_f32 v111, v111
  v_cvt_pk_bf16_f32 v118, v108, v109
  v_cvt_pk_bf16_f32 v119, v110, v111
  v_mfma_f32_32x32x16_bf16 v[96:111], v[152:155], a[232:235], 0
  buffer_load_dwordx4 v[192:195], v6, s[28:31], s74 offen offset:2048 sc1
  v_exp_f32 v80, v80
  v_exp_f32 v81, v81
  v_exp_f32 v82, v82
  v_exp_f32 v83, v83
  v_cvt_pk_bf16_f32 v112, v80, v81
  v_cvt_pk_bf16_f32 v113, v82, v83
  v_mfma_f32_32x32x16_bf16 v[64:79], v[148:151], v[116:119], v[64:79]
  buffer_load_dwordx4 v[136:139], v6, s[28:31], s72 offen offset:0 sc1
  v_exp_f32 v84, v84
  v_exp_f32 v85, v85
  v_exp_f32 v86, v86
  v_exp_f32 v87, v87
  v_cvt_pk_bf16_f32 v114, v84, v85
  v_cvt_pk_bf16_f32 v115, v86, v87
  v_mfma_f32_32x32x16_bf16 v[96:111], v[156:159], a[236:239], v[96:111]
  v_exp_f32 v88, v88
  v_exp_f32 v89, v89
  v_exp_f32 v90, v90
  v_exp_f32 v91, v91
  v_cvt_pk_bf16_f32 v116, v88, v89
  v_cvt_pk_bf16_f32 v117, v90, v91
  v_mfma_f32_32x32x16_bf16 v[16:31], v[160:163], v[112:115], v[16:31]
  buffer_load_dwordx4 v[140:143], v6, s[28:31], s72 offen offset:1024 sc1
  v_exp_f32 v92, v92
  v_exp_f32 v93, v93
  v_exp_f32 v94, v94
  v_exp_f32 v95, v95
  v_cvt_pk_bf16_f32 v118, v92, v93
  v_cvt_pk_bf16_f32 v119, v94, v95
  v_mfma_f32_32x32x16_bf16 v[80:95], v[152:155], a[240:243], 0
  v_exp_f32 v96, v96
  v_exp_f32 v97, v97
  v_exp_f32 v98, v98
  v_exp_f32 v99, v99
  v_cvt_pk_bf16_f32 v112, v96, v97
  v_cvt_pk_bf16_f32 v113, v98, v99
  v_mfma_f32_32x32x16_bf16 v[16:31], v[164:167], v[116:119], v[16:31]
  buffer_load_dwordx4 v[144:147], v6, s[28:31], s72 offen offset:2048 sc1
  v_exp_f32 v100, v100
  v_exp_f32 v101, v101
  v_exp_f32 v102, v102
  v_exp_f32 v103, v103
  v_cvt_pk_bf16_f32 v114, v100, v101
  v_cvt_pk_bf16_f32 v115, v102, v103
  v_mfma_f32_32x32x16_bf16 v[80:95], v[156:159], a[244:247], v[80:95]
  v_exp_f32 v104, v104
  v_exp_f32 v105, v105
  v_exp_f32 v106, v106
  v_exp_f32 v107, v107
  v_cvt_pk_bf16_f32 v116, v104, v105
  v_cvt_pk_bf16_f32 v117, v106, v107
  v_mfma_f32_32x32x16_bf16 v[32:47], v[160:163], v[112:115], v[32:47]
  buffer_load_dwordx4 v[148:151], v6, s[28:31], s72 offen offset:3072 sc1
  v_exp_f32 v108, v108
  v_exp_f32 v109, v109
  v_exp_f32 v110, v110
  v_exp_f32 v111, v111
  v_cvt_pk_bf16_f32 v118, v108, v109
  v_cvt_pk_bf16_f32 v119, v110, v111
  v_mfma_f32_32x32x16_bf16 v[96:111], v[152:155], a[248:251], 0
  s_add_u32 s63, s63, 16384
  v_exp_f32 v80, v80
  v_exp_f32 v81, v81
  v_exp_f32 v82, v82
  v_exp_f32 v83, v83
  v_cvt_pk_bf16_f32 v112, v80, v81
  v_cvt_pk_bf16_f32 v113, v82, v83
  v_mfma_f32_32x32x16_bf16 v[32:47], v[164:167], v[116:119], v[32:47]
  buffer_load_dwordx4 v[196:199], v6, s[28:31], s74 offen offset:3072 sc1
  v_exp_f32 v84, v84
  v_exp_f32 v85, v85
  v_exp_f32 v86, v86
  v_exp_f32 v87, v87
  v_cvt_pk_bf16_f32 v114, v84, v85
  v_cvt_pk_bf16_f32 v115, v86, v87
  v_mfma_f32_32x32x16_bf16 v[96:111], v[156:159], a[252:255], v[96:111]
  s_and_b32 s63, s63, 262143
  s_add_u32 s72, s73, s63
  v_exp_f32 v88, v88
  v_exp_f32 v89, v89
  v_exp_f32 v90, v90
  v_exp_f32 v91, v91
  v_cvt_pk_bf16_f32 v116, v88, v89
  v_cvt_pk_bf16_f32 v117, v90, v91
  v_mfma_f32_32x32x16_bf16 v[48:63], v[160:163], v[112:115], v[48:63]
  s_add_u32 s74, s74, 4096
  buffer_load_dwordx4 v[200:203], v6, s[28:31], s74 offen offset:0 sc1
  v_exp_f32 v92, v92
  v_exp_f32 v93, v93
  v_exp_f32 v94, v94
  v_exp_f32 v95, v95
  v_cvt_pk_bf16_f32 v118, v92, v93
  v_cvt_pk_bf16_f32 v119, v94, v95
  s_waitcnt vmcnt(20)
  v_mfma_f32_32x32x16_bf16 v[80:95], v[168:171], a[224:227], 0
  v_exp_f32 v96, v96
  v_exp_f32 v97, v97
  v_exp_f32 v98, v98
  v_exp_f32 v99, v99
  v_cvt_pk_bf16_f32 v112, v96, v97
  v_cvt_pk_bf16_f32 v113, v98, v99
  v_mfma_f32_32x32x16_bf16 v[48:63], v[164:167], v[116:119], v[48:63]
  buffer_load_dwordx4 v[204:207], v6, s[28:31], s74 offen offset:1024 sc1
  v_exp_f32 v100, v100
  v_exp_f32 v101, v101
  v_exp_f32 v102, v102
  v_exp_f32 v103, v103
  v_cvt_pk_bf16_f32 v114, v100, v101
  v_cvt_pk_bf16_f32 v115, v102, v103
  v_mfma_f32_32x32x16_bf16 v[80:95], v[172:175], a[228:231], v[80:95]
  v_exp_f32 v104, v104
  v_exp_f32 v105, v105
  v_exp_f32 v106, v106
  v_exp_f32 v107, v107
  v_cvt_pk_bf16_f32 v116, v104, v105
  v_cvt_pk_bf16_f32 v117, v106, v107
  v_mfma_f32_32x32x16_bf16 v[64:79], v[160:163], v[112:115], v[64:79]
  buffer_load_dwordx4 v[208:211], v6, s[28:31], s74 offen offset:2048 sc1
  v_exp_f32 v108, v108
  v_exp_f32 v109, v109
  v_exp_f32 v110, v110
  v_exp_f32 v111, v111
  v_cvt_pk_bf16_f32 v118, v108, v109
  v_cvt_pk_bf16_f32 v119, v110, v111
  v_mfma_f32_32x32x16_bf16 v[96:111], v[168:171], a[232:235], 0
  buffer_load_dwordx4 v[212:215], v6, s[28:31], s74 offen offset:3072 sc1
  v_exp_f32 v80, v80
  v_exp_f32 v81, v81
  v_exp_f32 v82, v82
  v_exp_f32 v83, v83
  v_cvt_pk_bf16_f32 v112, v80, v81
  v_cvt_pk_bf16_f32 v113, v82, v83
  v_mfma_f32_32x32x16_bf16 v[64:79], v[164:167], v[116:119], v[64:79]
  buffer_load_dwordx4 v[152:155], v6, s[28:31], s72 offen offset:0 sc1
  v_exp_f32 v84, v84
  v_exp_f32 v85, v85
  v_exp_f32 v86, v86
  v_exp_f32 v87, v87
  v_cvt_pk_bf16_f32 v114, v84, v85
  v_cvt_pk_bf16_f32 v115, v86, v87
  v_mfma_f32_32x32x16_bf16 v[96:111], v[172:175], a[236:239], v[96:111]
  v_exp_f32 v88, v88
  v_exp_f32 v89, v89
  v_exp_f32 v90, v90
  v_exp_f32 v91, v91
  v_cvt_pk_bf16_f32 v116, v88, v89
  v_cvt_pk_bf16_f32 v117, v90, v91
  v_mfma_f32_32x32x16_bf16 v[16:31], v[176:179], v[112:115], v[16:31]
  buffer_load_dwordx4 v[156:159], v6, s[28:31], s72 offen offset:1024 sc1
  v_exp_f32 v92, v92
  v_exp_f32 v93, v93
  v_exp_f32 v94, v94
  v_exp_f32 v95, v95
  v_cvt_pk_bf16_f32 v118, v92, v93
  v_cvt_pk_bf16_f32 v119, v94, v95
  v_mfma_f32_32x32x16_bf16 v[80:95], v[168:171], a[240:243], 0
  v_exp_f32 v96, v96
  v_exp_f32 v97, v97
  v_exp_f32 v98, v98
  v_exp_f32 v99, v99
  v_cvt_pk_bf16_f32 v112, v96, v97
  v_cvt_pk_bf16_f32 v113, v98, v99
  v_mfma_f32_32x32x16_bf16 v[16:31], v[180:183], v[116:119], v[16:31]
  buffer_load_dwordx4 v[160:163], v6, s[28:31], s72 offen offset:2048 sc1
  v_exp_f32 v100, v100
  v_exp_f32 v101, v101
  v_exp_f32 v102, v102
  v_exp_f32 v103, v103
  v_cvt_pk_bf16_f32 v114, v100, v101
  v_cvt_pk_bf16_f32 v115, v102, v103
  v_mfma_f32_32x32x16_bf16 v[80:95], v[172:175], a[244:247], v[80:95]
  v_exp_f32 v104, v104
  v_exp_f32 v105, v105
  v_exp_f32 v106, v106
  v_exp_f32 v107, v107
  v_cvt_pk_bf16_f32 v116, v104, v105
  v_cvt_pk_bf16_f32 v117, v106, v107
  v_mfma_f32_32x32x16_bf16 v[32:47], v[176:179], v[112:115], v[32:47]
  buffer_load_dwordx4 v[164:167], v6, s[28:31], s72 offen offset:3072 sc1
  v_exp_f32 v108, v108
  v_exp_f32 v109, v109
  v_exp_f32 v110, v110
  v_exp_f32 v111, v111
  v_cvt_pk_bf16_f32 v118, v108, v109
  v_cvt_pk_bf16_f32 v119, v110, v111
  v_mfma_f32_32x32x16_bf16 v[96:111], v[168:171], a[248:251], 0
  s_add_u32 s63, s63, 16384
  v_exp_f32 v80, v80
  v_exp_f32 v81, v81
  v_exp_f32 v82, v82
  v_exp_f32 v83, v83
  v_cvt_pk_bf16_f32 v112, v80, v81
  v_cvt_pk_bf16_f32 v113, v82, v83
  v_mfma_f32_32x32x16_bf16 v[32:47], v[180:183], v[116:119], v[32:47]
  s_xor_b32 s74, s75, 1
  s_lshl_b32 s74, s74, 2
  s_add_u32 s74, s74, s3
  s_lshl_b32 s74, s74, 13
  s_add_u32 s74, s74, 2424832
  buffer_load_dwordx4 v[216:219], v6, s[28:31], s74 offen offset:0 sc1
  v_exp_f32 v84, v84
  v_exp_f32 v85, v85
  v_exp_f32 v86, v86
  v_exp_f32 v87, v87
  v_cvt_pk_bf16_f32 v114, v84, v85
  v_cvt_pk_bf16_f32 v115, v86, v87
  v_mfma_f32_32x32x16_bf16 v[96:111], v[172:175], a[252:255], v[96:111]
  s_and_b32 s63, s63, 262143
  s_add_u32 s72, s73, s63
  v_exp_f32 v88, v88
  v_exp_f32 v89, v89
  v_exp_f32 v90, v90
  v_exp_f32 v91, v91
  v_cvt_pk_bf16_f32 v116, v88, v89
  v_cvt_pk_bf16_f32 v117, v90, v91
  v_mfma_f32_32x32x16_bf16 v[48:63], v[176:179], v[112:115], v[48:63]
  buffer_load_dwordx4 v[220:223], v6, s[28:31], s74 offen offset:1024 sc1
  v_exp_f32 v92, v92
  v_exp_f32 v93, v93
  v_exp_f32 v94, v94
  v_exp_f32 v95, v95
  v_cvt_pk_bf16_f32 v118, v92, v93
  v_cvt_pk_bf16_f32 v119, v94, v95
  s_waitcnt vmcnt(20)
  v_mfma_f32_32x32x16_bf16 v[80:95], v[120:123], a[224:227], 0
  v_exp_f32 v96, v96
  v_exp_f32 v97, v97
  v_exp_f32 v98, v98
  v_exp_f32 v99, v99
  v_cvt_pk_bf16_f32 v112, v96, v97
  v_cvt_pk_bf16_f32 v113, v98, v99
  v_mfma_f32_32x32x16_bf16 v[48:63], v[180:183], v[116:119], v[48:63]
  buffer_load_dwordx4 v[224:227], v6, s[28:31], s74 offen offset:2048 sc1
  v_exp_f32 v100, v100
  v_exp_f32 v101, v101
  v_exp_f32 v102, v102
  v_exp_f32 v103, v103
  v_cvt_pk_bf16_f32 v114, v100, v101
  v_cvt_pk_bf16_f32 v115, v102, v103
  v_mfma_f32_32x32x16_bf16 v[80:95], v[124:127], a[228:231], v[80:95]
  v_exp_f32 v104, v104
  v_exp_f32 v105, v105
  v_exp_f32 v106, v106
  v_exp_f32 v107, v107
  v_cvt_pk_bf16_f32 v116, v104, v105
  v_cvt_pk_bf16_f32 v117, v106, v107
  v_mfma_f32_32x32x16_bf16 v[64:79], v[176:179], v[112:115], v[64:79]
  buffer_load_dwordx4 v[228:231], v6, s[28:31], s74 offen offset:3072 sc1
  v_exp_f32 v108, v108
  v_exp_f32 v109, v109
  v_exp_f32 v110, v110
  v_exp_f32 v111, v111
  v_cvt_pk_bf16_f32 v118, v108, v109
  v_cvt_pk_bf16_f32 v119, v110, v111
  v_mfma_f32_32x32x16_bf16 v[96:111], v[120:123], a[232:235], 0
  s_add_u32 s74, s74, 4096
  buffer_load_dwordx4 v[232:235], v6, s[28:31], s74 offen offset:0 sc1
  v_exp_f32 v80, v80
  v_exp_f32 v81, v81
  v_exp_f32 v82, v82
  v_exp_f32 v83, v83
  v_cvt_pk_bf16_f32 v112, v80, v81
  v_cvt_pk_bf16_f32 v113, v82, v83
  v_mfma_f32_32x32x16_bf16 v[64:79], v[180:183], v[116:119], v[64:79]
  buffer_load_dwordx4 v[168:171], v6, s[28:31], s72 offen offset:0 sc1
  v_exp_f32 v84, v84
  v_exp_f32 v85, v85
  v_exp_f32 v86, v86
  v_exp_f32 v87, v87
  v_cvt_pk_bf16_f32 v114, v84, v85
  v_cvt_pk_bf16_f32 v115, v86, v87
  v_mfma_f32_32x32x16_bf16 v[96:111], v[124:127], a[236:239], v[96:111]
  v_exp_f32 v88, v88
  v_exp_f32 v89, v89
  v_exp_f32 v90, v90
  v_exp_f32 v91, v91
  v_cvt_pk_bf16_f32 v116, v88, v89
  v_cvt_pk_bf16_f32 v117, v90, v91
  v_mfma_f32_32x32x16_bf16 v[16:31], v[128:131], v[112:115], v[16:31]
  buffer_load_dwordx4 v[172:175], v6, s[28:31], s72 offen offset:1024 sc1
  v_exp_f32 v92, v92
  v_exp_f32 v93, v93
  v_exp_f32 v94, v94
  v_exp_f32 v95, v95
  v_cvt_pk_bf16_f32 v118, v92, v93
  v_cvt_pk_bf16_f32 v119, v94, v95
  v_mfma_f32_32x32x16_bf16 v[80:95], v[120:123], a[240:243], 0
  v_exp_f32 v96, v96
  v_exp_f32 v97, v97
  v_exp_f32 v98, v98
  v_exp_f32 v99, v99
  v_cvt_pk_bf16_f32 v112, v96, v97
  v_cvt_pk_bf16_f32 v113, v98, v99
  v_mfma_f32_32x32x16_bf16 v[16:31], v[132:135], v[116:119], v[16:31]
  buffer_load_dwordx4 v[176:179], v6, s[28:31], s72 offen offset:2048 sc1
  v_exp_f32 v100, v100
  v_exp_f32 v101, v101
  v_exp_f32 v102, v102
  v_exp_f32 v103, v103
  v_cvt_pk_bf16_f32 v114, v100, v101
  v_cvt_pk_bf16_f32 v115, v102, v103
  v_mfma_f32_32x32x16_bf16 v[80:95], v[124:127], a[244:247], v[80:95]
  v_exp_f32 v104, v104
  v_exp_f32 v105, v105
  v_exp_f32 v106, v106
  v_exp_f32 v107, v107
  v_cvt_pk_bf16_f32 v116, v104, v105
  v_cvt_pk_bf16_f32 v117, v106, v107
  v_mfma_f32_32x32x16_bf16 v[32:47], v[128:131], v[112:115], v[32:47]
  buffer_load_dwordx4 v[180:183], v6, s[28:31], s72 offen offset:3072 sc1
  v_exp_f32 v108, v108
  v_exp_f32 v109, v109
  v_exp_f32 v110, v110
  v_exp_f32 v111, v111
  v_cvt_pk_bf16_f32 v118, v108, v109
  v_cvt_pk_bf16_f32 v119, v110, v111
  v_mfma_f32_32x32x16_bf16 v[96:111], v[120:123], a[248:251], 0
  s_add_u32 s63, s63, 16384
  v_exp_f32 v80, v80
  v_exp_f32 v81, v81
  v_exp_f32 v82, v82
  v_exp_f32 v83, v83
  v_cvt_pk_bf16_f32 v112, v80, v81
  v_cvt_pk_bf16_f32 v113, v82, v83
  v_mfma_f32_32x32x16_bf16 v[32:47], v[132:135], v[116:119], v[32:47]
  buffer_load_dwordx4 v[236:239], v6, s[28:31], s74 offen offset:1024 sc1
  v_exp_f32 v84, v84
  v_exp_f32 v85, v85
  v_exp_f32 v86, v86
  v_exp_f32 v87, v87
  v_cvt_pk_bf16_f32 v114, v84, v85
  v_cvt_pk_bf16_f32 v115, v86, v87
  v_mfma_f32_32x32x16_bf16 v[96:111], v[124:127], a[252:255], v[96:111]
  s_and_b32 s63, s63, 262143
  s_add_u32 s72, s73, s63
  v_exp_f32 v88, v88
  v_exp_f32 v89, v89
  v_exp_f32 v90, v90
  v_exp_f32 v91, v91
  v_cvt_pk_bf16_f32 v116, v88, v89
  v_cvt_pk_bf16_f32 v117, v90, v91
  v_mfma_f32_32x32x16_bf16 v[48:63], v[128:131], v[112:115], v[48:63]
  buffer_load_dwordx4 v[240:243], v6, s[28:31], s74 offen offset:2048 sc1
  v_exp_f32 v92, v92
  v_exp_f32 v93, v93
  v_exp_f32 v94, v94
  v_exp_f32 v95, v95
  v_cvt_pk_bf16_f32 v118, v92, v93
  v_cvt_pk_bf16_f32 v119, v94, v95
  s_waitcnt vmcnt(20)
  v_mfma_f32_32x32x16_bf16 v[80:95], v[136:139], a[224:227], 0
  v_exp_f32 v96, v96
  v_exp_f32 v97, v97
  v_exp_f32 v98, v98
  v_exp_f32 v99, v99
  v_cvt_pk_bf16_f32 v112, v96, v97
  v_cvt_pk_bf16_f32 v113, v98, v99
  v_mfma_f32_32x32x16_bf16 v[48:63], v[132:135], v[116:119], v[48:63]
  buffer_load_dwordx4 v[244:247], v6, s[28:31], s74 offen offset:3072 sc1
  v_exp_f32 v100, v100
  v_exp_f32 v101, v101
  v_exp_f32 v102, v102
  v_exp_f32 v103, v103
  v_cvt_pk_bf16_f32 v114, v100, v101
  v_cvt_pk_bf16_f32 v115, v102, v103
  v_mfma_f32_32x32x16_bf16 v[80:95], v[140:143], a[228:231], v[80:95]
  v_exp_f32 v104, v104
  v_exp_f32 v105, v105
  v_exp_f32 v106, v106
  v_exp_f32 v107, v107
  v_cvt_pk_bf16_f32 v116, v104, v105
  v_cvt_pk_bf16_f32 v117, v106, v107
  v_mfma_f32_32x32x16_bf16 v[64:79], v[128:131], v[112:115], v[64:79]
  s_xor_b32 s52, s75, 0
  s_mul_i32 s52, s52, 112
  s_mul_i32 s53, s3, 28
  s_add_u32 s52, s52, s53
  s_lshl_b32 s52, s52, 10
  s_add_u32 s54, s52, 2883584
  s_xor_b32 s52, s75, 1
  s_mul_i32 s52, s52, 112
  s_mul_i32 s53, s3, 28
  s_add_u32 s52, s52, s53
  s_lshl_b32 s52, s52, 10
  s_add_u32 s55, s52, 2883584
  s_add_u32 s52, s10, 0
  s_and_b32 s52, s52, 3
  s_mul_i32 s52, s52, 7168
  s_add_u32 s52, s52, s54
  buffer_load_dwordx4 a[0:3], v6, s[28:31], s52 offen offset:0 sc1
  v_exp_f32 v108, v108
  v_exp_f32 v109, v109
  v_exp_f32 v110, v110
  v_exp_f32 v111, v111
  v_cvt_pk_bf16_f32 v118, v108, v109
  v_cvt_pk_bf16_f32 v119, v110, v111
  v_mfma_f32_32x32x16_bf16 v[96:111], v[136:139], a[232:235], 0
  buffer_load_dwordx4 a[4:7], v6, s[28:31], s52 offen offset:1024 sc1
  v_exp_f32 v80, v80
  v_exp_f32 v81, v81
  v_exp_f32 v82, v82
  v_exp_f32 v83, v83
  v_cvt_pk_bf16_f32 v112, v80, v81
  v_cvt_pk_bf16_f32 v113, v82, v83
  v_mfma_f32_32x32x16_bf16 v[64:79], v[132:135], v[116:119], v[64:79]
  v_exp_f32 v84, v84
  v_exp_f32 v85, v85
  v_exp_f32 v86, v86
  v_exp_f32 v87, v87
  v_cvt_pk_bf16_f32 v114, v84, v85
  v_cvt_pk_bf16_f32 v115, v86, v87
  v_mfma_f32_32x32x16_bf16 v[96:111], v[140:143], a[236:239], v[96:111]
  v_exp_f32 v88, v88
  v_exp_f32 v89, v89
  v_exp_f32 v90, v90
  v_exp_f32 v91, v91
  v_cvt_pk_bf16_f32 v116, v88, v89
  v_cvt_pk_bf16_f32 v117, v90, v91
  v_mfma_f32_32x32x16_bf16 v[16:31], v[144:147], v[112:115], v[16:31]
  v_exp_f32 v92, v92
  v_exp_f32 v93, v93
  v_exp_f32 v94, v94
  v_exp_f32 v95, v95
  v_cvt_pk_bf16_f32 v118, v92, v93
  v_cvt_pk_bf16_f32 v119, v94, v95
  v_mfma_f32_32x32x16_bf16 v[80:95], v[136:139], a[240:243], 0
  v_exp_f32 v96, v96
  v_exp_f32 v97, v97
  v_exp_f32 v98, v98
  v_exp_f32 v99, v99
  v_cvt_pk_bf16_f32 v112, v96, v97
  v_cvt_pk_bf16_f32 v113, v98, v99
  v_mfma_f32_32x32x16_bf16 v[16:31], v[148:151], v[116:119], v[16:31]
  v_exp_f32 v100, v100
  v_exp_f32 v101, v101
  v_exp_f32 v102, v102
  v_exp_f32 v103, v103
  v_cvt_pk_bf16_f32 v114, v100, v101
  v_cvt_pk_bf16_f32 v115, v102, v103
  v_mfma_f32_32x32x16_bf16 v[80:95], v[140:143], a[244:247], v[80:95]
  v_exp_f32 v104, v104
  v_exp_f32 v105, v105
  v_exp_f32 v106, v106
  v_exp_f32 v107, v107
  v_cvt_pk_bf16_f32 v116, v104, v105
  v_cvt_pk_bf16_f32 v117, v106, v107
  v_mfma_f32_32x32x16_bf16 v[32:47], v[144:147], v[112:115], v[32:47]
  v_exp_f32 v108, v108
  v_exp_f32 v109, v109
  v_exp_f32 v110, v110
  v_exp_f32 v111, v111
  v_cvt_pk_bf16_f32 v118, v108, v109
  v_cvt_pk_bf16_f32 v119, v110, v111
  v_mfma_f32_32x32x16_bf16 v[96:111], v[136:139], a[248:251], 0
  v_exp_f32 v80, v80
  v_exp_f32 v81, v81
  v_exp_f32 v82, v82
  v_exp_f32 v83, v83
  v_cvt_pk_bf16_f32 v112, v80, v81
  v_cvt_pk_bf16_f32 v113, v82, v83
  v_mfma_f32_32x32x16_bf16 v[32:47], v[148:151], v[116:119], v[32:47]
  buffer_load_dwordx4 a[8:11], v6, s[28:31], s52 offen offset:2048 sc1
  v_exp_f32 v84, v84
  v_exp_f32 v85, v85
  v_exp_f32 v86, v86
  v_exp_f32 v87, v87
  v_cvt_pk_bf16_f32 v114, v84, v85
  v_cvt_pk_bf16_f32 v115, v86, v87
  v_mfma_f32_32x32x16_bf16 v[96:111], v[140:143], a[252:255], v[96:111]
  v_exp_f32 v88, v88
  v_exp_f32 v89, v89
  v_exp_f32 v90, v90
  v_exp_f32 v91, v91
  v_cvt_pk_bf16_f32 v116, v88, v89
  v_cvt_pk_bf16_f32 v117, v90, v91
  v_mfma_f32_32x32x16_bf16 v[48:63], v[144:147], v[112:115], v[48:63]
  buffer_load_dwordx4 a[12:15], v6, s[28:31], s52 offen offset:3072 sc1
  v_exp_f32 v92, v92
  v_exp_f32 v93, v93
  v_exp_f32 v94, v94
  v_exp_f32 v95, v95
  v_cvt_pk_bf16_f32 v118, v92, v93
  v_cvt_pk_bf16_f32 v119, v94, v95
  s_waitcnt vmcnt(16)
  v_mfma_f32_32x32x16_bf16 v[80:95], v[152:155], a[224:227], 0
  v_exp_f32 v96, v96
  v_exp_f32 v97, v97
  v_exp_f32 v98, v98
  v_exp_f32 v99, v99
  v_cvt_pk_bf16_f32 v112, v96, v97
  v_cvt_pk_bf16_f32 v113, v98, v99
  v_mfma_f32_32x32x16_bf16 v[48:63], v[148:151], v[116:119], v[48:63]
  s_add_u32 s52, s10, 1
  s_and_b32 s52, s52, 3
  s_mul_i32 s52, s52, 7168
  s_add_u32 s52, s52, s54
  buffer_load_dwordx4 a[16:19], v6, s[28:31], s52 offen offset:0 sc1
  v_exp_f32 v100, v100
  v_exp_f32 v101, v101
  v_exp_f32 v102, v102
  v_exp_f32 v103, v103
  v_cvt_pk_bf16_f32 v114, v100, v101
  v_cvt_pk_bf16_f32 v115, v102, v103
  v_mfma_f32_32x32x16_bf16 v[80:95], v[156:159], a[228:231], v[80:95]
  v_exp_f32 v104, v104
  v_exp_f32 v105, v105
  v_exp_f32 v106, v106
  v_exp_f32 v107, v107
  v_cvt_pk_bf16_f32 v116, v104, v105
  v_cvt_pk_bf16_f32 v117, v106, v107
  v_mfma_f32_32x32x16_bf16 v[64:79], v[144:147], v[112:115], v[64:79]
  buffer_load_dwordx4 a[20:23], v6, s[28:31], s52 offen offset:1024 sc1
  v_exp_f32 v108, v108
  v_exp_f32 v109, v109
  v_exp_f32 v110, v110
  v_exp_f32 v111, v111
  v_cvt_pk_bf16_f32 v118, v108, v109
  v_cvt_pk_bf16_f32 v119, v110, v111
  v_mfma_f32_32x32x16_bf16 v[96:111], v[152:155], a[232:235], 0
  buffer_load_dwordx4 a[24:27], v6, s[28:31], s52 offen offset:2048 sc1
  v_exp_f32 v80, v80
  v_exp_f32 v81, v81
  v_exp_f32 v82, v82
  v_exp_f32 v83, v83
  v_cvt_pk_bf16_f32 v112, v80, v81
  v_cvt_pk_bf16_f32 v113, v82, v83
  v_mfma_f32_32x32x16_bf16 v[64:79], v[148:151], v[116:119], v[64:79]
  v_exp_f32 v84, v84
  v_exp_f32 v85, v85
  v_exp_f32 v86, v86
  v_exp_f32 v87, v87
  v_cvt_pk_bf16_f32 v114, v84, v85
  v_cvt_pk_bf16_f32 v115, v86, v87
  v_mfma_f32_32x32x16_bf16 v[96:111], v[156:159], a[236:239], v[96:111]
  v_exp_f32 v88, v88
  v_exp_f32 v89, v89
  v_exp_f32 v90, v90
  v_exp_f32 v91, v91
  v_cvt_pk_bf16_f32 v116, v88, v89
  v_cvt_pk_bf16_f32 v117, v90, v91
  v_mfma_f32_32x32x16_bf16 v[16:31], v[160:163], v[112:115], v[16:31]
  v_exp_f32 v92, v92
  v_exp_f32 v93, v93
  v_exp_f32 v94, v94
  v_exp_f32 v95, v95
  v_cvt_pk_bf16_f32 v118, v92, v93
  v_cvt_pk_bf16_f32 v119, v94, v95
  v_mfma_f32_32x32x16_bf16 v[80:95], v[152:155], a[240:243], 0
  v_exp_f32 v96, v96
  v_exp_f32 v97, v97
  v_exp_f32 v98, v98
  v_exp_f32 v99, v99
  v_cvt_pk_bf16_f32 v112, v96, v97
  v_cvt_pk_bf16_f32 v113, v98, v99
  v_mfma_f32_32x32x16_bf16 v[16:31], v[164:167], v[116:119], v[16:31]
  v_exp_f32 v100, v100
  v_exp_f32 v101, v101
  v_exp_f32 v102, v102
  v_exp_f32 v103, v103
  v_cvt_pk_bf16_f32 v114, v100, v101
  v_cvt_pk_bf16_f32 v115, v102, v103
  v_mfma_f32_32x32x16_bf16 v[80:95], v[156:159], a[244:247], v[80:95]
  v_exp_f32 v104, v104
  v_exp_f32 v105, v105
  v_exp_f32 v106, v106
  v_exp_f32 v107, v107
  v_cvt_pk_bf16_f32 v116, v104, v105
  v_cvt_pk_bf16_f32 v117, v106, v107
  v_mfma_f32_32x32x16_bf16 v[32:47], v[160:163], v[112:115], v[32:47]
  v_exp_f32 v108, v108
  v_exp_f32 v109, v109
  v_exp_f32 v110, v110
  v_exp_f32 v111, v111
  v_cvt_pk_bf16_f32 v118, v108, v109
  v_cvt_pk_bf16_f32 v119, v110, v111
  v_mfma_f32_32x32x16_bf16 v[96:111], v[152:155], a[248:251], 0
  v_exp_f32 v80, v80
  v_exp_f32 v81, v81
  v_exp_f32 v82, v82
  v_exp_f32 v83, v83
  v_cvt_pk_bf16_f32 v112, v80, v81
  v_cvt_pk_bf16_f32 v113, v82, v83
  v_mfma_f32_32x32x16_bf16 v[32:47], v[164:167], v[116:119], v[32:47]
  buffer_load_dwordx4 a[28:31], v6, s[28:31], s52 offen offset:3072 sc1
  v_exp_f32 v84, v84
  v_exp_f32 v85, v85
  v_exp_f32 v86, v86
  v_exp_f32 v87, v87
  v_cvt_pk_bf16_f32 v114, v84, v85
  v_cvt_pk_bf16_f32 v115, v86, v87
  v_mfma_f32_32x32x16_bf16 v[96:111], v[156:159], a[252:255], v[96:111]
  v_exp_f32 v88, v88
  v_exp_f32 v89, v89
  v_exp_f32 v90, v90
  v_exp_f32 v91, v91
  v_cvt_pk_bf16_f32 v116, v88, v89
  v_cvt_pk_bf16_f32 v117, v90, v91
  v_mfma_f32_32x32x16_bf16 v[48:63], v[160:163], v[112:115], v[48:63]
  s_add_u32 s52, s10, 0
  s_and_b32 s52, s52, 3
  s_mul_i32 s52, s52, 7168
  s_add_u32 s52, s52, s55
  buffer_load_dwordx4 a[112:115], v6, s[28:31], s52 offen offset:0 sc1
  v_exp_f32 v92, v92
  v_exp_f32 v93, v93
  v_exp_f32 v94, v94
  v_exp_f32 v95, v95
  v_cvt_pk_bf16_f32 v118, v92, v93
  v_cvt_pk_bf16_f32 v119, v94, v95
  s_waitcnt vmcnt(12)
  v_mfma_f32_32x32x16_bf16 v[80:95], v[168:171], a[224:227], 0
  v_exp_f32 v96, v96
  v_exp_f32 v97, v97
  v_exp_f32 v98, v98
  v_exp_f32 v99, v99
  v_cvt_pk_bf16_f32 v112, v96, v97
  v_cvt_pk_bf16_f32 v113, v98, v99
  v_mfma_f32_32x32x16_bf16 v[48:63], v[164:167], v[116:119], v[48:63]
  buffer_load_dwordx4 a[116:119], v6, s[28:31], s52 offen offset:1024 sc1
  v_exp_f32 v100, v100
  v_exp_f32 v101, v101
  v_exp_f32 v102, v102
  v_exp_f32 v103, v103
  v_cvt_pk_bf16_f32 v114, v100, v101
  v_cvt_pk_bf16_f32 v115, v102, v103
  v_mfma_f32_32x32x16_bf16 v[80:95], v[172:175], a[228:231], v[80:95]
  v_exp_f32 v104, v104
  v_exp_f32 v105, v105
  v_exp_f32 v106, v106
  v_exp_f32 v107, v107
  v_cvt_pk_bf16_f32 v116, v104, v105
  v_cvt_pk_bf16_f32 v117, v106, v107
  v_mfma_f32_32x32x16_bf16 v[64:79], v[160:163], v[112:115], v[64:79]
  buffer_load_dwordx4 a[120:123], v6, s[28:31], s52 offen offset:2048 sc1
  v_exp_f32 v108, v108
  v_exp_f32 v109, v109
  v_exp_f32 v110, v110
  v_exp_f32 v111, v111
  v_cvt_pk_bf16_f32 v118, v108, v109
  v_cvt_pk_bf16_f32 v119, v110, v111
  v_mfma_f32_32x32x16_bf16 v[96:111], v[168:171], a[232:235], 0
  buffer_load_dwordx4 a[124:127], v6, s[28:31], s52 offen offset:3072 sc1
  v_exp_f32 v80, v80
  v_exp_f32 v81, v81
  v_exp_f32 v82, v82
  v_exp_f32 v83, v83
  v_cvt_pk_bf16_f32 v112, v80, v81
  v_cvt_pk_bf16_f32 v113, v82, v83
  v_mfma_f32_32x32x16_bf16 v[64:79], v[164:167], v[116:119], v[64:79]
  v_exp_f32 v84, v84
  v_exp_f32 v85, v85
  v_exp_f32 v86, v86
  v_exp_f32 v87, v87
  v_cvt_pk_bf16_f32 v114, v84, v85
  v_cvt_pk_bf16_f32 v115, v86, v87
  v_mfma_f32_32x32x16_bf16 v[96:111], v[172:175], a[236:239], v[96:111]
  v_exp_f32 v88, v88
  v_exp_f32 v89, v89
  v_exp_f32 v90, v90
  v_exp_f32 v91, v91
  v_cvt_pk_bf16_f32 v116, v88, v89
  v_cvt_pk_bf16_f32 v117, v90, v91
  v_mfma_f32_32x32x16_bf16 v[16:31], v[176:179], v[112:115], v[16:31]
  v_exp_f32 v92, v92
  v_exp_f32 v93, v93
  v_exp_f32 v94, v94
  v_exp_f32 v95, v95
  v_cvt_pk_bf16_f32 v118, v92, v93
  v_cvt_pk_bf16_f32 v119, v94, v95
  v_mfma_f32_32x32x16_bf16 v[80:95], v[168:171], a[240:243], 0
  v_exp_f32 v96, v96
  v_exp_f32 v97, v97
  v_exp_f32 v98, v98
  v_exp_f32 v99, v99
  v_cvt_pk_bf16_f32 v112, v96, v97
  v_cvt_pk_bf16_f32 v113, v98, v99
  v_mfma_f32_32x32x16_bf16 v[16:31], v[180:183], v[116:119], v[16:31]
  v_exp_f32 v100, v100
  v_exp_f32 v101, v101
  v_exp_f32 v102, v102
  v_exp_f32 v103, v103
  v_cvt_pk_bf16_f32 v114, v100, v101
  v_cvt_pk_bf16_f32 v115, v102, v103
  v_mfma_f32_32x32x16_bf16 v[80:95], v[172:175], a[244:247], v[80:95]
  v_exp_f32 v104, v104
  v_exp_f32 v105, v105
  v_exp_f32 v106, v106
  v_exp_f32 v107, v107
  v_cvt_pk_bf16_f32 v116, v104, v105
  v_cvt_pk_bf16_f32 v117, v106, v107
  v_mfma_f32_32x32x16_bf16 v[32:47], v[176:179], v[112:115], v[32:47]
  v_exp_f32 v108, v108
  v_exp_f32 v109, v109
  v_exp_f32 v110, v110
  v_exp_f32 v111, v111
  v_cvt_pk_bf16_f32 v118, v108, v109
  v_cvt_pk_bf16_f32 v119, v110, v111
  v_mfma_f32_32x32x16_bf16 v[96:111], v[168:171], a[248:251], 0
  v_exp_f32 v80, v80
  v_exp_f32 v81, v81
  v_exp_f32 v82, v82
  v_exp_f32 v83, v83
  v_cvt_pk_bf16_f32 v112, v80, v81
  v_cvt_pk_bf16_f32 v113, v82, v83
  v_mfma_f32_32x32x16_bf16 v[32:47], v[180:183], v[116:119], v[32:47]
  s_add_u32 s52, s10, 1
  s_and_b32 s52, s52, 3
  s_mul_i32 s52, s52, 7168
  s_add_u32 s52, s52, s55
  buffer_load_dwordx4 a[128:131], v6, s[28:31], s52 offen offset:0 sc1
  v_exp_f32 v84, v84
  v_exp_f32 v85, v85
  v_exp_f32 v86, v86
  v_exp_f32 v87, v87
  v_cvt_pk_bf16_f32 v114, v84, v85
  v_cvt_pk_bf16_f32 v115, v86, v87
  v_mfma_f32_32x32x16_bf16 v[96:111], v[172:175], a[252:255], v[96:111]
  v_exp_f32 v88, v88
  v_exp_f32 v89, v89
  v_exp_f32 v90, v90
  v_exp_f32 v91, v91
  v_cvt_pk_bf16_f32 v116, v88, v89
  v_cvt_pk_bf16_f32 v117, v90, v91
  v_mfma_f32_32x32x16_bf16 v[48:63], v[176:179], v[112:115], v[48:63]
  buffer_load_dwordx4 a[132:135], v6, s[28:31], s52 offen offset:1024 sc1
  v_exp_f32 v92, v92
  v_exp_f32 v93, v93
  v_exp_f32 v94, v94
  v_exp_f32 v95, v95
  v_cvt_pk_bf16_f32 v118, v92, v93
  v_cvt_pk_bf16_f32 v119, v94, v95
  v_exp_f32 v96, v96
  v_exp_f32 v97, v97
  v_exp_f32 v98, v98
  v_exp_f32 v99, v99
  v_cvt_pk_bf16_f32 v112, v96, v97
  v_cvt_pk_bf16_f32 v113, v98, v99
  v_mfma_f32_32x32x16_bf16 v[48:63], v[180:183], v[116:119], v[48:63]
  buffer_load_dwordx4 a[136:139], v6, s[28:31], s52 offen offset:2048 sc1
  v_exp_f32 v100, v100
  v_exp_f32 v101, v101
  v_exp_f32 v102, v102
  v_exp_f32 v103, v103
  v_cvt_pk_bf16_f32 v114, v100, v101
  v_cvt_pk_bf16_f32 v115, v102, v103
  v_exp_f32 v104, v104
  v_exp_f32 v105, v105
  v_exp_f32 v106, v106
  v_exp_f32 v107, v107
  v_cvt_pk_bf16_f32 v116, v104, v105
  v_cvt_pk_bf16_f32 v117, v106, v107
  v_mfma_f32_32x32x16_bf16 v[64:79], v[176:179], v[112:115], v[64:79]
  buffer_load_dwordx4 a[140:143], v6, s[28:31], s52 offen offset:3072 sc1
  v_exp_f32 v108, v108
  v_exp_f32 v109, v109
  v_exp_f32 v110, v110
  v_exp_f32 v111, v111
  v_cvt_pk_bf16_f32 v118, v108, v109
  v_cvt_pk_bf16_f32 v119, v110, v111
  s_nop 1
  v_mfma_f32_32x32x16_bf16 v[64:79], v[180:183], v[116:119], v[64:79]
  s_mov_b32 s32, s4
  s_and_b32 s33, s5, 0xffff
  s_mov_b32 s34, 1835008
  s_mov_b32 s35, 0x20000
  s_lshl_b32 s44, s76, 5
  v_add_u32 v5, s44, v3
  v_mul_u32_u24 v7, 896, v5
  v_lshl_add_u32 v7, v4, 3, v7
  s_lshl_b32 s44, s75, 6
  v_add_u32 v7, s44, v7
  buffer_load_dwordx2 v[248:249], v7, s[32:35], 0 offen offset:0
  buffer_load_dwordx2 v[250:251], v7, s[32:35], 0 offen offset:16
  buffer_load_dwordx2 v[252:253], v7, s[32:35], 0 offen offset:32
  buffer_load_dwordx2 v[254:255], v7, s[32:35], 0 offen offset:48
  s_nop 7
  s_xor_b32 s44, s3, 1
  s_mul_i32 s44, s44, 3
  s_add_u32 s44, s44, 0
  s_lshl_b32 s44, s44, 12
  v_add_u32 v7, s44, v6
  ds_write_b128 v7, v[32:35] offset:0
  ds_write_b128 v7, v[36:39] offset:1024
  ds_write_b128 v7, v[40:43] offset:2048
  ds_write_b128 v7, v[44:47] offset:3072
  s_xor_b32 s44, s3, 2
  s_mul_i32 s44, s44, 3
  s_add_u32 s44, s44, 1
  s_lshl_b32 s44, s44, 12
  v_add_u32 v7, s44, v6
  ds_write_b128 v7, v[48:51] offset:0
  ds_write_b128 v7, v[52:55] offset:1024
  ds_write_b128 v7, v[56:59] offset:2048
  ds_write_b128 v7, v[60:63] offset:3072
  s_xor_b32 s44, s3, 3
  s_mul_i32 s44, s44, 3
  s_add_u32 s44, s44, 2
  s_lshl_b32 s44, s44, 12
  v_add_u32 v7, s44, v6
  ds_write_b128 v7, v[64:67] offset:0
  ds_write_b128 v7, v[68:71] offset:1024
  ds_write_b128 v7, v[72:75] offset:2048
  ds_write_b128 v7, v[76:79] offset:3072
  s_waitcnt lgkmcnt(0)
  s_barrier
  s_mul_i32 s44, s3, 12288
  v_add_u32 v7, s44, v6
  ds_read_b128 v[32:35], v7 offset:0
  ds_read_b128 v[36:39], v7 offset:1024
  ds_read_b128 v[40:43], v7 offset:2048
  ds_read_b128 v[44:47], v7 offset:3072
  ds_read_b128 v[48:51], v7 offset:4096
  ds_read_b128 v[52:55], v7 offset:5120
  ds_read_b128 v[56:59], v7 offset:6144
  ds_read_b128 v[60:63], v7 offset:7168
  ds_read_b128 v[64:67], v7 offset:8192
  ds_read_b128 v[68:71], v7 offset:9216
  ds_read_b128 v[72:75], v7 offset:10240
  ds_read_b128 v[76:79], v7 offset:11264
  s_waitcnt lgkmcnt(8)
  v_add_f32 v16, v16, v32
  v_add_f32 v17, v17, v33
  v_add_f32 v18, v18, v34
  v_add_f32 v19, v19, v35
  v_add_f32 v20, v20, v36
  v_add_f32 v21, v21, v37
  v_add_f32 v22, v22, v38
  v_add_f32 v23, v23, v39
  v_add_f32 v24, v24, v40
  v_add_f32 v25, v25, v41
  v_add_f32 v26, v26, v42
  v_add_f32 v27, v27, v43
  v_add_f32 v28, v28, v44
  v_add_f32 v29, v29, v45
  v_add_f32 v30, v30, v46
  v_add_f32 v31, v31, v47
  s_waitcnt lgkmcnt(4)
  v_add_f32 v16, v16, v48
  v_add_f32 v17, v17, v49
  v_add_f32 v18, v18, v50
  v_add_f32 v19, v19, v51
  v_add_f32 v20, v20, v52
  v_add_f32 v21, v21, v53
  v_add_f32 v22, v22, v54
  v_add_f32 v23, v23, v55
  v_add_f32 v24, v24, v56
  v_add_f32 v25, v25, v57
  v_add_f32 v26, v26, v58
  v_add_f32 v27, v27, v59
  v_add_f32 v28, v28, v60
  v_add_f32 v29, v29, v61
  v_add_f32 v30, v30, v62
  v_add_f32 v31, v31, v63
  s_waitcnt lgkmcnt(0)
  v_add_f32 v16, v16, v64
  v_add_f32 v17, v17, v65
  v_add_f32 v18, v18, v66
  v_add_f32 v19, v19, v67
  v_add_f32 v20, v20, v68
  v_add_f32 v21, v21, v69
  v_add_f32 v22, v22, v70
  v_add_f32 v23, v23, v71
  v_add_f32 v24, v24, v72
  v_add_f32 v25, v25, v73
  v_add_f32 v26, v26, v74
  v_add_f32 v27, v27, v75
  v_add_f32 v28, v28, v76
  v_add_f32 v29, v29, v77
  v_add_f32 v30, v30, v78
  v_add_f32 v31, v31, v79
  v_mov_b32 v8, v28
  v_mov_b32 v9, v28
  s_nop 1
  v_permlane32_swap_b32 v8, v9
  s_nop 1
  v_cmp_le_f32 vcc, 0x17800000, v9
  v_mov_b32 v10, 0x67800000
  v_cmp_ge_f32 s[44:45], v10, v9
  s_and_b64 vcc, vcc, s[44:45]
  s_cmp_eq_u64 vcc, -1
  s_cbranch_scc1 L_att_27_ok
  s_lshl_b32 s44, s66, 18
  s_add_u32 s72, s44, 7733248
  v_mov_b32 v16, 0
  v_mov_b32 v17, 0
  v_mov_b32 v18, 0
  v_mov_b32 v19, 0
  v_mov_b32 v20, 0
  v_mov_b32 v21, 0
  v_mov_b32 v22, 0
  v_mov_b32 v23, 0
  v_mov_b32 v24, 0
  v_mov_b32 v25, 0
  v_mov_b32 v26, 0
  v_mov_b32 v27, 0
  v_mov_b32 v28, 0
  v_mov_b32 v29, 0
  v_mov_b32 v30, 0
  v_mov_b32 v31, 0
  v_mov_b32 v10, 0xff800000
  s_mov_b32 s51, 64
L_att_27_slow:
  buffer_load_dwordx4 v[120:123], v6, s[28:31], s72 offen offset:0 sc1
  buffer_load_dwordx4 v[124:127], v6, s[28:31], s72 offen offset:1024 sc1
  buffer_load_dwordx4 v[128:131], v6, s[28:31], s72 offen offset:2048 sc1
  buffer_load_dwordx4 v[132:135], v6, s[28:31], s72 offen offset:3072 sc1
  s_add_u32 s72, s72, 4096
  s_waitcnt vmcnt(0)
  v_mfma_f32_32x32x16_bf16 v[80:95], v[120:123], a[224:227], 0
  v_mfma_f32_32x32x16_bf16 v[80:95], v[124:127], a[228:231], v[80:95]
  s_nop 12
  v_max3_f32 v11, v80, v81, v82
  v_max3_f32 v11, v11, v83, v84
  v_max3_f32 v11, v11, v85, v86
  v_max3_f32 v11, v11, v87, v88
  v_max3_f32 v11, v11, v89, v90
  v_max3_f32 v11, v11, v91, v92
  v_max3_f32 v11, v11, v93, v94
  v_max_f32 v11, v11, v95
  v_mov_b32 v12, v11
  s_nop 1
  v_permlane32_swap_b32 v11, v12
  s_nop 1
  v_max3_f32 v11, v11, v12, v10
  v_sub_f32 v12, v10, v11
  v_exp_f32 v12, v12
  v_mov_b32 v10, v11
  v_mul_f32 v16, v16, v12
  v_mul_f32 v17, v17, v12
  v_mul_f32 v18, v18, v12
  v_mul_f32 v19, v19, v12
  v_mul_f32 v20, v20, v12
  v_mul_f32 v21, v21, v12
  v_mul_f32 v22, v22, v12
  v_mul_f32 v23, v23, v12
  v_mul_f32 v24, v24, v12
  v_mul_f32 v25, v25, v12
  v_mul_f32 v26, v26, v12
  v_mul_f32 v27, v27, v12
  v_mul_f32 v28, v28, v12
  v_mul_f32 v29, v29, v12
  v_mul_f32 v30, v30, v12
  v_mul_f32 v31, v31, v12
  v_sub_f32 v80, v80, v10
  v_sub_f32 v81, v81, v10
  v_sub_f32 v82, v82, v10
  v_sub_f32 v83, v83, v10
  v_sub_f32 v84, v84, v10
  v_sub_f32 v85, v85, v10
  v_sub_f32 v86, v86, v10
  v_sub_f32 v87, v87, v10
  v_sub_f32 v88, v88, v10
  v_sub_f32 v89, v89, v10
  v_sub_f32 v90, v90, v10
  v_sub_f32 v91, v91, v10
  v_sub_f32 v92, v92, v10
  v_sub_f32 v93, v93, v10
  v_sub_f32 v94, v94, v10
  v_sub_f32 v95, v95, v10
  v_exp_f32 v80, v80
  v_exp_f32 v81, v81
  v_exp_f32 v82, v82
  v_exp_f32 v83, v83
  v_exp_f32 v84, v84
  v_exp_f32 v85, v85
  v_exp_f32 v86, v86
  v_exp_f32 v87, v87
  v_exp_f32 v88, v88
  v_exp_f32 v89, v89
  v_exp_f32 v90, v90
  v_exp_f32 v91, v91
  v_exp_f32 v92, v92
  v_exp_f32 v93, v93
  v_exp_f32 v94, v94
  v_exp_f32 v95, v95
  s_nop 0
  v_cvt_pk_bf16_f32 v112, v80, v81
  v_cvt_pk_bf16_f32 v113, v82, v83
  v_cvt_pk_bf16_f32 v114, v84, v85
  v_cvt_pk_bf16_f32 v115, v86, v87
  v_cvt_pk_bf16_f32 v116, v88, v89
  v_cvt_pk_bf16_f32 v117, v90, v91
  v_cvt_pk_bf16_f32 v118, v92, v93
  v_cvt_pk_bf16_f32 v119, v94, v95
  s_nop 1
  v_mfma_f32_32x32x16_bf16 v[16:31], v[128:131], v[112:115], v[16:31]
  v_mfma_f32_32x32x16_bf16 v[16:31], v[132:135], v[116:119], v[16:31]
  s_nop 12
  s_sub_u32 s51, s51, 1
  s_cmp_lg_u32 s51, 0
  s_cbranch_scc1 L_att_27_slow
  v_mov_b32 v8, v28
  v_mov_b32 v9, v28
  s_nop 1
  v_permlane32_swap_b32 v8, v9
  s_nop 1
L_att_27_ok:
  v_rcp_f32 v9, v9
  s_nop 0
  v_mul_f32 v16, v16, v9
  v_mul_f32 v17, v17, v9
  v_mul_f32 v18, v18, v9
  v_mul_f32 v19, v19, v9
  v_mul_f32 v20, v20, v9
  v_mul_f32 v21, v21, v9
  v_mul_f32 v22, v22, v9
  v_mul_f32 v23, v23, v9
  v_mul_f32 v24, v24, v9
  v_mul_f32 v25, v25, v9
  v_mul_f32 v26, v26, v9
  v_mul_f32 v27, v27, v9
  v_mul_f32 v28, v28, v9
  v_mul_f32 v29, v29, v9
  v_mul_f32 v30, v30, v9
  v_mul_f32 v31, v31, v9
  v_cvt_pk_bf16_f32 v112, v16, v17
  v_cvt_pk_bf16_f32 v113, v18, v19
  v_cvt_pk_bf16_f32 v114, v20, v21
  v_cvt_pk_bf16_f32 v115, v22, v23
  v_cvt_pk_bf16_f32 v116, v24, v25
  v_cvt_pk_bf16_f32 v117, v26, v27
  v_cvt_pk_bf16_f32 v118, v28, v29
  v_cvt_pk_bf16_f32 v119, v30, v31
  s_lshl_b32 s44, s65, 2
  s_add_u32 s44, s44, s3
  s_lshl_b32 s44, s44, 5
  s_lshl_b32 s45, s66, 1
  s_add_u32 s44, s44, s45
  s_lshl_b32 s44, s44, 10
  s_add_u32 s44, s44, 14024704
  buffer_store_dwordx4 v[112:115], v6, s[28:31], s44 offen sc1
  buffer_store_dwordx4 v[116:119], v6, s[28:31], s44 offen offset:1024 sc1
  s_barrier
  s_cmp_ge_u32 s2, 224
  s_cbranch_scc1 L_nop4_34
  s_lshl_b32 s44, s68, 6
  s_add_u32 s44, s44, 896
  v_and_b32 v8, 63, v0
  v_add_u32 v8, s44, v8
  v_lshlrev_b32 v8, 3, v8
  s_mov_b32 s18, 25427968
  s_mov_b32 s19, 25449472
  s_mov_b32 s20, 25470976
  s_mov_b32 s21, 25492480
  s_mov_b32 s71, 0
L_ga_35:
  buffer_load_dwordx2 v[120:121], v8, s[28:31], s18 offen sc1
  buffer_load_dwordx2 v[122:123], v8, s[28:31], s19 offen sc1
  buffer_load_dwordx2 v[124:125], v8, s[28:31], s20 offen sc1
  buffer_load_dwordx2 v[126:127], v8, s[28:31], s21 offen sc1
  s_waitcnt vmcnt(0)
  v_cmp_ne_u32 vcc, s64, v121
  v_cmp_ne_u32 s[56:57], s64, v123
  s_or_b64 vcc, vcc, s[56:57]
  v_cmp_ne_u32 s[56:57], s64, v125
  s_or_b64 vcc, vcc, s[56:57]
  v_cmp_ne_u32 s[56:57], s64, v127
  s_or_b64 vcc, vcc, s[56:57]
  s_add_u32 s71, s71, 1
  s_cmp_gt_u32 s71, 400000
  s_cbranch_scc1 L_gad_36
  s_cbranch_vccnz L_ga_35
L_gad_36:
  v_add_f32 v120, v120, v122
  v_add_f32 v124, v124, v126
  v_add_f32 v9, v120, v124
  v_cvt_pk_bf16_f32 v9, v9, v9
  v_lshlrev_b32 v9, 16, v9
  v_and_b32 v8, 63, v0
  v_lshlrev_b32 v8, 2, v8
  v_add_u32 v8, 30720, v8
  ds_write_b32 v8, v9
  s_and_b32 s44, s3, 1
  s_lshl_b32 s44, s44, 7
  v_lshlrev_b32 v8, 4, v4
  v_add_u32 v8, s44, v8
  v_add_u32 v8, 30720, v8
  s_waitcnt lgkmcnt(0)
  ds_read_b128 v[80:83], v8 offset:0
  ds_read_b128 v[84:87], v8 offset:32
  ds_read_b128 v[88:91], v8 offset:64
  ds_read_b128 v[92:95], v8 offset:96
  s_waitcnt lgkmcnt(0)
  s_lshl_b32 s45, s3, 3
  s_xor_b32 s44, s76, 0
  s_lshl_b32 s44, s44, 5
  s_add_u32 s44, s44, s45
  s_lshl_b32 s44, s44, 10
  s_add_u32 s50, s44, 14024704
  s_add_u32 s51, s50, 4096
  s_xor_b32 s44, s76, 1
  s_lshl_b32 s44, s44, 5
  s_add_u32 s44, s44, s45
  s_lshl_b32 s44, s44, 10
  s_add_u32 s52, s44, 14024704
  s_add_u32 s53, s52, 4096
  v_and_b32 v8, 3, v1
  v_lshlrev_b32 v8, 11, v8
  v_add_u32 v8, 2044, v8
  v_mov_b32 v9, s50
  v_mov_b32 v11, s52
  v_and_b32 v12, 4, v1
  v_cmp_eq_u32 vcc, 0, v12
  s_nop 1
  v_cndmask_b32 v9, v11, v9, vcc
  v_add_u32 v8, v8, v9
  s_mov_b32 s71, 0
L_p4re_37:
L_p4pr_38:
  buffer_load_dword v9, v8, s[28:31], 0 offen sc1
  s_waitcnt vmcnt(0)
  v_cmp_eq_u32 vcc, -1, v9
  s_add_u32 s71, s71, 1
  s_cmp_gt_u32 s71, 400000
  s_cbranch_scc1 L_p4go_39
  s_cbranch_vccnz L_p4pr_38
L_p4go_39:
  buffer_load_dwordx4 v[120:123], v6, s[28:31], s50 offen offset:0 sc1
  buffer_load_dwordx4 v[152:155], v6, s[28:31], s52 offen offset:0 sc1
  buffer_load_dwordx4 v[124:127], v6, s[28:31], s50 offen offset:1024 sc1
  buffer_load_dwordx4 v[156:159], v6, s[28:31], s52 offen offset:1024 sc1
  buffer_load_dwordx4 v[128:131], v6, s[28:31], s50 offen offset:2048 sc1
  buffer_load_dwordx4 v[160:163], v6, s[28:31], s52 offen offset:2048 sc1
  buffer_load_dwordx4 v[132:135], v6, s[28:31], s50 offen offset:3072 sc1
  buffer_load_dwordx4 v[164:167], v6, s[28:31], s52 offen offset:3072 sc1
  buffer_load_dwordx4 v[136:139], v6, s[28:31], s51 offen offset:0 sc1
  buffer_load_dwordx4 v[168:171], v6, s[28:31], s53 offen offset:0 sc1
  buffer_load_dwordx4 v[140:143], v6, s[28:31], s51 offen offset:1024 sc1
  buffer_load_dwordx4 v[172:175], v6, s[28:31], s53 offen offset:1024 sc1
  buffer_load_dwordx4 v[144:147], v6, s[28:31], s51 offen offset:2048 sc1
  buffer_load_dwordx4 v[176:179], v6, s[28:31], s53 offen offset:2048 sc1
  buffer_load_dwordx4 v[148:151], v6, s[28:31], s51 offen offset:3072 sc1
  buffer_load_dwordx4 v[180:183], v6, s[28:31], s53 offen offset:3072 sc1
  v_mov_b32 v10, 0
  s_waitcnt vmcnt(14)
  v_mfma_f32_32x32x16_bf16 v[16:31], v[184:187], v[120:123], 0
  v_max3_u32 v10, v10, v120, v121
  v_max3_u32 v10, v10, v122, v123
  v_mfma_f32_32x32x16_bf16 v[48:63], v[184:187], v[152:155], 0
  v_max3_u32 v10, v10, v152, v153
  v_max3_u32 v10, v10, v154, v155
  v_mfma_f32_32x32x16_bf16 v[32:47], v[216:219], v[120:123], 0
  v_mfma_f32_32x32x16_bf16 v[64:79], v[216:219], v[152:155], 0
  s_waitcnt vmcnt(12)
  v_mfma_f32_32x32x16_bf16 v[16:31], v[188:191], v[124:127], v[16:31]
  v_max3_u32 v10, v10, v124, v125
  v_max3_u32 v10, v10, v126, v127
  v_mfma_f32_32x32x16_bf16 v[48:63], v[188:191], v[156:159], v[48:63]
  v_max3_u32 v10, v10, v156, v157
  v_max3_u32 v10, v10, v158, v159
  v_mfma_f32_32x32x16_bf16 v[32:47], v[220:223], v[124:127], v[32:47]
  v_mfma_f32_32x32x16_bf16 v[64:79], v[220:223], v[156:159], v[64:79]
  s_waitcnt vmcnt(10)
  v_mfma_f32_32x32x16_bf16 v[16:31], v[192:195], v[128:131], v[16:31]
  v_max3_u32 v10, v10, v128, v129
  v_max3_u32 v10, v10, v130, v131
  v_mfma_f32_32x32x16_bf16 v[48:63], v[192:195], v[160:163], v[48:63]
  v_max3_u32 v10, v10, v160, v161
  v_max3_u32 v10, v10, v162, v163
  v_mfma_f32_32x32x16_bf16 v[32:47], v[224:227], v[128:131], v[32:47]
  v_mfma_f32_32x32x16_bf16 v[64:79], v[224:227], v[160:163], v[64:79]
  s_waitcnt vmcnt(8)
  v_mfma_f32_32x32x16_bf16 v[16:31], v[196:199], v[132:135], v[16:31]
  v_max3_u32 v10, v10, v132, v133
  v_max3_u32 v10, v10, v134, v135
  v_mfma_f32_32x32x16_bf16 v[48:63], v[196:199], v[164:167], v[48:63]
  v_max3_u32 v10, v10, v164, v165
  v_max3_u32 v10, v10, v166, v167
  v_mfma_f32_32x32x16_bf16 v[32:47], v[228:231], v[132:135], v[32:47]
  v_mfma_f32_32x32x16_bf16 v[64:79], v[228:231], v[164:167], v[64:79]
  s_waitcnt vmcnt(6)
  v_mfma_f32_32x32x16_bf16 v[16:31], v[200:203], v[136:139], v[16:31]
  v_max3_u32 v10, v10, v136, v137
  v_max3_u32 v10, v10, v138, v139
  v_mfma_f32_32x32x16_bf16 v[48:63], v[200:203], v[168:171], v[48:63]
  v_max3_u32 v10, v10, v168, v169
  v_max3_u32 v10, v10, v170, v171
  v_mfma_f32_32x32x16_bf16 v[32:47], v[232:235], v[136:139], v[32:47]
  v_mfma_f32_32x32x16_bf16 v[64:79], v[232:235], v[168:171], v[64:79]
  s_waitcnt vmcnt(4)
  v_mfma_f32_32x32x16_bf16 v[16:31], v[204:207], v[140:143], v[16:31]
  v_max3_u32 v10, v10, v140, v141
  v_max3_u32 v10, v10, v142, v143
  v_mfma_f32_32x32x16_bf16 v[48:63], v[204:207], v[172:175], v[48:63]
  v_max3_u32 v10, v10, v172, v173
  v_max3_u32 v10, v10, v174, v175
  v_mfma_f32_32x32x16_bf16 v[32:47], v[236:239], v[140:143], v[32:47]
  v_mfma_f32_32x32x16_bf16 v[64:79], v[236:239], v[172:175], v[64:79]
  s_waitcnt vmcnt(2)
  v_mfma_f32_32x32x16_bf16 v[16:31], v[208:211], v[144:147], v[16:31]
  v_max3_u32 v10, v10, v144, v145
  v_max3_u32 v10, v10, v146, v147
  v_mfma_f32_32x32x16_bf16 v[48:63], v[208:211], v[176:179], v[48:63]
  v_max3_u32 v10, v10, v176, v177
  v_max3_u32 v10, v10, v178, v179
  v_mfma_f32_32x32x16_bf16 v[32:47], v[240:243], v[144:147], v[32:47]
  v_mfma_f32_32x32x16_bf16 v[64:79], v[240:243], v[176:179], v[64:79]
  s_waitcnt vmcnt(0)
  v_mfma_f32_32x32x16_bf16 v[16:31], v[212:215], v[148:151], v[16:31]
  v_max3_u32 v10, v10, v148, v149
  v_max3_u32 v10, v10, v150, v151
  v_mfma_f32_32x32x16_bf16 v[48:63], v[212:215], v[180:183], v[48:63]
  v_max3_u32 v10, v10, v180, v181
  v_max3_u32 v10, v10, v182, v183
  v_mfma_f32_32x32x16_bf16 v[32:47], v[244:247], v[148:151], v[32:47]
  v_mfma_f32_32x32x16_bf16 v[64:79], v[244:247], v[180:183], v[64:79]
  v_cmp_eq_u32 vcc, -1, v10
  s_cmp_gt_u32 s71, 400000
  s_cbranch_scc1 L_p4ok_40
  s_cbranch_vccnz L_p4re_37
L_p4ok_40:
  s_nop 11
  s_xor_b32 s44, s3, 1
  s_mul_i32 s44, s44, 3
  s_add_u32 s44, s44, 0
  s_lshl_b32 s44, s44, 12
  v_add_u32 v9, s44, v6
  ds_write_b128 v9, v[32:35] offset:0
  ds_write_b128 v9, v[36:39] offset:1024
  ds_write_b128 v9, v[40:43] offset:2048
  ds_write_b128 v9, v[44:47] offset:3072
  s_xor_b32 s44, s3, 2
  s_mul_i32 s44, s44, 3
  s_add_u32 s44, s44, 1
  s_lshl_b32 s44, s44, 12
  v_add_u32 v9, s44, v6
  ds_write_b128 v9, v[48:51] offset:0
  ds_write_b128 v9, v[52:55] offset:1024
  ds_write_b128 v9, v[56:59] offset:2048
  ds_write_b128 v9, v[60:63] offset:3072
  s_xor_b32 s44, s3, 3
  s_mul_i32 s44, s44, 3
  s_add_u32 s44, s44, 2
  s_lshl_b32 s44, s44, 12
  v_add_u32 v9, s44, v6
  ds_write_b128 v9, v[64:67] offset:0
  ds_write_b128 v9, v[68:71] offset:1024
  ds_write_b128 v9, v[72:75] offset:2048
  ds_write_b128 v9, v[76:79] offset:3072
  s_waitcnt lgkmcnt(0)
  s_barrier
  s_mul_i32 s44, s3, 12288
  v_add_u32 v9, s44, v6
  ds_read_b128 v[32:35], v9 offset:0
  ds_read_b128 v[36:39], v9 offset:1024
  ds_read_b128 v[40:43], v9 offset:2048
  ds_read_b128 v[44:47], v9 offset:3072
  ds_read_b128 v[48:51], v9 offset:4096
  ds_read_b128 v[52:55], v9 offset:5120
  ds_read_b128 v[56:59], v9 offset:6144
  ds_read_b128 v[60:63], v9 offset:7168
  ds_read_b128 v[64:67], v9 offset:8192
  ds_read_b128 v[68:71], v9 offset:9216
  ds_read_b128 v[72:75], v9 offset:10240
  ds_read_b128 v[76:79], v9 offset:11264
  s_waitcnt lgkmcnt(8)
  v_add_f32 v16, v16, v32
  v_add_f32 v17, v17, v33
  v_add_f32 v18, v18, v34
  v_add_f32 v19, v19, v35
  v_add_f32 v20, v20, v36
  v_add_f32 v21, v21, v37
  v_add_f32 v22, v22, v38
  v_add_f32 v23, v23, v39
  v_add_f32 v24, v24, v40
  v_add_f32 v25, v25, v41
  v_add_f32 v26, v26, v42
  v_add_f32 v27, v27, v43
  v_add_f32 v28, v28, v44
  v_add_f32 v29, v29, v45
  v_add_f32 v30, v30, v46
  v_add_f32 v31, v31, v47
  s_waitcnt lgkmcnt(4)
  v_add_f32 v16, v16, v48
  v_add_f32 v17, v17, v49
  v_add_f32 v18, v18, v50
  v_add_f32 v19, v19, v51
  v_add_f32 v20, v20, v52
  v_add_f32 v21, v21, v53
  v_add_f32 v22, v22, v54
  v_add_f32 v23, v23, v55
  v_add_f32 v24, v24, v56
  v_add_f32 v25, v25, v57
  v_add_f32 v26, v26, v58
  v_add_f32 v27, v27, v59
  v_add_f32 v28, v28, v60
  v_add_f32 v29, v29, v61
  v_add_f32 v30, v30, v62
  v_add_f32 v31, v31, v63
  s_waitcnt lgkmcnt(0)
  v_add_f32 v16, v16, v64
  v_add_f32 v17, v17, v65
  v_add_f32 v18, v18, v66
  v_add_f32 v19, v19, v67
  v_add_f32 v20, v20, v68
  v_add_f32 v21, v21, v69
  v_add_f32 v22, v22, v70
  v_add_f32 v23, v23, v71
  v_add_f32 v24, v24, v72
  v_add_f32 v25, v25, v73
  v_add_f32 v26, v26, v74
  v_add_f32 v27, v27, v75
  v_add_f32 v28, v28, v76
  v_add_f32 v29, v29, v77
  v_add_f32 v30, v30, v78
  v_add_f32 v31, v31, v79
  s_mov_b32 s55, 0xffff0000
  v_lshlrev_b32 v10, 16, v248
  v_and_b32 v11, s55, v248
  v_fma_f32 v16, v16, v80, v10
  v_fma_f32 v17, v17, v81, v11
  v_lshlrev_b32 v10, 16, v249
  v_and_b32 v11, s55, v249
  v_fma_f32 v18, v18, v82, v10
  v_fma_f32 v19, v19, v83, v11
  v_lshlrev_b32 v10, 16, v250
  v_and_b32 v11, s55, v250
  v_fma_f32 v20, v20, v84, v10
  v_fma_f32 v21, v21, v85, v11
  v_lshlrev_b32 v10, 16, v251
  v_and_b32 v11, s55, v251
  v_fma_f32 v22, v22, v86, v10
  v_fma_f32 v23, v23, v87, v11
  v_lshlrev_b32 v10, 16, v252
  v_and_b32 v11, s55, v252
  v_fma_f32 v24, v24, v88, v10
  v_fma_f32 v25, v25, v89, v11
  v_lshlrev_b32 v10, 16, v253
  v_and_b32 v11, s55, v253
  v_fma_f32 v26, v26, v90, v10
  v_fma_f32 v27, v27, v91, v11
  v_lshlrev_b32 v10, 16, v254
  v_and_b32 v11, s55, v254
  v_fma_f32 v28, v28, v92, v10
  v_fma_f32 v29, v29, v93, v11
  v_lshlrev_b32 v10, 16, v255
  v_and_b32 v11, s55, v255
  v_fma_f32 v30, v30, v94, v10
  v_fma_f32 v31, v31, v95, v11
  v_cvt_pk_bf16_f32 v248, v16, v17
  v_cvt_pk_bf16_f32 v249, v18, v19
  v_cvt_pk_bf16_f32 v250, v20, v21
  v_cvt_pk_bf16_f32 v251, v22, v23
  v_cvt_pk_bf16_f32 v252, v24, v25
  v_cvt_pk_bf16_f32 v253, v26, v27
  v_cvt_pk_bf16_f32 v254, v28, v29
  v_cvt_pk_bf16_f32 v255, v30, v31
  s_mul_i32 s44, s76, 28
  s_lshl_b32 s45, s75, 1
  s_add_u32 s44, s44, s45
  s_lshl_b32 s44, s44, 10
  s_add_u32 s44, s44, 16121856
  buffer_store_dwordx4 v[248:251], v6, s[28:31], s44 offen sc1
  buffer_store_dwordx4 v[252:255], v6, s[28:31], s44 offen offset:1024 sc1
  v_lshlrev_b32 v16, 16, v248
  v_and_b32 v17, s55, v248
  v_lshlrev_b32 v18, 16, v249
  v_and_b32 v19, s55, v249
  v_lshlrev_b32 v20, 16, v250
  v_and_b32 v21, s55, v250
  v_lshlrev_b32 v22, 16, v251
  v_and_b32 v23, s55, v251
  v_lshlrev_b32 v24, 16, v252
  v_and_b32 v25, s55, v252
  v_lshlrev_b32 v26, 16, v253
  v_and_b32 v27, s55, v253
  v_lshlrev_b32 v28, 16, v254
  v_and_b32 v29, s55, v254
  v_lshlrev_b32 v30, 16, v255
  v_and_b32 v31, s55, v255
  v_add_f32 v10, v16, v17
  v_add_f32 v11, v18, v19
  v_add_f32 v10, v10, v20
  v_add_f32 v11, v11, v21
  v_add_f32 v10, v10, v22
  v_add_f32 v11, v11, v23
  v_add_f32 v10, v10, v24
  v_add_f32 v11, v11, v25
  v_add_f32 v10, v10, v26
  v_add_f32 v11, v11, v27
  v_add_f32 v10, v10, v28
  v_add_f32 v11, v11, v29
  v_add_f32 v10, v10, v30
  v_add_f32 v11, v11, v31
  v_add_f32 v10, v10, v11
  v_mov_b32 v11, v10
  s_nop 1
  v_permlane32_swap_b32 v10, v11
  s_nop 1
  v_add_f32 v10, v10, v11
  v_mul_f32 v10, 0x3d000000, v10
  v_mov_b32 v11, 0
  v_mov_b32 v13, 0
  v_sub_f32 v12, v16, v10
  v_sub_f32 v14, v17, v10
  v_fmac_f32 v11, v12, v12
  v_fmac_f32 v13, v14, v14
  v_sub_f32 v12, v18, v10
  v_sub_f32 v14, v19, v10
  v_fmac_f32 v11, v12, v12
  v_fmac_f32 v13, v14, v14
  v_sub_f32 v12, v20, v10
  v_sub_f32 v14, v21, v10
  v_fmac_f32 v11, v12, v12
  v_fmac_f32 v13, v14, v14
  v_sub_f32 v12, v22, v10
  v_sub_f32 v14, v23, v10
  v_fmac_f32 v11, v12, v12
  v_fmac_f32 v13, v14, v14
  v_sub_f32 v12, v24, v10
  v_sub_f32 v14, v25, v10
  v_fmac_f32 v11, v12, v12
  v_fmac_f32 v13, v14, v14
  v_sub_f32 v12, v26, v10
  v_sub_f32 v14, v27, v10
  v_fmac_f32 v11, v12, v12
  v_fmac_f32 v13, v14, v14
  v_sub_f32 v12, v28, v10
  v_sub_f32 v14, v29, v10
  v_fmac_f32 v11, v12, v12
  v_fmac_f32 v13, v14, v14
  v_sub_f32 v12, v30, v10
  v_sub_f32 v14, v31, v10
  v_fmac_f32 v11, v12, v12
  v_fmac_f32 v13, v14, v14
  v_add_f32 v11, v11, v13
  v_mov_b32 v12, v11
  s_nop 1
  v_permlane32_swap_b32 v11, v12
  s_nop 1
  v_add_f32 v11, v11, v12
  s_mul_i32 s44, s76, 14
  s_add_u32 s44, s44, s75
  s_lshl_b32 s44, s44, 8
  s_add_u32 s44, s44, 65536
  v_lshlrev_b32 v12, 3, v3
  v_mov_b32 v13, 2147483632
  v_cmp_eq_u32 vcc, 0, v4
  s_nop 1
  v_cndmask_b32 v12, v13, v12, vcc
  buffer_store_dwordx2 v[10:11], v12, s[28:31], s44 offen sc1
  s_barrier
L_nop4_34:
  s_mul_i32 s74, s3, 7168
  s_add_u32 m0, s74, 0
  s_add_u32 s74, s74, s78
  s_add_u32 s74, s74, 114688
  buffer_load_dwordx4 v6, s[28:31], s74 offen offset:0 sc1 lds
  buffer_load_dwordx4 v6, s[28:31], s74 offen offset:1024 sc1 lds
  buffer_load_dwordx4 v6, s[28:31], s74 offen offset:2048 sc1 lds
  buffer_load_dwordx4 v6, s[28:31], s74 offen offset:3072 sc1 lds
  s_add_u32 m0, m0, 4096
  s_add_u32 s74, s74, 4096
  buffer_load_dwordx4 v6, s[28:31], s74 offen offset:0 sc1 lds
  buffer_load_dwordx4 v6, s[28:31], s74 offen offset:1024 sc1 lds
  buffer_load_dwordx4 v6, s[28:31], s74 offen offset:2048 sc1 lds
  s_mul_i32 s44, s70, 7168
  s_add_u32 s44, s44, 25296896
  v_lshrrev_b32 v8, 6, v0
  v_lshlrev_b32 v8, 10, v8
  v_and_b32 v9, 63, v0
  v_lshl_add_u32 v8, v9, 2, v8
  v_mov_b32 v10, 2147483632
  v_add_u32 v11, 4096, v8
  v_cmp_gt_u32 vcc, 192, v0
  s_nop 1
  v_cndmask_b32 v11, v10, v11, vcc
  buffer_load_dword v16, v8, s[28:31], s44 offen offset:0 sc1
  buffer_load_dword v20, v11, s[28:31], s44 offen offset:0 sc1
  buffer_load_dword v17, v8, s[28:31], s44 offen offset:256 sc1
  buffer_load_dword v21, v11, s[28:31], s44 offen offset:256 sc1
  buffer_load_dword v18, v8, s[28:31], s44 offen offset:512 sc1
  buffer_load_dword v22, v11, s[28:31], s44 offen offset:512 sc1
  buffer_load_dword v19, v8, s[28:31], s44 offen offset:768 sc1
  buffer_load_dword v23, v11, s[28:31], s44 offen offset:768 sc1
  s_waitcnt vmcnt(0)
  v_add_f32 v16, v16, v17
  v_add_f32 v18, v18, v19
  v_add_f32 v9, v16, v18
  v_add_f32 v20, v20, v21
  v_add_f32 v22, v22, v23
  v_add_f32 v12, v20, v22
  v_lshlrev_b32 v8, 2, v0
  v_add_u32 v8, 28672, v8
  ds_write_b32 v8, v9
  ds_write_b32 v8, v12 offset:1024
  s_waitcnt lgkmcnt(0)
  s_barrier
  s_mov_b32 s71, 0
L_p5re_41:
  v_min_u32 v8, 13, v1
  v_lshlrev_b32 v8, 8, v8
  s_mul_i32 s44, s77, 3584
  s_add_u32 s44, s44, 65536
L_p5pr_42:
  buffer_load_dword v9, v8, s[28:31], s44 offen sc1
  s_waitcnt vmcnt(0)
  v_cmp_eq_u32 vcc, -1, v9
  s_add_u32 s71, s71, 1
  s_cmp_gt_u32 s71, 400000
  s_cbranch_scc1 L_p5go_43
  s_cbranch_vccnz L_p5pr_42
L_p5go_43:
  v_mul_u32_u24 v7, 1792, v4
  v_lshl_add_u32 v7, v3, 3, v7
  s_mul_i32 s44, s77, 3584
  s_add_u32 s44, s44, 65536
  buffer_load_dwordx2 v[224:225], v7, s[28:31], s44 offen offset:0 sc1
  buffer_load_dwordx2 v[226:227], v7, s[28:31], s44 offen offset:256 sc1
  buffer_load_dwordx2 v[228:229], v7, s[28:31], s44 offen offset:512 sc1
  buffer_load_dwordx2 v[230:231], v7, s[28:31], s44 offen offset:768 sc1
  buffer_load_dwordx2 v[232:233], v7, s[28:31], s44 offen offset:1024 sc1
  buffer_load_dwordx2 v[234:235], v7, s[28:31], s44 offen offset:1280 sc1
  buffer_load_dwordx2 v[236:237], v7, s[28:31], s44 offen offset:1536 sc1
  s_mul_i32 s74, s77, 28672
  s_add_u32 s74, s74, 16121856
  buffer_load_dwordx4 v[16:19], v6, s[28:31], s74 offen offset:0 sc1
  buffer_load_dwordx4 v[20:23], v6, s[28:31], s74 offen offset:1024 sc1
  buffer_load_dwordx4 v[24:27], v6, s[28:31], s74 offen offset:2048 sc1
  buffer_load_dwordx4 v[28:31], v6, s[28:31], s74 offen offset:3072 sc1
  s_add_u32 s74, s74, 4096
  buffer_load_dwordx4 v[32:35], v6, s[28:31], s74 offen offset:0 sc1
  buffer_load_dwordx4 v[36:39], v6, s[28:31], s74 offen offset:1024 sc1
  buffer_load_dwordx4 v[40:43], v6, s[28:31], s74 offen offset:2048 sc1
  buffer_load_dwordx4 v[44:47], v6, s[28:31], s74 offen offset:3072 sc1
  s_add_u32 s74, s74, 4096
  buffer_load_dwordx4 v[48:51], v6, s[28:31], s74 offen offset:0 sc1
  buffer_load_dwordx4 v[52:55], v6, s[28:31], s74 offen offset:1024 sc1
  v_lshlrev_b32 v10, 4, v4
  v_add_u32 v10, 28672, v10
  s_mul_i32 s50, s77, 112
  s_mul_i32 s51, s70, 7
  s_add_u32 s50, s50, s51
  s_lshl_b32 s50, s50, 10
  s_add_u32 s79, s50, 17956864
  v_mov_b32 v12, 0xbdd2d3e8
  v_add_u32 v11, 49152, v6
  v_add_u32 v13, 77824, v6
  ds_read_b128 v[192:195], v10 offset:0
  ds_read_b128 v[196:199], v10 offset:32
  ds_read_b128 v[200:203], v10 offset:64
  ds_read_b128 v[204:207], v10 offset:96
  ds_read_b128 v[208:211], v10 offset:128
  ds_read_b128 v[212:215], v10 offset:160
  ds_read_b128 v[216:219], v10 offset:192
  ds_read_b128 v[220:223], v10 offset:224
  ds_read_b128 v[160:163], v11 offset:0
  ds_read_b128 v[164:167], v11 offset:1024
  ds_read_b128 v[168:171], v11 offset:2048
  ds_read_b128 v[172:175], v11 offset:3072
  ds_read_b128 v[176:179], v11 offset:4096
  ds_read_b128 v[180:183], v11 offset:5120
  s_waitcnt lgkmcnt(3)
  s_waitcnt vmcnt(9)
  v_mfma_f32_32x32x16_bf16 v[128:143], v[160:163], v[16:19], 0
  ds_read_b128 v[184:187], v11 offset:6144
  buffer_load_dwordx4 v[56:59], v6, s[28:31], s74 offen offset:2048 sc1
  v_mov_b32 v246, 0
  v_max3_u32 v246, v246, v16, v17
  v_max3_u32 v246, v246, v18, v19
  s_waitcnt vmcnt(9)
  v_mfma_f32_32x32x16_bf16 v[128:143], v[164:167], v[20:23], v[128:143]
  ds_read_b128 v[188:191], v11 offset:7168
  buffer_load_dwordx4 v[60:63], v6, s[28:31], s74 offen offset:3072 sc1
  v_max3_u32 v246, v246, v20, v21
  v_max3_u32 v246, v246, v22, v23
  s_waitcnt vmcnt(9)
  v_mfma_f32_32x32x16_bf16 v[128:143], v[168:171], v[24:27], v[128:143]
  ds_read_b128 v[160:163], v11 offset:8192
  s_add_u32 s74, s74, 4096
  buffer_load_dwordx4 v[64:67], v6, s[28:31], s74 offen offset:0 sc1
  v_max3_u32 v246, v246, v24, v25
  v_max3_u32 v246, v246, v26, v27
  s_waitcnt lgkmcnt(3)
  s_waitcnt vmcnt(9)
  v_mfma_f32_32x32x16_bf16 v[128:143], v[172:175], v[28:31], v[128:143]
  ds_read_b128 v[164:167], v11 offset:9216
  buffer_load_dwordx4 v[68:71], v6, s[28:31], s74 offen offset:1024 sc1
  v_max3_u32 v246, v246, v28, v29
  v_max3_u32 v246, v246, v30, v31
  s_waitcnt vmcnt(9)
  v_mfma_f32_32x32x16_bf16 v[128:143], v[176:179], v[32:35], v[128:143]
  ds_read_b128 v[168:171], v11 offset:10240
  buffer_load_dwordx4 v[72:75], v6, s[28:31], s74 offen offset:2048 sc1
  v_max3_u32 v246, v246, v32, v33
  v_max3_u32 v246, v246, v34, v35
  s_waitcnt vmcnt(9)
  v_mfma_f32_32x32x16_bf16 v[128:143], v[180:183], v[36:39], v[128:143]
  ds_read_b128 v[172:175], v11 offset:11264
  buffer_load_dwordx4 v[76:79], v6, s[28:31], s74 offen offset:3072 sc1
  v_max3_u32 v246, v246, v36, v37
  v_max3_u32 v246, v246, v38, v39
  s_waitcnt lgkmcnt(3)
  s_waitcnt vmcnt(9)
  v_mfma_f32_32x32x16_bf16 v[128:143], v[184:187], v[40:43], v[128:143]
  ds_read_b128 v[176:179], v11 offset:12288
  s_add_u32 s74, s74, 4096
  buffer_load_dwordx4 v[80:83], v6, s[28:31], s74 offen offset:0 sc1
  v_max3_u32 v246, v246, v40, v41
  v_max3_u32 v246, v246, v42, v43
  s_waitcnt vmcnt(9)
  v_mfma_f32_32x32x16_bf16 v[128:143], v[188:191], v[44:47], v[128:143]
  ds_read_b128 v[180:183], v11 offset:13312
  buffer_load_dwordx4 v[84:87], v6, s[28:31], s74 offen offset:1024 sc1
  v_max3_u32 v246, v246, v44, v45
  v_max3_u32 v246, v246, v46, v47
  v_max3_u32 v246, v246, v224, v225
  v_max3_u32 v246, v246, v226, v227
  v_max3_u32 v246, v246, v228, v229
  v_max3_u32 v246, v246, v230, v231
  v_max3_u32 v246, v246, v232, v233
  v_max3_u32 v246, v246, v234, v235
  v_max3_u32 v246, v246, v236, v237
  s_waitcnt vmcnt(9)
  v_mfma_f32_32x32x16_bf16 v[128:143], v[160:163], v[48:51], v[128:143]
  ds_read_b128 v[184:187], v11 offset:14336
  buffer_load_dwordx4 v[88:91], v6, s[28:31], s74 offen offset:2048 sc1
  v_max3_u32 v246, v246, v48, v49
  v_max3_u32 v246, v246, v50, v51
  s_waitcnt lgkmcnt(3)
  s_waitcnt vmcnt(9)
  v_mfma_f32_32x32x16_bf16 v[128:143], v[164:167], v[52:55], v[128:143]
  ds_read_b128 v[188:191], v11 offset:15360
  buffer_load_dwordx4 v[92:95], v6, s[28:31], s74 offen offset:3072 sc1
  v_max3_u32 v246, v246, v52, v53
  v_max3_u32 v246, v246, v54, v55
  v_add_f32 v8, v224, v226
  s_waitcnt vmcnt(9)
  v_mfma_f32_32x32x16_bf16 v[128:143], v[168:171], v[56:59], v[128:143]
  ds_read_b128 v[160:163], v11 offset:16384
  s_add_u32 s74, s74, 4096
  buffer_load_dwordx4 v[96:99], v6, s[28:31], s74 offen offset:0 sc1
  v_max3_u32 v246, v246, v56, v57
  v_max3_u32 v246, v246, v58, v59
  v_add_f32 v8, v8, v228
  s_waitcnt vmcnt(9)
  v_mfma_f32_32x32x16_bf16 v[128:143], v[172:175], v[60:63], v[128:143]
  ds_read_b128 v[164:167], v11 offset:17408
  buffer_load_dwordx4 v[100:103], v6, s[28:31], s74 offen offset:1024 sc1
  v_max3_u32 v246, v246, v60, v61
  v_max3_u32 v246, v246, v62, v63
  s_waitcnt lgkmcnt(3)
  s_waitcnt vmcnt(9)
  v_mfma_f32_32x32x16_bf16 v[128:143], v[176:179], v[64:67], v[128:143]
  ds_read_b128 v[168:171], v11 offset:18432
  buffer_load_dwordx4 v[104:107], v6, s[28:31], s74 offen offset:2048 sc1
  v_max3_u32 v246, v246, v64, v65
  v_max3_u32 v246, v246, v66, v67
  v_add_f32 v8, v8, v230
  s_waitcnt vmcnt(9)
  v_mfma_f32_32x32x16_bf16 v[128:143], v[180:183], v[68:71], v[128:143]
  ds_read_b128 v[172:175], v11 offset:19456
  buffer_load_dwordx4 v[108:111], v6, s[28:31], s74 offen offset:3072 sc1
  v_max3_u32 v246, v246, v68, v69
  v_max3_u32 v246, v246, v70, v71
  v_add_f32 v8, v8, v232
  s_waitcnt vmcnt(9)
  v_mfma_f32_32x32x16_bf16 v[128:143], v[184:187], v[72:75], v[128:143]
  ds_read_b128 v[176:179], v11 offset:20480
  s_add_u32 s74, s74, 4096
  buffer_load_dwordx4 v[112:115], v6, s[28:31], s74 offen offset:0 sc1
  v_max3_u32 v246, v246, v72, v73
  v_max3_u32 v246, v246, v74, v75
  s_waitcnt lgkmcnt(3)
  s_waitcnt vmcnt(9)
  v_mfma_f32_32x32x16_bf16 v[128:143], v[188:191], v[76:79], v[128:143]
  ds_read_b128 v[180:183], v11 offset:21504
  buffer_load_dwordx4 v[116:119], v6, s[28:31], s74 offen offset:1024 sc1
  v_max3_u32 v246, v246, v76, v77
  v_max3_u32 v246, v246, v78, v79
  v_add_f32 v8, v8, v234
  s_waitcnt vmcnt(9)
  v_mfma_f32_32x32x16_bf16 v[128:143], v[160:163], v[80:83], v[128:143]
  ds_read_b128 v[184:187], v11 offset:22528
  buffer_load_dwordx4 v[120:123], v6, s[28:31], s74 offen offset:2048 sc1
  v_max3_u32 v246, v246, v80, v81
  v_max3_u32 v246, v246, v82, v83
  v_add_f32 v8, v8, v236
  s_waitcnt vmcnt(9)
  v_mfma_f32_32x32x16_bf16 v[128:143], v[164:167], v[84:87], v[128:143]
  ds_read_b128 v[188:191], v11 offset:23552
  buffer_load_dwordx4 v[124:127], v6, s[28:31], s74 offen offset:3072 sc1
  v_max3_u32 v246, v246, v84, v85
  v_max3_u32 v246, v246, v86, v87
  s_waitcnt lgkmcnt(3)
  s_waitcnt vmcnt(9)
  v_mfma_f32_32x32x16_bf16 v[128:143], v[168:171], v[88:91], v[128:143]
  ds_read_b128 v[160:163], v11 offset:24576
  v_max3_u32 v246, v246, v88, v89
  v_max3_u32 v246, v246, v90, v91
  v_mov_b32 v9, v8
  s_nop 1
  v_permlane32_swap_b32 v8, v9
  s_waitcnt vmcnt(8)
  v_mfma_f32_32x32x16_bf16 v[128:143], v[172:175], v[92:95], v[128:143]
  ds_read_b128 v[164:167], v11 offset:25600
  v_max3_u32 v246, v246, v92, v93
  v_max3_u32 v246, v246, v94, v95
  s_nop 1
  v_add_f32 v8, v8, v9
  v_mul_f32 v8, 0x3d924925, v8
  s_waitcnt vmcnt(7)
  v_mfma_f32_32x32x16_bf16 v[128:143], v[176:179], v[96:99], v[128:143]
  ds_read_b128 v[168:171], v11 offset:26624
  v_max3_u32 v246, v246, v96, v97
  v_max3_u32 v246, v246, v98, v99
  v_mov_b32 v9, 0
  v_mov_b32 v14, 0
  s_waitcnt lgkmcnt(3)
  s_waitcnt vmcnt(6)
  v_mfma_f32_32x32x16_bf16 v[128:143], v[180:183], v[100:103], v[128:143]
  ds_read_b128 v[172:175], v11 offset:27648
  v_max3_u32 v246, v246, v100, v101
  v_max3_u32 v246, v246, v102, v103
  v_add_u32 v11, 106496, v6
  v_sub_f32 v15, v224, v8
  v_fmac_f32 v9, v15, v15
  s_waitcnt vmcnt(5)
  v_mfma_f32_32x32x16_bf16 v[128:143], v[184:187], v[104:107], v[128:143]
  ds_read_b128 v[176:179], v13 offset:0
  v_max3_u32 v246, v246, v104, v105
  v_max3_u32 v246, v246, v106, v107
  v_add_f32 v14, v14, v225
  v_sub_f32 v15, v226, v8
  v_fmac_f32 v9, v15, v15
  s_waitcnt vmcnt(4)
  v_mfma_f32_32x32x16_bf16 v[128:143], v[188:191], v[108:111], v[128:143]
  ds_read_b128 v[180:183], v13 offset:1024
  v_max3_u32 v246, v246, v108, v109
  v_max3_u32 v246, v246, v110, v111
  v_add_f32 v14, v14, v227
  v_sub_f32 v15, v228, v8
  s_waitcnt lgkmcnt(3)
  s_waitcnt vmcnt(3)
  v_mfma_f32_32x32x16_bf16 v[128:143], v[160:163], v[112:115], v[128:143]
  ds_read_b128 v[184:187], v13 offset:2048
  v_max3_u32 v246, v246, v112, v113
  v_max3_u32 v246, v246, v114, v115
  v_fmac_f32 v9, v15, v15
  v_add_f32 v14, v14, v229
  v_sub_f32 v15, v230, v8
  s_waitcnt vmcnt(2)
  v_mfma_f32_32x32x16_bf16 v[128:143], v[164:167], v[116:119], v[128:143]
  ds_read_b128 v[188:191], v13 offset:3072
  v_max3_u32 v246, v246, v116, v117
  v_max3_u32 v246, v246, v118, v119
  v_fmac_f32 v9, v15, v15
  v_add_f32 v14, v14, v231
  v_sub_f32 v15, v232, v8
  s_waitcnt vmcnt(1)
  v_mfma_f32_32x32x16_bf16 v[128:143], v[168:171], v[120:123], v[128:143]
  ds_read_b128 v[160:163], v13 offset:4096
  v_max3_u32 v246, v246, v120, v121
  v_max3_u32 v246, v246, v122, v123
  v_fmac_f32 v9, v15, v15
  v_add_f32 v14, v14, v233
  s_waitcnt lgkmcnt(3)
  s_waitcnt vmcnt(0)
  v_mfma_f32_32x32x16_bf16 v[128:143], v[172:175], v[124:127], v[128:143]
  ds_read_b128 v[164:167], v13 offset:5120
  v_max3_u32 v246, v246, v124, v125
  v_max3_u32 v246, v246, v126, v127
  v_sub_f32 v15, v234, v8
  v_fmac_f32 v9, v15, v15
  v_add_f32 v14, v14, v235
  v_sub_f32 v15, v236, v8
  v_fmac_f32 v9, v15, v15
  v_add_f32 v14, v14, v237
  v_fmac_f32 v14, 0x42000000, v9
  v_mov_b32 v15, v14
  s_nop 1
  v_permlane32_swap_b32 v14, v15
  s_nop 1
  v_add_f32 v14, v14, v15
  v_mul_f32 v14, 0x3b124925, v14
  v_add_f32 v14, 0x3727c5ac, v14
  v_rsq_f32 v9, v14
  v_sub_f32 v8, 0, v8
  v_cmp_eq_u32 vcc, -1, v246
  s_cmp_gt_u32 s71, 400000
  s_cbranch_scc1 L_p5ok_44
  s_cbranch_vccz L_p5ok_44
  s_waitcnt vmcnt(0) lgkmcnt(0)
  s_branch L_p5re_41
L_p5ok_44:
  s_barrier
  v_mfma_f32_32x32x16_bf16 v[144:159], v[176:179], v[16:19], 0
  ds_read_b128 v[168:171], v13 offset:6144
  s_mul_i32 s74, s3, 7168
  s_add_u32 m0, s74, 49152
  s_add_u32 s74, s74, s78
  s_add_u32 s74, s74, 143360
  buffer_load_dwordx4 v6, s[28:31], s74 offen offset:0 sc1 lds
  v_mfma_f32_32x32x16_bf16 v[144:159], v[180:183], v[20:23], v[144:159]
  ds_read_b128 v[172:175], v13 offset:7168
  v_fmac_f32 v128, v8, v192
  v_fmac_f32 v129, v8, v193
  v_fmac_f32 v130, v8, v194
  v_fmac_f32 v131, v8, v195
  s_waitcnt lgkmcnt(3)
  v_mfma_f32_32x32x16_bf16 v[144:159], v[184:187], v[24:27], v[144:159]
  ds_read_b128 v[176:179], v13 offset:8192
  buffer_load_dwordx4 v6, s[28:31], s74 offen offset:1024 sc1 lds
  v_fmac_f32 v132, v8, v196
  v_fmac_f32 v133, v8, v197
  v_fmac_f32 v134, v8, v198
  v_fmac_f32 v135, v8, v199
  v_mfma_f32_32x32x16_bf16 v[144:159], v[188:191], v[28:31], v[144:159]
  ds_read_b128 v[180:183], v13 offset:9216
  s_xor_b32 s52, s75, 0
  s_mul_i32 s52, s52, 112
  s_mul_i32 s53, s3, 28
  s_add_u32 s52, s52, s53
  s_lshl_b32 s52, s52, 10
  s_add_u32 s54, s52, 2883584
  s_xor_b32 s52, s75, 1
  s_mul_i32 s52, s52, 112
  s_mul_i32 s53, s3, 28
  s_add_u32 s52, s52, s53
  s_lshl_b32 s52, s52, 10
  s_add_u32 s55, s52, 2883584
  s_add_u32 s52, s10, 2
  s_and_b32 s52, s52, 3
  s_mul_i32 s52, s52, 7168
  s_add_u32 s52, s52, s54
  buffer_load_dwordx4 a[32:35], v6, s[28:31], s52 offen offset:0 sc1
  v_mfma_f32_32x32x16_bf16 v[144:159], v[160:163], v[32:35], v[144:159]
  ds_read_b128 v[184:187], v13 offset:10240
  buffer_load_dwordx4 v6, s[28:31], s74 offen offset:2048 sc1 lds
  v_fmac_f32 v136, v8, v200
  v_fmac_f32 v137, v8, v201
  v_fmac_f32 v138, v8, v202
  s_waitcnt lgkmcnt(3)
  v_mfma_f32_32x32x16_bf16 v[144:159], v[164:167], v[36:39], v[144:159]
  ds_read_b128 v[188:191], v13 offset:11264
  v_fmac_f32 v139, v8, v203
  v_fmac_f32 v140, v8, v204
  v_fmac_f32 v141, v8, v205
  v_fmac_f32 v142, v8, v206
  v_fmac_f32 v143, v8, v207
  v_mfma_f32_32x32x16_bf16 v[144:159], v[168:171], v[40:43], v[144:159]
  ds_read_b128 v[160:163], v13 offset:12288
  buffer_load_dwordx4 v6, s[28:31], s74 offen offset:3072 sc1 lds
  v_fma_f32 v128, v128, v9, v208
  v_fma_f32 v129, v129, v9, v209
  v_fma_f32 v130, v130, v9, v210
  v_fma_f32 v131, v131, v9, v211
  v_mfma_f32_32x32x16_bf16 v[144:159], v[172:175], v[44:47], v[144:159]
  ds_read_b128 v[164:167], v13 offset:13312
  buffer_load_dwordx4 a[36:39], v6, s[28:31], s52 offen offset:1024 sc1
  v_fma_f32 v132, v132, v9, v212
  v_fma_f32 v133, v133, v9, v213
  v_fma_f32 v134, v134, v9, v214
  s_waitcnt lgkmcnt(3)
  v_mfma_f32_32x32x16_bf16 v[144:159], v[176:179], v[48:51], v[144:159]
  ds_read_b128 v[168:171], v13 offset:14336
  s_add_u32 m0, m0, 4096
  s_add_u32 s74, s74, 4096
  buffer_load_dwordx4 v6, s[28:31], s74 offen offset:0 sc1 lds
  v_fma_f32 v135, v135, v9, v215
  v_fma_f32 v136, v136, v9, v216
  v_mfma_f32_32x32x16_bf16 v[144:159], v[180:183], v[52:55], v[144:159]
  ds_read_b128 v[172:175], v13 offset:15360
  v_fma_f32 v137, v137, v9, v217
  v_fma_f32 v138, v138, v9, v218
  v_fma_f32 v139, v139, v9, v219
  v_fma_f32 v140, v140, v9, v220
  v_fma_f32 v141, v141, v9, v221
  v_mfma_f32_32x32x16_bf16 v[144:159], v[184:187], v[56:59], v[144:159]
  ds_read_b128 v[176:179], v13 offset:16384
  buffer_load_dwordx4 v6, s[28:31], s74 offen offset:1024 sc1 lds
  v_fma_f32 v142, v142, v9, v222
  v_fma_f32 v143, v143, v9, v223
  v_mul_f32 v224, v128, v128
  s_waitcnt lgkmcnt(3)
  v_mfma_f32_32x32x16_bf16 v[144:159], v[188:191], v[60:63], v[144:159]
  ds_read_b128 v[180:183], v13 offset:17408
  ds_read_b128 v[192:195], v10 offset:256
  buffer_load_dwordx4 a[40:43], v6, s[28:31], s52 offen offset:2048 sc1
  v_mul_f32 v225, v129, v129
  v_mul_f32 v226, v130, v130
  v_mul_f32 v227, v131, v131
  v_mfma_f32_32x32x16_bf16 v[144:159], v[160:163], v[64:67], v[144:159]
  ds_read_b128 v[184:187], v13 offset:18432
  ds_read_b128 v[196:199], v10 offset:288
  buffer_load_dwordx4 v6, s[28:31], s74 offen offset:2048 sc1 lds
  v_mul_f32 v228, v132, v132
  v_mul_f32 v229, v133, v133
  v_mul_f32 v230, v134, v134
  v_mfma_f32_32x32x16_bf16 v[144:159], v[164:167], v[68:71], v[144:159]
  ds_read_b128 v[188:191], v13 offset:19456
  ds_read_b128 v[200:203], v10 offset:320
  v_mul_f32 v231, v135, v135
  v_fmaak_f32 v224, v12, v224, 0xc0135761
  v_fmaak_f32 v225, v12, v225, 0xc0135761
  s_waitcnt lgkmcnt(6)
  v_mfma_f32_32x32x16_bf16 v[144:159], v[168:171], v[72:75], v[144:159]
  ds_read_b128 v[160:163], v13 offset:20480
  ds_read_b128 v[204:207], v10 offset:352
  v_fmaak_f32 v226, v12, v226, 0xc0135761
  v_fmaak_f32 v227, v12, v227, 0xc0135761
  v_fmaak_f32 v228, v12, v228, 0xc0135761
  v_fmaak_f32 v229, v12, v229, 0xc0135761
  v_mfma_f32_32x32x16_bf16 v[144:159], v[172:175], v[76:79], v[144:159]
  ds_read_b128 v[164:167], v13 offset:21504
  ds_read_b128 v[208:211], v10 offset:384
  buffer_load_dwordx4 a[44:47], v6, s[28:31], s52 offen offset:3072 sc1
  v_fmaak_f32 v230, v12, v230, 0xc0135761
  v_fmaak_f32 v231, v12, v231, 0xc0135761
  v_mul_f32 v224, v224, v128
  v_mfma_f32_32x32x16_bf16 v[144:159], v[176:179], v[80:83], v[144:159]
  ds_read_b128 v[168:171], v13 offset:22528
  ds_read_b128 v[212:215], v10 offset:416
  v_mul_f32 v225, v225, v129
  v_mul_f32 v226, v226, v130
  v_mul_f32 v227, v227, v131
  s_waitcnt lgkmcnt(7)
  v_mfma_f32_32x32x16_bf16 v[144:159], v[180:183], v[84:87], v[144:159]
  ds_read_b128 v[172:175], v13 offset:23552
  ds_read_b128 v[216:219], v10 offset:448
  v_mul_f32 v228, v228, v132
  v_mul_f32 v229, v229, v133
  v_mul_f32 v230, v230, v134
  v_mul_f32 v231, v231, v135
  v_mfma_f32_32x32x16_bf16 v[144:159], v[184:187], v[88:91], v[144:159]
  ds_read_b128 v[176:179], v13 offset:24576
  ds_read_b128 v[220:223], v10 offset:480
  v_exp_f32 v224, v224
  v_exp_f32 v225, v225
  v_mfma_f32_32x32x16_bf16 v[144:159], v[188:191], v[92:95], v[144:159]
  ds_read_b128 v[180:183], v13 offset:25600
  s_add_u32 s52, s10, 3
  s_and_b32 s52, s52, 3
  s_mul_i32 s52, s52, 7168
  s_add_u32 s52, s52, s54
  buffer_load_dwordx4 a[48:51], v6, s[28:31], s52 offen offset:0 sc1
  s_waitcnt lgkmcnt(6)
  v_mfma_f32_32x32x16_bf16 v[144:159], v[160:163], v[96:99], v[144:159]
  ds_read_b128 v[184:187], v13 offset:26624
  v_exp_f32 v226, v226
  v_exp_f32 v227, v227
  v_mfma_f32_32x32x16_bf16 v[144:159], v[164:167], v[100:103], v[144:159]
  ds_read_b128 v[188:191], v13 offset:27648
  v_add_u32 v13, 135168, v6
  v_exp_f32 v228, v228
  v_exp_f32 v229, v229
  v_mfma_f32_32x32x16_bf16 v[144:159], v[168:171], v[104:107], v[144:159]
  ds_read_b128 v[160:163], v11 offset:0
  v_exp_f32 v230, v230
  v_exp_f32 v231, v231
  s_waitcnt lgkmcnt(3)
  v_mfma_f32_32x32x16_bf16 v[144:159], v[172:175], v[108:111], v[144:159]
  ds_read_b128 v[164:167], v11 offset:1024
  buffer_load_dwordx4 a[52:55], v6, s[28:31], s52 offen offset:1024 sc1
  v_mul_f32 v128, v128, v136
  v_mul_f32 v129, v129, v137
  v_mul_f32 v130, v130, v138
  v_mul_f32 v131, v131, v139
  v_mfma_f32_32x32x16_bf16 v[144:159], v[176:179], v[112:115], v[144:159]
  ds_read_b128 v[168:171], v11 offset:2048
  v_mul_f32 v132, v132, v140
  v_mul_f32 v133, v133, v141
  v_mul_f32 v134, v134, v142
  v_mul_f32 v135, v135, v143
  v_add_f32 v224, 1.0, v224
  v_mfma_f32_32x32x16_bf16 v[144:159], v[180:183], v[116:119], v[144:159]
  ds_read_b128 v[172:175], v11 offset:3072
  v_add_f32 v225, 1.0, v225
  v_add_f32 v226, 1.0, v226
  v_add_f32 v227, 1.0, v227
  v_add_f32 v228, 1.0, v228
  s_waitcnt lgkmcnt(3)
  v_mfma_f32_32x32x16_bf16 v[144:159], v[184:187], v[120:123], v[144:159]
  ds_read_b128 v[176:179], v11 offset:4096
  v_add_f32 v229, 1.0, v229
  v_add_f32 v230, 1.0, v230
  v_add_f32 v231, 1.0, v231
  v_rcp_f32 v224, v224
  v_mfma_f32_32x32x16_bf16 v[144:159], v[188:191], v[124:127], v[144:159]
  ds_read_b128 v[180:183], v11 offset:5120
  buffer_load_dwordx4 a[56:59], v6, s[28:31], s52 offen offset:2048 sc1
  v_rcp_f32 v225, v225
  v_rcp_f32 v226, v226
  v_rcp_f32 v227, v227
  v_rcp_f32 v228, v228
  v_rcp_f32 v229, v229
  v_rcp_f32 v230, v230
  v_rcp_f32 v231, v231
  s_nop 0
  v_mul_f32 v128, v128, v224
  v_mul_f32 v129, v129, v225
  v_mul_f32 v130, v130, v226
  v_mul_f32 v131, v131, v227
  v_mul_f32 v132, v132, v228
  v_mul_f32 v133, v133, v229
  v_mul_f32 v134, v134, v230
  v_mul_f32 v135, v135, v231
  v_cvt_pk_bf16_f32 v232, v128, v129
  v_cvt_pk_bf16_f32 v233, v130, v131
  v_cvt_pk_bf16_f32 v234, v132, v133
  v_cvt_pk_bf16_f32 v235, v134, v135
  buffer_store_dwordx4 v[232:235], v6, s[28:31], s79 offen sc1
  s_add_u32 s79, s79, 1024
  s_barrier
  v_mfma_f32_32x32x16_bf16 v[128:143], v[160:163], v[16:19], 0
  ds_read_b128 v[184:187], v11 offset:6144
  s_mul_i32 s74, s3, 7168
  s_add_u32 m0, s74, 77824
  s_add_u32 s74, s74, s78
  s_add_u32 s74, s74, 172032
  buffer_load_dwordx4 v6, s[28:31], s74 offen offset:0 sc1 lds
  s_waitcnt lgkmcnt(3)
  v_mfma_f32_32x32x16_bf16 v[128:143], v[164:167], v[20:23], v[128:143]
  ds_read_b128 v[188:191], v11 offset:7168
  v_fmac_f32 v144, v8, v192
  v_fmac_f32 v145, v8, v193
  v_fmac_f32 v146, v8, v194
  v_fmac_f32 v147, v8, v195
  v_fmac_f32 v148, v8, v196
  v_mfma_f32_32x32x16_bf16 v[128:143], v[168:171], v[24:27], v[128:143]
  ds_read_b128 v[160:163], v11 offset:8192
  buffer_load_dwordx4 v6, s[28:31], s74 offen offset:1024 sc1 lds
  v_fmac_f32 v149, v8, v197
  v_fmac_f32 v150, v8, v198
  v_fmac_f32 v151, v8, v199
  v_fmac_f32 v152, v8, v200
  v_mfma_f32_32x32x16_bf16 v[128:143], v[172:175], v[28:31], v[128:143]
  ds_read_b128 v[164:167], v11 offset:9216
  buffer_load_dwordx4 a[60:63], v6, s[28:31], s52 offen offset:3072 sc1
  v_fmac_f32 v153, v8, v201
  v_fmac_f32 v154, v8, v202
  v_fmac_f32 v155, v8, v203
  s_waitcnt lgkmcnt(3)
  v_mfma_f32_32x32x16_bf16 v[128:143], v[176:179], v[32:35], v[128:143]
  ds_read_b128 v[168:171], v11 offset:10240
  buffer_load_dwordx4 v6, s[28:31], s74 offen offset:2048 sc1 lds
  v_fmac_f32 v156, v8, v204
  v_fmac_f32 v157, v8, v205
  v_fmac_f32 v158, v8, v206
  v_fmac_f32 v159, v8, v207
  v_mfma_f32_32x32x16_bf16 v[128:143], v[180:183], v[36:39], v[128:143]
  ds_read_b128 v[172:175], v11 offset:11264
  v_fma_f32 v144, v144, v9, v208
  v_fma_f32 v145, v145, v9, v209
  v_fma_f32 v146, v146, v9, v210
  v_fma_f32 v147, v147, v9, v211
  v_fma_f32 v148, v148, v9, v212
  v_mfma_f32_32x32x16_bf16 v[128:143], v[184:187], v[40:43], v[128:143]
  ds_read_b128 v[176:179], v11 offset:12288
  buffer_load_dwordx4 v6, s[28:31], s74 offen offset:3072 sc1 lds
  v_fma_f32 v149, v149, v9, v213
  v_fma_f32 v150, v150, v9, v214
  v_fma_f32 v151, v151, v9, v215
  s_waitcnt lgkmcnt(3)
  v_mfma_f32_32x32x16_bf16 v[128:143], v[188:191], v[44:47], v[128:143]
  ds_read_b128 v[180:183], v11 offset:13312
  s_add_u32 s52, s10, 0
  s_and_b32 s52, s52, 3
  s_mul_i32 s52, s52, 7168
  s_add_u32 s52, s52, s54
  s_add_u32 s52, s52, 4096
  buffer_load_dwordx4 a[64:67], v6, s[28:31], s52 offen offset:0 sc1
  v_mfma_f32_32x32x16_bf16 v[128:143], v[160:163], v[48:51], v[128:143]
  ds_read_b128 v[184:187], v11 offset:14336
  s_add_u32 m0, m0, 4096
  s_add_u32 s74, s74, 4096
  buffer_load_dwordx4 v6, s[28:31], s74 offen offset:0 sc1 lds
  v_fma_f32 v152, v152, v9, v216
  v_fma_f32 v153, v153, v9, v217
  v_mfma_f32_32x32x16_bf16 v[128:143], v[164:167], v[52:55], v[128:143]
  ds_read_b128 v[188:191], v11 offset:15360
  v_fma_f32 v154, v154, v9, v218
  v_fma_f32 v155, v155, v9, v219
  v_fma_f32 v156, v156, v9, v220
  v_fma_f32 v157, v157, v9, v221
  s_waitcnt lgkmcnt(3)
  v_mfma_f32_32x32x16_bf16 v[128:143], v[168:171], v[56:59], v[128:143]
  ds_read_b128 v[160:163], v11 offset:16384
  buffer_load_dwordx4 v6, s[28:31], s74 offen offset:1024 sc1 lds
  v_fma_f32 v158, v158, v9, v222
  v_fma_f32 v159, v159, v9, v223
  v_mul_f32 v224, v144, v144
  v_mul_f32 v225, v145, v145
  v_mfma_f32_32x32x16_bf16 v[128:143], v[172:175], v[60:63], v[128:143]
  ds_read_b128 v[164:167], v11 offset:17408
  ds_read_b128 v[192:195], v10 offset:512
  buffer_load_dwordx4 a[68:71], v6, s[28:31], s52 offen offset:1024 sc1
  v_mul_f32 v226, v146, v146
  v_mul_f32 v227, v147, v147
  v_mul_f32 v228, v148, v148
  v_mfma_f32_32x32x16_bf16 v[128:143], v[176:179], v[64:67], v[128:143]
  ds_read_b128 v[168:171], v11 offset:18432
  ds_read_b128 v[196:199], v10 offset:544
  buffer_load_dwordx4 v6, s[28:31], s74 offen offset:2048 sc1 lds
  v_mul_f32 v229, v149, v149
  v_mul_f32 v230, v150, v150
  s_waitcnt lgkmcnt(5)
  v_mfma_f32_32x32x16_bf16 v[128:143], v[180:183], v[68:71], v[128:143]
  ds_read_b128 v[172:175], v11 offset:19456
  ds_read_b128 v[200:203], v10 offset:576
  v_mul_f32 v231, v151, v151
  v_fmaak_f32 v224, v12, v224, 0xc0135761
  v_fmaak_f32 v225, v12, v225, 0xc0135761
  v_fmaak_f32 v226, v12, v226, 0xc0135761
  v_mfma_f32_32x32x16_bf16 v[128:143], v[184:187], v[72:75], v[128:143]
  ds_read_b128 v[176:179], v11 offset:20480
  ds_read_b128 v[204:207], v10 offset:608
  v_fmaak_f32 v227, v12, v227, 0xc0135761
  v_fmaak_f32 v228, v12, v228, 0xc0135761
  v_fmaak_f32 v229, v12, v229, 0xc0135761
  v_fmaak_f32 v230, v12, v230, 0xc0135761
  v_mfma_f32_32x32x16_bf16 v[128:143], v[188:191], v[76:79], v[128:143]
  ds_read_b128 v[180:183], v11 offset:21504
  ds_read_b128 v[208:211], v10 offset:640
  buffer_load_dwordx4 a[72:75], v6, s[28:31], s52 offen offset:2048 sc1
  v_fmaak_f32 v231, v12, v231, 0xc0135761
  v_mul_f32 v224, v224, v144
  s_waitcnt lgkmcnt(7)
  v_mfma_f32_32x32x16_bf16 v[128:143], v[160:163], v[80:83], v[128:143]
  ds_read_b128 v[184:187], v11 offset:22528
  ds_read_b128 v[212:215], v10 offset:672
  v_mul_f32 v225, v225, v145
  v_mul_f32 v226, v226, v146
  v_mul_f32 v227, v227, v147
  v_mul_f32 v228, v228, v148
  v_mfma_f32_32x32x16_bf16 v[128:143], v[164:167], v[84:87], v[128:143]
  ds_read_b128 v[188:191], v11 offset:23552
  ds_read_b128 v[216:219], v10 offset:704
  v_mul_f32 v229, v229, v149
  v_mul_f32 v230, v230, v150
  v_mul_f32 v231, v231, v151
  v_mfma_f32_32x32x16_bf16 v[128:143], v[168:171], v[88:91], v[128:143]
  ds_read_b128 v[160:163], v11 offset:24576
  ds_read_b128 v[220:223], v10 offset:736
  v_exp_f32 v224, v224
  s_waitcnt lgkmcnt(7)
  v_mfma_f32_32x32x16_bf16 v[128:143], v[172:175], v[92:95], v[128:143]
  ds_read_b128 v[164:167], v11 offset:25600
  s_add_u32 s52, s10, 1
  s_and_b32 s52, s52, 3
  s_mul_i32 s52, s52, 7168
  s_add_u32 s52, s52, s54
  s_add_u32 s52, s52, 4096
  buffer_load_dwordx4 a[76:79], v6, s[28:31], s52 offen offset:0 sc1
  v_mfma_f32_32x32x16_bf16 v[128:143], v[176:179], v[96:99], v[128:143]
  ds_read_b128 v[168:171], v11 offset:26624
  v_exp_f32 v225, v225
  v_exp_f32 v226, v226
  v_mfma_f32_32x32x16_bf16 v[128:143], v[180:183], v[100:103], v[128:143]
  ds_read_b128 v[172:175], v11 offset:27648
  v_add_u32 v11, 0, v6
  v_exp_f32 v227, v227
  s_waitcnt lgkmcnt(4)
  v_mfma_f32_32x32x16_bf16 v[128:143], v[184:187], v[104:107], v[128:143]
  ds_read_b128 v[176:179], v13 offset:0
  v_exp_f32 v228, v228
  v_exp_f32 v229, v229
  v_mfma_f32_32x32x16_bf16 v[128:143], v[188:191], v[108:111], v[128:143]
  ds_read_b128 v[180:183], v13 offset:1024
  buffer_load_dwordx4 a[80:83], v6, s[28:31], s52 offen offset:1024 sc1
  v_exp_f32 v230, v230
  v_exp_f32 v231, v231
  v_mfma_f32_32x32x16_bf16 v[128:143], v[160:163], v[112:115], v[128:143]
  ds_read_b128 v[184:187], v13 offset:2048
  v_mul_f32 v144, v144, v152
  v_mul_f32 v145, v145, v153
  v_mul_f32 v146, v146, v154
  v_mul_f32 v147, v147, v155
  s_waitcnt lgkmcnt(3)
  v_mfma_f32_32x32x16_bf16 v[128:143], v[164:167], v[116:119], v[128:143]
  ds_read_b128 v[188:191], v13 offset:3072
  v_mul_f32 v148, v148, v156
  v_mul_f32 v149, v149, v157
  v_mul_f32 v150, v150, v158
  v_mul_f32 v151, v151, v159
  v_add_f32 v224, 1.0, v224
  v_mfma_f32_32x32x16_bf16 v[128:143], v[168:171], v[120:123], v[128:143]
  ds_read_b128 v[160:163], v13 offset:4096
  v_add_f32 v225, 1.0, v225
  v_add_f32 v226, 1.0, v226
  v_add_f32 v227, 1.0, v227
  v_add_f32 v228, 1.0, v228
  v_add_f32 v229, 1.0, v229
  v_mfma_f32_32x32x16_bf16 v[128:143], v[172:175], v[124:127], v[128:143]
  ds_read_b128 v[164:167], v13 offset:5120
  buffer_load_dwordx4 a[84:87], v6, s[28:31], s52 offen offset:2048 sc1
  v_add_f32 v230, 1.0, v230
  v_add_f32 v231, 1.0, v231
  v_rcp_f32 v224, v224
  v_rcp_f32 v225, v225
  v_rcp_f32 v226, v226
  v_rcp_f32 v227, v227
  v_rcp_f32 v228, v228
  v_rcp_f32 v229, v229
  v_rcp_f32 v230, v230
  v_rcp_f32 v231, v231
  s_nop 0
  v_mul_f32 v144, v144, v224
  v_mul_f32 v145, v145, v225
  v_mul_f32 v146, v146, v226
  v_mul_f32 v147, v147, v227
  v_mul_f32 v148, v148, v228
  v_mul_f32 v149, v149, v229
  v_mul_f32 v150, v150, v230
  v_mul_f32 v151, v151, v231
  v_cvt_pk_bf16_f32 v232, v144, v145
  v_cvt_pk_bf16_f32 v233, v146, v147
  v_cvt_pk_bf16_f32 v234, v148, v149
  v_cvt_pk_bf16_f32 v235, v150, v151
  buffer_store_dwordx4 v[232:235], v6, s[28:31], s79 offen sc1
  s_add_u32 s79, s79, 1024
  s_waitcnt lgkmcnt(3)
  v_mfma_f32_32x32x16_bf16 v[144:159], v[176:179], v[16:19], 0
  ds_read_b128 v[168:171], v13 offset:6144
  v_mfma_f32_32x32x16_bf16 v[144:159], v[180:183], v[20:23], v[144:159]
  ds_read_b128 v[172:175], v13 offset:7168
  v_fmac_f32 v128, v8, v192
  v_fmac_f32 v129, v8, v193
  v_fmac_f32 v130, v8, v194
  v_fmac_f32 v131, v8, v195
  v_fmac_f32 v132, v8, v196
  v_mfma_f32_32x32x16_bf16 v[144:159], v[184:187], v[24:27], v[144:159]
  ds_read_b128 v[176:179], v13 offset:8192
  v_fmac_f32 v133, v8, v197
  v_fmac_f32 v134, v8, v198
  v_fmac_f32 v135, v8, v199
  v_fmac_f32 v136, v8, v200
  s_waitcnt lgkmcnt(3)
  v_mfma_f32_32x32x16_bf16 v[144:159], v[188:191], v[28:31], v[144:159]
  ds_read_b128 v[180:183], v13 offset:9216
  s_add_u32 s52, s10, 2
  s_and_b32 s52, s52, 3
  s_mul_i32 s52, s52, 7168
  s_add_u32 s52, s52, s54
  s_add_u32 s52, s52, 4096
  buffer_load_dwordx4 a[88:91], v6, s[28:31], s52 offen offset:0 sc1
  v_mfma_f32_32x32x16_bf16 v[144:159], v[160:163], v[32:35], v[144:159]
  ds_read_b128 v[184:187], v13 offset:10240
  v_fmac_f32 v137, v8, v201
  v_fmac_f32 v138, v8, v202
  v_fmac_f32 v139, v8, v203
  v_fmac_f32 v140, v8, v204
  v_fmac_f32 v141, v8, v205
  v_mfma_f32_32x32x16_bf16 v[144:159], v[164:167], v[36:39], v[144:159]
  ds_read_b128 v[188:191], v13 offset:11264
  v_fmac_f32 v142, v8, v206
  v_fmac_f32 v143, v8, v207
  v_fma_f32 v128, v128, v9, v208
  v_fma_f32 v129, v129, v9, v209
  s_waitcnt lgkmcnt(3)
  v_mfma_f32_32x32x16_bf16 v[144:159], v[168:171], v[40:43], v[144:159]
  ds_read_b128 v[160:163], v13 offset:12288
  v_fma_f32 v130, v130, v9, v210
  v_fma_f32 v131, v131, v9, v211
  v_fma_f32 v132, v132, v9, v212
  v_fma_f32 v133, v133, v9, v213
  v_fma_f32 v134, v134, v9, v214
  v_mfma_f32_32x32x16_bf16 v[144:159], v[172:175], v[44:47], v[144:159]
  ds_read_b128 v[164:167], v13 offset:13312
  buffer_load_dwordx4 a[92:95], v6, s[28:31], s52 offen offset:1024 sc1
  v_fma_f32 v135, v135, v9, v215
  v_fma_f32 v136, v136, v9, v216
  v_fma_f32 v137, v137, v9, v217
  v_fma_f32 v138, v138, v9, v218
  v_mfma_f32_32x32x16_bf16 v[144:159], v[176:179], v[48:51], v[144:159]
  ds_read_b128 v[168:171], v13 offset:14336
  v_fma_f32 v139, v139, v9, v219
  v_fma_f32 v140, v140, v9, v220
  v_fma_f32 v141, v141, v9, v221
  v_fma_f32 v142, v142, v9, v222
  s_waitcnt lgkmcnt(3)
  v_mfma_f32_32x32x16_bf16 v[144:159], v[180:183], v[52:55], v[144:159]
  ds_read_b128 v[172:175], v13 offset:15360
  v_fma_f32 v143, v143, v9, v223
  v_mul_f32 v224, v128, v128
  v_mul_f32 v225, v129, v129
  v_mul_f32 v226, v130, v130
  v_mul_f32 v227, v131, v131
  v_mfma_f32_32x32x16_bf16 v[144:159], v[184:187], v[56:59], v[144:159]
  ds_read_b128 v[176:179], v13 offset:16384
  ds_read_b128 v[192:195], v10 offset:768
  v_mul_f32 v228, v132, v132
  v_mul_f32 v229, v133, v133
  v_mul_f32 v230, v134, v134
  v_mul_f32 v231, v135, v135
  v_mfma_f32_32x32x16_bf16 v[144:159], v[188:191], v[60:63], v[144:159]
  ds_read_b128 v[180:183], v13 offset:17408
  ds_read_b128 v[196:199], v10 offset:800
  buffer_load_dwordx4 a[96:99], v6, s[28:31], s52 offen offset:2048 sc1
  v_fmaak_f32 v224, v12, v224, 0xc0135761
  v_fmaak_f32 v225, v12, v225, 0xc0135761
  s_waitcnt lgkmcnt(5)
  v_mfma_f32_32x32x16_bf16 v[144:159], v[160:163], v[64:67], v[144:159]
  ds_read_b128 v[184:187], v13 offset:18432
  ds_read_b128 v[200:203], v10 offset:832
  v_fmaak_f32 v226, v12, v226, 0xc0135761
  v_fmaak_f32 v227, v12, v227, 0xc0135761
  v_fmaak_f32 v228, v12, v228, 0xc0135761
  v_fmaak_f32 v229, v12, v229, 0xc0135761
  v_mfma_f32_32x32x16_bf16 v[144:159], v[164:167], v[68:71], v[144:159]
  ds_read_b128 v[188:191], v13 offset:19456
  ds_read_b128 v[204:207], v10 offset:864
  v_fmaak_f32 v230, v12, v230, 0xc0135761
  v_fmaak_f32 v231, v12, v231, 0xc0135761
  v_mul_f32 v224, v224, v128
  v_mul_f32 v225, v225, v129
  v_mfma_f32_32x32x16_bf16 v[144:159], v[168:171], v[72:75], v[144:159]
  ds_read_b128 v[160:163], v13 offset:20480
  ds_read_b128 v[208:211], v10 offset:896
  v_mul_f32 v226, v226, v130
  v_mul_f32 v227, v227, v131
  v_mul_f32 v228, v228, v132
  s_waitcnt lgkmcnt(7)
  v_mfma_f32_32x32x16_bf16 v[144:159], v[172:175], v[76:79], v[144:159]
  ds_read_b128 v[164:167], v13 offset:21504
  ds_read_b128 v[212:215], v10 offset:928
  s_add_u32 s52, s10, 3
  s_and_b32 s52, s52, 3
  s_mul_i32 s52, s52, 7168
  s_add_u32 s52, s52, s54
  s_add_u32 s52, s52, 4096
  buffer_load_dwordx4 a[100:103], v6, s[28:31], s52 offen offset:0 sc1
  v_mfma_f32_32x32x16_bf16 v[144:159], v[176:179], v[80:83], v[144:159]
  ds_read_b128 v[168:171], v13 offset:22528
  ds_read_b128 v[216:219], v10 offset:960
  v_mul_f32 v229, v229, v133
  v_mul_f32 v230, v230, v134
  v_mul_f32 v231, v231, v135
  v_mfma_f32_32x32x16_bf16 v[144:159], v[180:183], v[84:87], v[144:159]
  ds_read_b128 v[172:175], v13 offset:23552
  ds_read_b128 v[220:223], v10 offset:992
  v_exp_f32 v224, v224
  s_waitcnt lgkmcnt(7)
  v_mfma_f32_32x32x16_bf16 v[144:159], v[184:187], v[88:91], v[144:159]
  ds_read_b128 v[176:179], v13 offset:24576
  v_exp_f32 v225, v225
  v_exp_f32 v226, v226
  v_mfma_f32_32x32x16_bf16 v[144:159], v[188:191], v[92:95], v[144:159]
  ds_read_b128 v[180:183], v13 offset:25600
  buffer_load_dwordx4 a[104:107], v6, s[28:31], s52 offen offset:1024 sc1
  v_exp_f32 v227, v227
  v_exp_f32 v228, v228
  v_mfma_f32_32x32x16_bf16 v[144:159], v[160:163], v[96:99], v[144:159]
  ds_read_b128 v[184:187], v13 offset:26624
  v_exp_f32 v229, v229
  v_exp_f32 v230, v230
  s_waitcnt lgkmcnt(4)
  v_mfma_f32_32x32x16_bf16 v[144:159], v[164:167], v[100:103], v[144:159]
  ds_read_b128 v[188:191], v13 offset:27648
  v_add_u32 v13, 49152, v6
  v_exp_f32 v231, v231
  v_mul_f32 v128, v128, v136
  v_mul_f32 v129, v129, v137
  v_mfma_f32_32x32x16_bf16 v[144:159], v[168:171], v[104:107], v[144:159]
  ds_read_b128 v[160:163], v11 offset:0
  v_mul_f32 v130, v130, v138
  v_mul_f32 v131, v131, v139
  v_mul_f32 v132, v132, v140
  v_mul_f32 v133, v133, v141
  v_mul_f32 v134, v134, v142
  v_mfma_f32_32x32x16_bf16 v[144:159], v[172:175], v[108:111], v[144:159]
  ds_read_b128 v[164:167], v11 offset:1024
  buffer_load_dwordx4 a[108:111], v6, s[28:31], s52 offen offset:2048 sc1
  v_mul_f32 v135, v135, v143
  v_add_f32 v224, 1.0, v224
  v_add_f32 v225, 1.0, v225
  s_waitcnt lgkmcnt(3)
  v_mfma_f32_32x32x16_bf16 v[144:159], v[176:179], v[112:115], v[144:159]
  ds_read_b128 v[168:171], v11 offset:2048
  v_add_f32 v226, 1.0, v226
  v_add_f32 v227, 1.0, v227
  v_add_f32 v228, 1.0, v228
  v_add_f32 v229, 1.0, v229
  v_add_f32 v230, 1.0, v230
  v_mfma_f32_32x32x16_bf16 v[144:159], v[180:183], v[116:119], v[144:159]
  ds_read_b128 v[172:175], v11 offset:3072
  v_add_f32 v231, 1.0, v231
  v_rcp_f32 v224, v224
  v_rcp_f32 v225, v225
  v_mfma_f32_32x32x16_bf16 v[144:159], v[184:187], v[120:123], v[144:159]
  ds_read_b128 v[176:179], v11 offset:4096
  v_rcp_f32 v226, v226
  v_rcp_f32 v227, v227
  s_waitcnt lgkmcnt(3)
  v_mfma_f32_32x32x16_bf16 v[144:159], v[188:191], v[124:127], v[144:159]
  ds_read_b128 v[180:183], v11 offset:5120
  s_add_u32 s52, s10, 2
  s_and_b32 s52, s52, 3
  s_mul_i32 s52, s52, 7168
  s_add_u32 s52, s52, s55
  buffer_load_dwordx4 a[144:147], v6, s[28:31], s52 offen offset:0 sc1
  v_rcp_f32 v228, v228
  v_rcp_f32 v229, v229
  v_rcp_f32 v230, v230
  v_rcp_f32 v231, v231
  s_nop 0
  v_mul_f32 v128, v128, v224
  v_mul_f32 v129, v129, v225
  v_mul_f32 v130, v130, v226
  v_mul_f32 v131, v131, v227
  v_mul_f32 v132, v132, v228
  v_mul_f32 v133, v133, v229
  v_mul_f32 v134, v134, v230
  v_mul_f32 v135, v135, v231
  v_cvt_pk_bf16_f32 v232, v128, v129
  v_cvt_pk_bf16_f32 v233, v130, v131
  v_cvt_pk_bf16_f32 v234, v132, v133
  v_cvt_pk_bf16_f32 v235, v134, v135
  buffer_store_dwordx4 v[232:235], v6, s[28:31], s79 offen sc1
  s_add_u32 s79, s79, 1024
  v_mfma_f32_32x32x16_bf16 v[128:143], v[160:163], v[16:19], 0
  ds_read_b128 v[184:187], v11 offset:6144
  v_mfma_f32_32x32x16_bf16 v[128:143], v[164:167], v[20:23], v[128:143]
  ds_read_b128 v[188:191], v11 offset:7168
  v_fmac_f32 v144, v8, v192
  v_fmac_f32 v145, v8, v193
  v_fmac_f32 v146, v8, v194
  v_fmac_f32 v147, v8, v195
  s_waitcnt lgkmcnt(3)
  v_mfma_f32_32x32x16_bf16 v[128:143], v[168:171], v[24:27], v[128:143]
  ds_read_b128 v[160:163], v11 offset:8192
  v_fmac_f32 v148, v8, v196
  v_fmac_f32 v149, v8, v197
  v_fmac_f32 v150, v8, v198
  v_fmac_f32 v151, v8, v199
  v_fmac_f32 v152, v8, v200
  v_mfma_f32_32x32x16_bf16 v[128:143], v[172:175], v[28:31], v[128:143]
  ds_read_b128 v[164:167], v11 offset:9216
  buffer_load_dwordx4 a[148:151], v6, s[28:31], s52 offen offset:1024 sc1
  v_fmac_f32 v153, v8, v201
  v_fmac_f32 v154, v8, v202
  v_fmac_f32 v155, v8, v203
  v_fmac_f32 v156, v8, v204
  v_mfma_f32_32x32x16_bf16 v[128:143], v[176:179], v[32:35], v[128:143]
  ds_read_b128 v[168:171], v11 offset:10240
  v_fmac_f32 v157, v8, v205
  v_fmac_f32 v158, v8, v206
  v_fmac_f32 v159, v8, v207
  v_fma_f32 v144, v144, v9, v208
  s_waitcnt lgkmcnt(3)
  v_mfma_f32_32x32x16_bf16 v[128:143], v[180:183], v[36:39], v[128:143]
  ds_read_b128 v[172:175], v11 offset:11264
  v_fma_f32 v145, v145, v9, v209
  v_fma_f32 v146, v146, v9, v210
  v_fma_f32 v147, v147, v9, v211
  v_fma_f32 v148, v148, v9, v212
  v_fma_f32 v149, v149, v9, v213
  v_mfma_f32_32x32x16_bf16 v[128:143], v[184:187], v[40:43], v[128:143]
  ds_read_b128 v[176:179], v11 offset:12288
  v_fma_f32 v150, v150, v9, v214
  v_fma_f32 v151, v151, v9, v215
  v_fma_f32 v152, v152, v9, v216
  v_fma_f32 v153, v153, v9, v217
  v_fma_f32 v154, v154, v9, v218
  v_mfma_f32_32x32x16_bf16 v[128:143], v[188:191], v[44:47], v[128:143]
  ds_read_b128 v[180:183], v11 offset:13312
  buffer_load_dwordx4 a[152:155], v6, s[28:31], s52 offen offset:2048 sc1
  v_fma_f32 v155, v155, v9, v219
  v_fma_f32 v156, v156, v9, v220
  v_fma_f32 v157, v157, v9, v221
  s_waitcnt lgkmcnt(3)
  v_mfma_f32_32x32x16_bf16 v[128:143], v[160:163], v[48:51], v[128:143]
  ds_read_b128 v[184:187], v11 offset:14336
  v_fma_f32 v158, v158, v9, v222
  v_fma_f32 v159, v159, v9, v223
  v_mul_f32 v224, v144, v144
  v_mul_f32 v225, v145, v145
  v_mul_f32 v226, v146, v146
  v_mfma_f32_32x32x16_bf16 v[128:143], v[164:167], v[52:55], v[128:143]
  ds_read_b128 v[188:191], v11 offset:15360
  ds_read_b128 v[192:195], v10 offset:1024
  v_mul_f32 v227, v147, v147
  v_mul_f32 v228, v148, v148
  v_mul_f32 v229, v149, v149
  v_mul_f32 v230, v150, v150
  v_mfma_f32_32x32x16_bf16 v[128:143], v[168:171], v[56:59], v[128:143]
  ds_read_b128 v[160:163], v11 offset:16384
  ds_read_b128 v[196:199], v10 offset:1056
  v_mul_f32 v231, v151, v151
  v_fmaak_f32 v224, v12, v224, 0xc0135761
  v_fmaak_f32 v225, v12, v225, 0xc0135761
  s_waitcnt lgkmcnt(5)
  v_mfma_f32_32x32x16_bf16 v[128:143], v[172:175], v[60:63], v[128:143]
  ds_read_b128 v[164:167], v11 offset:17408
  ds_read_b128 v[200:203], v10 offset:1088
  buffer_load_dwordx4 a[156:159], v6, s[28:31], s52 offen offset:3072 sc1
  v_fmaak_f32 v226, v12, v226, 0xc0135761
  v_fmaak_f32 v227, v12, v227, 0xc0135761
  v_fmaak_f32 v228, v12, v228, 0xc0135761
  v_mfma_f32_32x32x16_bf16 v[128:143], v[176:179], v[64:67], v[128:143]
  ds_read_b128 v[168:171], v11 offset:18432
  ds_read_b128 v[204:207], v10 offset:1120
  v_fmaak_f32 v229, v12, v229, 0xc0135761
  v_fmaak_f32 v230, v12, v230, 0xc0135761
  v_fmaak_f32 v231, v12, v231, 0xc0135761
  v_mul_f32 v224, v224, v144
  v_mfma_f32_32x32x16_bf16 v[128:143], v[180:183], v[68:71], v[128:143]
  ds_read_b128 v[172:175], v11 offset:19456
  ds_read_b128 v[208:211], v10 offset:1152
  v_mul_f32 v225, v225, v145
  v_mul_f32 v226, v226, v146
  v_mul_f32 v227, v227, v147
  s_waitcnt lgkmcnt(7)
  v_mfma_f32_32x32x16_bf16 v[128:143], v[184:187], v[72:75], v[128:143]
  ds_read_b128 v[176:179], v11 offset:20480
  ds_read_b128 v[212:215], v10 offset:1184
  v_mul_f32 v228, v228, v148
  v_mul_f32 v229, v229, v149
  v_mul_f32 v230, v230, v150
  v_mul_f32 v231, v231, v151
  v_mfma_f32_32x32x16_bf16 v[128:143], v[188:191], v[76:79], v[128:143]
  ds_read_b128 v[180:183], v11 offset:21504
  ds_read_b128 v[216:219], v10 offset:1216
  s_add_u32 s52, s10, 3
  s_and_b32 s52, s52, 3
  s_mul_i32 s52, s52, 7168
  s_add_u32 s52, s52, s55
  buffer_load_dwordx4 a[160:163], v6, s[28:31], s52 offen offset:0 sc1
  v_mfma_f32_32x32x16_bf16 v[128:143], v[160:163], v[80:83], v[128:143]
  ds_read_b128 v[184:187], v11 offset:22528
  ds_read_b128 v[220:223], v10 offset:1248
  v_exp_f32 v224, v224
  s_waitcnt lgkmcnt(7)
  v_mfma_f32_32x32x16_bf16 v[128:143], v[164:167], v[84:87], v[128:143]
  ds_read_b128 v[188:191], v11 offset:23552
  v_exp_f32 v225, v225
  v_exp_f32 v226, v226
  v_mfma_f32_32x32x16_bf16 v[128:143], v[168:171], v[88:91], v[128:143]
  ds_read_b128 v[160:163], v11 offset:24576
  v_exp_f32 v227, v227
  v_exp_f32 v228, v228
  v_mfma_f32_32x32x16_bf16 v[128:143], v[172:175], v[92:95], v[128:143]
  ds_read_b128 v[164:167], v11 offset:25600
  buffer_load_dwordx4 a[164:167], v6, s[28:31], s52 offen offset:1024 sc1
  v_exp_f32 v229, v229
  s_waitcnt lgkmcnt(4)
  v_mfma_f32_32x32x16_bf16 v[128:143], v[176:179], v[96:99], v[128:143]
  ds_read_b128 v[168:171], v11 offset:26624
  v_exp_f32 v230, v230
  v_exp_f32 v231, v231
  v_mul_f32 v144, v144, v152
  v_mfma_f32_32x32x16_bf16 v[128:143], v[180:183], v[100:103], v[128:143]
  ds_read_b128 v[172:175], v11 offset:27648
  v_add_u32 v11, 77824, v6
  v_mul_f32 v145, v145, v153
  v_mul_f32 v146, v146, v154
  v_mul_f32 v147, v147, v155
  v_mul_f32 v148, v148, v156
  v_mfma_f32_32x32x16_bf16 v[128:143], v[184:187], v[104:107], v[128:143]
  s_waitcnt vmcnt(33)
  s_barrier
  ds_read_b128 v[176:179], v13 offset:0
  v_mul_f32 v149, v149, v157
  v_mul_f32 v150, v150, v158
  s_waitcnt lgkmcnt(3)
  v_mfma_f32_32x32x16_bf16 v[128:143], v[188:191], v[108:111], v[128:143]
  ds_read_b128 v[180:183], v13 offset:1024
  buffer_load_dwordx4 a[168:171], v6, s[28:31], s52 offen offset:2048 sc1
  v_mul_f32 v151, v151, v159
  v_add_f32 v224, 1.0, v224
  v_add_f32 v225, 1.0, v225
  v_add_f32 v226, 1.0, v226
  v_mfma_f32_32x32x16_bf16 v[128:143], v[160:163], v[112:115], v[128:143]
  ds_read_b128 v[184:187], v13 offset:2048
  v_add_f32 v227, 1.0, v227
  v_add_f32 v228, 1.0, v228
  v_add_f32 v229, 1.0, v229
  v_add_f32 v230, 1.0, v230
  v_add_f32 v231, 1.0, v231
  v_mfma_f32_32x32x16_bf16 v[128:143], v[164:167], v[116:119], v[128:143]
  ds_read_b128 v[188:191], v13 offset:3072
  v_rcp_f32 v224, v224
  v_rcp_f32 v225, v225
  s_waitcnt lgkmcnt(3)
  v_mfma_f32_32x32x16_bf16 v[128:143], v[168:171], v[120:123], v[128:143]
  ds_read_b128 v[160:163], v13 offset:4096
  v_rcp_f32 v226, v226
  v_rcp_f32 v227, v227
  v_mfma_f32_32x32x16_bf16 v[128:143], v[172:175], v[124:127], v[128:143]
  ds_read_b128 v[164:167], v13 offset:5120
  buffer_load_dwordx4 a[172:175], v6, s[28:31], s52 offen offset:3072 sc1
  v_rcp_f32 v228, v228
  v_rcp_f32 v229, v229
  v_rcp_f32 v230, v230
  v_rcp_f32 v231, v231
  s_nop 0
  v_mul_f32 v144, v144, v224
  v_mul_f32 v145, v145, v225
  v_mul_f32 v146, v146, v226
  v_mul_f32 v147, v147, v227
  v_mul_f32 v148, v148, v228
  v_mul_f32 v149, v149, v229
  v_mul_f32 v150, v150, v230
  v_mul_f32 v151, v151, v231
  v_cvt_pk_bf16_f32 v232, v144, v145
  v_cvt_pk_bf16_f32 v233, v146, v147
  v_cvt_pk_bf16_f32 v234, v148, v149
  v_cvt_pk_bf16_f32 v235, v150, v151
  buffer_store_dwordx4 v[232:235], v6, s[28:31], s79 offen sc1
  s_add_u32 s79, s79, 1024
  v_mfma_f32_32x32x16_bf16 v[144:159], v[176:179], v[16:19], 0
  ds_read_b128 v[168:171], v13 offset:6144
  s_waitcnt lgkmcnt(3)
  v_mfma_f32_32x32x16_bf16 v[144:159], v[180:183], v[20:23], v[144:159]
  ds_read_b128 v[172:175], v13 offset:7168
  v_fmac_f32 v128, v8, v192
  v_fmac_f32 v129, v8, v193
  v_fmac_f32 v130, v8, v194
  v_fmac_f32 v131, v8, v195
  v_fmac_f32 v132, v8, v196
  v_mfma_f32_32x32x16_bf16 v[144:159], v[184:187], v[24:27], v[144:159]
  ds_read_b128 v[176:179], v13 offset:8192
  v_fmac_f32 v133, v8, v197
  v_fmac_f32 v134, v8, v198
  v_fmac_f32 v135, v8, v199
  v_fmac_f32 v136, v8, v200
  v_fmac_f32 v137, v8, v201
  v_mfma_f32_32x32x16_bf16 v[144:159], v[188:191], v[28:31], v[144:159]
  ds_read_b128 v[180:183], v13 offset:9216
  s_add_u32 s52, s10, 0
  s_and_b32 s52, s52, 3
  s_mul_i32 s52, s52, 7168
  s_add_u32 s52, s52, s55
  s_add_u32 s52, s52, 4096
  buffer_load_dwordx4 a[176:179], v6, s[28:31], s52 offen offset:0 sc1
  s_waitcnt lgkmcnt(3)
  v_mfma_f32_32x32x16_bf16 v[144:159], v[160:163], v[32:35], v[144:159]
  ds_read_b128 v[184:187], v13 offset:10240
  v_fmac_f32 v138, v8, v202
  v_fmac_f32 v139, v8, v203
  v_fmac_f32 v140, v8, v204
  v_fmac_f32 v141, v8, v205
  v_fmac_f32 v142, v8, v206
  v_mfma_f32_32x32x16_bf16 v[144:159], v[164:167], v[36:39], v[144:159]
  ds_read_b128 v[188:191], v13 offset:11264
  v_fmac_f32 v143, v8, v207
  v_fma_f32 v128, v128, v9, v208
  v_fma_f32 v129, v129, v9, v209
  v_fma_f32 v130, v130, v9, v210
  v_fma_f32 v131, v131, v9, v211
  v_mfma_f32_32x32x16_bf16 v[144:159], v[168:171], v[40:43], v[144:159]
  ds_read_b128 v[160:163], v13 offset:12288
  v_fma_f32 v132, v132, v9, v212
  v_fma_f32 v133, v133, v9, v213
  v_fma_f32 v134, v134, v9, v214
  v_fma_f32 v135, v135, v9, v215
  s_waitcnt lgkmcnt(3)
  v_mfma_f32_32x32x16_bf16 v[144:159], v[172:175], v[44:47], v[144:159]
  ds_read_b128 v[164:167], v13 offset:13312
  buffer_load_dwordx4 a[180:183], v6, s[28:31], s52 offen offset:1024 sc1
  v_fma_f32 v136, v136, v9, v216
  v_fma_f32 v137, v137, v9, v217
  v_fma_f32 v138, v138, v9, v218
  v_fma_f32 v139, v139, v9, v219
  v_mfma_f32_32x32x16_bf16 v[144:159], v[176:179], v[48:51], v[144:159]
  ds_read_b128 v[168:171], v13 offset:14336
  v_fma_f32 v140, v140, v9, v220
  v_fma_f32 v141, v141, v9, v221
  v_fma_f32 v142, v142, v9, v222
  v_fma_f32 v143, v143, v9, v223
  v_mul_f32 v224, v128, v128
  v_mfma_f32_32x32x16_bf16 v[144:159], v[180:183], v[52:55], v[144:159]
  ds_read_b128 v[172:175], v13 offset:15360
  ds_read_b128 v[192:195], v10 offset:1280
  v_mul_f32 v225, v129, v129
  v_mul_f32 v226, v130, v130
  v_mul_f32 v227, v131, v131
  s_waitcnt lgkmcnt(4)
  v_mfma_f32_32x32x16_bf16 v[144:159], v[184:187], v[56:59], v[144:159]
  ds_read_b128 v[176:179], v13 offset:16384
  ds_read_b128 v[196:199], v10 offset:1312
  v_mul_f32 v228, v132, v132
  v_mul_f32 v229, v133, v133
  v_mul_f32 v230, v134, v134
  v_mul_f32 v231, v135, v135
  v_mfma_f32_32x32x16_bf16 v[144:159], v[188:191], v[60:63], v[144:159]
  ds_read_b128 v[180:183], v13 offset:17408
  ds_read_b128 v[200:203], v10 offset:1344
  buffer_load_dwordx4 a[184:187], v6, s[28:31], s52 offen offset:2048 sc1
  v_fmaak_f32 v224, v12, v224, 0xc0135761
  v_fmaak_f32 v225, v12, v225, 0xc0135761
  v_fmaak_f32 v226, v12, v226, 0xc0135761
  v_mfma_f32_32x32x16_bf16 v[144:159], v[160:163], v[64:67], v[144:159]
  ds_read_b128 v[184:187], v13 offset:18432
  ds_read_b128 v[204:207], v10 offset:1376
  v_fmaak_f32 v227, v12, v227, 0xc0135761
  v_fmaak_f32 v228, v12, v228, 0xc0135761
  v_fmaak_f32 v229, v12, v229, 0xc0135761
  s_waitcnt lgkmcnt(7)
  v_mfma_f32_32x32x16_bf16 v[144:159], v[164:167], v[68:71], v[144:159]
  ds_read_b128 v[188:191], v13 offset:19456
  ds_read_b128 v[208:211], v10 offset:1408
  v_fmaak_f32 v230, v12, v230, 0xc0135761
  v_fmaak_f32 v231, v12, v231, 0xc0135761
  v_mul_f32 v224, v224, v128
  v_mul_f32 v225, v225, v129
  v_mfma_f32_32x32x16_bf16 v[144:159], v[168:171], v[72:75], v[144:159]
  ds_read_b128 v[160:163], v13 offset:20480
  ds_read_b128 v[212:215], v10 offset:1440
  v_mul_f32 v226, v226, v130
  v_mul_f32 v227, v227, v131
  v_mul_f32 v228, v228, v132
  v_mul_f32 v229, v229, v133
  v_mfma_f32_32x32x16_bf16 v[144:159], v[172:175], v[76:79], v[144:159]
  ds_read_b128 v[164:167], v13 offset:21504
  ds_read_b128 v[216:219], v10 offset:1472
  s_add_u32 s52, s10, 1
  s_and_b32 s52, s52, 3
  s_mul_i32 s52, s52, 7168
  s_add_u32 s52, s52, s55
  s_add_u32 s52, s52, 4096
  buffer_load_dwordx4 a[188:191], v6, s[28:31], s52 offen offset:0 sc1
  s_waitcnt lgkmcnt(7)
  v_mfma_f32_32x32x16_bf16 v[144:159], v[176:179], v[80:83], v[144:159]
  ds_read_b128 v[168:171], v13 offset:22528
  ds_read_b128 v[220:223], v10 offset:1504
  v_mul_f32 v230, v230, v134
  v_mul_f32 v231, v231, v135
  v_exp_f32 v224, v224
  v_mfma_f32_32x32x16_bf16 v[144:159], v[180:183], v[84:87], v[144:159]
  ds_read_b128 v[172:175], v13 offset:23552
  v_exp_f32 v225, v225
  v_exp_f32 v226, v226
  v_mfma_f32_32x32x16_bf16 v[144:159], v[184:187], v[88:91], v[144:159]
  ds_read_b128 v[176:179], v13 offset:24576
  v_exp_f32 v227, v227
  v_exp_f32 v228, v228
  s_waitcnt lgkmcnt(5)
  v_mfma_f32_32x32x16_bf16 v[144:159], v[188:191], v[92:95], v[144:159]
  ds_read_b128 v[180:183], v13 offset:25600
  buffer_load_dwordx4 a[192:195], v6, s[28:31], s52 offen offset:1024 sc1
  v_exp_f32 v229, v229
  v_exp_f32 v230, v230
  v_mfma_f32_32x32x16_bf16 v[144:159], v[160:163], v[96:99], v[144:159]
  ds_read_b128 v[184:187], v13 offset:26624
  v_exp_f32 v231, v231
  v_mul_f32 v128, v128, v136
  v_mul_f32 v129, v129, v137
  v_mul_f32 v130, v130, v138
  v_mfma_f32_32x32x16_bf16 v[144:159], v[164:167], v[100:103], v[144:159]
  ds_read_b128 v[188:191], v13 offset:27648
  v_mul_f32 v131, v131, v139
  v_mul_f32 v132, v132, v140
  v_mul_f32 v133, v133, v141
  v_mul_f32 v134, v134, v142
  s_waitcnt lgkmcnt(3)
  v_mfma_f32_32x32x16_bf16 v[144:159], v[168:171], v[104:107], v[144:159]
  s_waitcnt vmcnt(26)
  s_barrier
  ds_read_b128 v[160:163], v11 offset:0
  v_mul_f32 v135, v135, v143
  v_add_f32 v224, 1.0, v224
  v_add_f32 v225, 1.0, v225
  v_mfma_f32_32x32x16_bf16 v[144:159], v[172:175], v[108:111], v[144:159]
  ds_read_b128 v[164:167], v11 offset:1024
  buffer_load_dwordx4 a[196:199], v6, s[28:31], s52 offen offset:2048 sc1
  v_add_f32 v226, 1.0, v226
  v_add_f32 v227, 1.0, v227
  v_add_f32 v228, 1.0, v228
  v_add_f32 v229, 1.0, v229
  v_mfma_f32_32x32x16_bf16 v[144:159], v[176:179], v[112:115], v[144:159]
  ds_read_b128 v[168:171], v11 offset:2048
  v_add_f32 v230, 1.0, v230
  v_add_f32 v231, 1.0, v231
  v_rcp_f32 v224, v224
  s_waitcnt lgkmcnt(3)
  v_mfma_f32_32x32x16_bf16 v[144:159], v[180:183], v[116:119], v[144:159]
  ds_read_b128 v[172:175], v11 offset:3072
  v_rcp_f32 v225, v225
  v_rcp_f32 v226, v226
  v_mfma_f32_32x32x16_bf16 v[144:159], v[184:187], v[120:123], v[144:159]
  ds_read_b128 v[176:179], v11 offset:4096
  v_rcp_f32 v227, v227
  v_rcp_f32 v228, v228
  v_mfma_f32_32x32x16_bf16 v[144:159], v[188:191], v[124:127], v[144:159]
  ds_read_b128 v[180:183], v11 offset:5120
  s_add_u32 s52, s10, 2
  s_and_b32 s52, s52, 3
  s_mul_i32 s52, s52, 7168
  s_add_u32 s52, s52, s55
  s_add_u32 s52, s52, 4096
  buffer_load_dwordx4 a[200:203], v6, s[28:31], s52 offen offset:0 sc1
  v_rcp_f32 v229, v229
  v_rcp_f32 v230, v230
  v_rcp_f32 v231, v231
  s_nop 0
  v_mul_f32 v128, v128, v224
  v_mul_f32 v129, v129, v225
  v_mul_f32 v130, v130, v226
  v_mul_f32 v131, v131, v227
  v_mul_f32 v132, v132, v228
  v_mul_f32 v133, v133, v229
  v_mul_f32 v134, v134, v230
  v_mul_f32 v135, v135, v231
  v_cvt_pk_bf16_f32 v232, v128, v129
  v_cvt_pk_bf16_f32 v233, v130, v131
  v_cvt_pk_bf16_f32 v234, v132, v133
  v_cvt_pk_bf16_f32 v235, v134, v135
  buffer_store_dwordx4 v[232:235], v6, s[28:31], s79 offen sc1
  s_add_u32 s79, s79, 1024
  s_waitcnt lgkmcnt(3)
  s_waitcnt vmcnt(8)
  s_barrier
  s_lshl_b32 s44, s69, 4
  s_add_u32 s44, s44, s70
  s_lshl_b32 s44, s44, 8
  s_add_u32 s48, s44, 786432
  s_cmp_lg_u32 s3, 0
  s_cbranch_scc1 L_pub_46
  v_mov_b32 v14, s64
  v_mov_b32 v15, 0
  s_mov_b64 exec, 1
  buffer_store_dword v14, v15, s[28:31], s48 offen sc1
  s_mov_b64 exec, -1
L_pub_46:
  v_mfma_f32_32x32x16_bf16 v[128:143], v[160:163], v[16:19], 0
  ds_read_b128 v[184:187], v11 offset:6144
  v_mfma_f32_32x32x16_bf16 v[128:143], v[164:167], v[20:23], v[128:143]
  ds_read_b128 v[188:191], v11 offset:7168
  v_fmac_f32 v144, v8, v192
  v_fmac_f32 v145, v8, v193
  v_fmac_f32 v146, v8, v194
  v_fmac_f32 v147, v8, v195
  v_fmac_f32 v148, v8, v196
  v_mfma_f32_32x32x16_bf16 v[128:143], v[168:171], v[24:27], v[128:143]
  ds_read_b128 v[160:163], v11 offset:8192
  s_lshr_b32 s44, s67, 1
  s_lshl_b32 s44, s44, 4
  s_lshl_b32 s45, s3, 2
  s_add_u32 s44, s44, s45
  s_lshl_b32 s44, s44, 8
  s_add_u32 s48, s44, 786432
  v_and_b32 v15, 3, v1
  v_lshlrev_b32 v245, 8, v15
  buffer_load_dword v244, v245, s[28:31], s48 offen sc1
  s_waitcnt lgkmcnt(3)
  v_mfma_f32_32x32x16_bf16 v[128:143], v[172:175], v[28:31], v[128:143]
  ds_read_b128 v[164:167], v11 offset:9216
  buffer_load_dwordx4 a[204:207], v6, s[28:31], s52 offen offset:1024 sc1
  v_fmac_f32 v149, v8, v197
  v_fmac_f32 v150, v8, v198
  v_fmac_f32 v151, v8, v199
  v_fmac_f32 v152, v8, v200
  v_mfma_f32_32x32x16_bf16 v[128:143], v[176:179], v[32:35], v[128:143]
  ds_read_b128 v[168:171], v11 offset:10240
  v_fmac_f32 v153, v8, v201
  v_fmac_f32 v154, v8, v202
  v_fmac_f32 v155, v8, v203
  v_fmac_f32 v156, v8, v204
  v_fmac_f32 v157, v8, v205
  v_mfma_f32_32x32x16_bf16 v[128:143], v[180:183], v[36:39], v[128:143]
  ds_read_b128 v[172:175], v11 offset:11264
  v_fmac_f32 v158, v8, v206
  v_fmac_f32 v159, v8, v207
  v_fma_f32 v144, v144, v9, v208
  v_fma_f32 v145, v145, v9, v209
  s_waitcnt lgkmcnt(3)
  v_mfma_f32_32x32x16_bf16 v[128:143], v[184:187], v[40:43], v[128:143]
  ds_read_b128 v[176:179], v11 offset:12288
  s_lshl_b32 s44, s68, 6
  s_add_u32 s44, s44, 2240
  v_and_b32 v15, 63, v0
  v_add_u32 v15, s44, v15
  v_lshlrev_b32 v246, 3, v15
  buffer_load_dwordx2 v[236:237], v246, s[28:31], s18 offen sc1
  buffer_load_dwordx2 v[238:239], v246, s[28:31], s19 offen sc1
  buffer_load_dwordx2 v[240:241], v246, s[28:31], s20 offen sc1
  buffer_load_dwordx2 v[242:243], v246, s[28:31], s21 offen sc1
  v_mfma_f32_32x32x16_bf16 v[128:143], v[188:191], v[44:47], v[128:143]
  ds_read_b128 v[180:183], v11 offset:13312
  buffer_load_dwordx4 a[208:211], v6, s[28:31], s52 offen offset:2048 sc1
  v_fma_f32 v146, v146, v9, v210
  v_fma_f32 v147, v147, v9, v211
  v_fma_f32 v148, v148, v9, v212
  v_fma_f32 v149, v149, v9, v213
  v_mfma_f32_32x32x16_bf16 v[128:143], v[160:163], v[48:51], v[128:143]
  ds_read_b128 v[184:187], v11 offset:14336
  v_fma_f32 v150, v150, v9, v214
  v_fma_f32 v151, v151, v9, v215
  v_fma_f32 v152, v152, v9, v216
  v_fma_f32 v153, v153, v9, v217
  s_waitcnt lgkmcnt(3)
  v_mfma_f32_32x32x16_bf16 v[128:143], v[164:167], v[52:55], v[128:143]
  ds_read_b128 v[188:191], v11 offset:15360
  v_fma_f32 v154, v154, v9, v218
  v_fma_f32 v155, v155, v9, v219
  v_fma_f32 v156, v156, v9, v220
  v_fma_f32 v157, v157, v9, v221
  v_fma_f32 v158, v158, v9, v222
  v_mfma_f32_32x32x16_bf16 v[128:143], v[168:171], v[56:59], v[128:143]
  ds_read_b128 v[160:163], v11 offset:16384
  v_fma_f32 v159, v159, v9, v223
  v_mul_f32 v224, v144, v144
  v_mul_f32 v225, v145, v145
  v_mul_f32 v226, v146, v146
  v_mul_f32 v227, v147, v147
  v_mfma_f32_32x32x16_bf16 v[128:143], v[172:175], v[60:63], v[128:143]
  ds_read_b128 v[164:167], v11 offset:17408
  ds_read_b128 v[192:195], v10 offset:1536
  s_add_u32 s52, s10, 3
  s_and_b32 s52, s52, 3
  s_mul_i32 s52, s52, 7168
  s_add_u32 s52, s52, s55
  s_add_u32 s52, s52, 4096
  buffer_load_dwordx4 a[212:215], v6, s[28:31], s52 offen offset:0 sc1
  s_waitcnt lgkmcnt(4)
  v_mfma_f32_32x32x16_bf16 v[128:143], v[176:179], v[64:67], v[128:143]
  ds_read_b128 v[168:171], v11 offset:18432
  ds_read_b128 v[196:199], v10 offset:1568
  v_mul_f32 v228, v148, v148
  v_mul_f32 v229, v149, v149
  v_mul_f32 v230, v150, v150
  v_mul_f32 v231, v151, v151
  v_mfma_f32_32x32x16_bf16 v[128:143], v[180:183], v[68:71], v[128:143]
  ds_read_b128 v[172:175], v11 offset:19456
  ds_read_b128 v[200:203], v10 offset:1600
  v_fmaak_f32 v224, v12, v224, 0xc0135761
  v_fmaak_f32 v225, v12, v225, 0xc0135761
  v_fmaak_f32 v226, v12, v226, 0xc0135761
  v_fmaak_f32 v227, v12, v227, 0xc0135761
  v_mfma_f32_32x32x16_bf16 v[128:143], v[184:187], v[72:75], v[128:143]
  ds_read_b128 v[176:179], v11 offset:20480
  ds_read_b128 v[204:207], v10 offset:1632
  v_fmaak_f32 v228, v12, v228, 0xc0135761
  v_fmaak_f32 v229, v12, v229, 0xc0135761
  v_fmaak_f32 v230, v12, v230, 0xc0135761
  s_waitcnt lgkmcnt(7)
  v_mfma_f32_32x32x16_bf16 v[128:143], v[188:191], v[76:79], v[128:143]
  ds_read_b128 v[180:183], v11 offset:21504
  ds_read_b128 v[208:211], v10 offset:1664
  buffer_load_dwordx4 a[216:219], v6, s[28:31], s52 offen offset:1024 sc1
  v_fmaak_f32 v231, v12, v231, 0xc0135761
  v_mul_f32 v224, v224, v144
  v_mul_f32 v225, v225, v145
  v_mfma_f32_32x32x16_bf16 v[128:143], v[160:163], v[80:83], v[128:143]
  ds_read_b128 v[184:187], v11 offset:22528
  ds_read_b128 v[212:215], v10 offset:1696
  v_mul_f32 v226, v226, v146
  v_mul_f32 v227, v227, v147
  v_mul_f32 v228, v228, v148
  v_mul_f32 v229, v229, v149
  v_mfma_f32_32x32x16_bf16 v[128:143], v[164:167], v[84:87], v[128:143]
  ds_read_b128 v[188:191], v11 offset:23552
  ds_read_b128 v[216:219], v10 offset:1728
  v_mul_f32 v230, v230, v150
  v_mul_f32 v231, v231, v151
  s_waitcnt lgkmcnt(7)
  v_mfma_f32_32x32x16_bf16 v[128:143], v[168:171], v[88:91], v[128:143]
  ds_read_b128 v[160:163], v11 offset:24576
  ds_read_b128 v[220:223], v10 offset:1760
  v_exp_f32 v224, v224
  v_exp_f32 v225, v225
  v_mfma_f32_32x32x16_bf16 v[128:143], v[172:175], v[92:95], v[128:143]
  ds_read_b128 v[164:167], v11 offset:25600
  buffer_load_dwordx4 a[220:223], v6, s[28:31], s52 offen offset:2048 sc1
  v_exp_f32 v226, v226
  v_exp_f32 v227, v227
  v_mfma_f32_32x32x16_bf16 v[128:143], v[176:179], v[96:99], v[128:143]
  ds_read_b128 v[168:171], v11 offset:26624
  v_exp_f32 v228, v228
  v_exp_f32 v229, v229
  s_waitcnt lgkmcnt(5)
  v_mfma_f32_32x32x16_bf16 v[128:143], v[180:183], v[100:103], v[128:143]
  ds_read_b128 v[172:175], v11 offset:27648
  v_exp_f32 v230, v230
  v_exp_f32 v231, v231
  v_mul_f32 v144, v144, v152
  v_mfma_f32_32x32x16_bf16 v[128:143], v[184:187], v[104:107], v[128:143]
  v_mul_f32 v145, v145, v153
  v_mul_f32 v146, v146, v154
  v_mul_f32 v147, v147, v155
  v_mul_f32 v148, v148, v156
  v_mul_f32 v149, v149, v157
  v_mul_f32 v150, v150, v158
  v_mfma_f32_32x32x16_bf16 v[128:143], v[188:191], v[108:111], v[128:143]
  v_mul_f32 v151, v151, v159
  v_add_f32 v224, 1.0, v224
  v_add_f32 v225, 1.0, v225
  v_add_f32 v226, 1.0, v226
  v_add_f32 v227, 1.0, v227
  s_waitcnt lgkmcnt(1)
  v_mfma_f32_32x32x16_bf16 v[128:143], v[160:163], v[112:115], v[128:143]
  v_add_f32 v228, 1.0, v228
  v_add_f32 v229, 1.0, v229
  v_add_f32 v230, 1.0, v230
  v_add_f32 v231, 1.0, v231
  v_rcp_f32 v224, v224
  v_mfma_f32_32x32x16_bf16 v[128:143], v[164:167], v[116:119], v[128:143]
  v_rcp_f32 v225, v225
  v_rcp_f32 v226, v226
  v_rcp_f32 v227, v227
  v_mfma_f32_32x32x16_bf16 v[128:143], v[168:171], v[120:123], v[128:143]
  v_rcp_f32 v228, v228
  v_rcp_f32 v229, v229
  s_waitcnt lgkmcnt(0)
  v_mfma_f32_32x32x16_bf16 v[128:143], v[172:175], v[124:127], v[128:143]
  v_rcp_f32 v230, v230
  v_rcp_f32 v231, v231
  s_nop 0
  v_mul_f32 v144, v144, v224
  v_mul_f32 v145, v145, v225
  v_mul_f32 v146, v146, v226
  v_mul_f32 v147, v147, v227
  v_mul_f32 v148, v148, v228
  v_mul_f32 v149, v149, v229
  v_mul_f32 v150, v150, v230
  v_mul_f32 v151, v151, v231
  v_cvt_pk_bf16_f32 v232, v144, v145
  v_cvt_pk_bf16_f32 v233, v146, v147
  v_cvt_pk_bf16_f32 v234, v148, v149
  v_cvt_pk_bf16_f32 v235, v150, v151
  buffer_store_dwordx4 v[232:235], v6, s[28:31], s79 offen sc1
  s_add_u32 s79, s79, 1024
  s_nop 11
  v_fmac_f32 v128, v8, v192
  v_fmac_f32 v129, v8, v193
  v_fmac_f32 v130, v8, v194
  v_fmac_f32 v131, v8, v195
  v_fmac_f32 v132, v8, v196
  v_fmac_f32 v133, v8, v197
  v_fmac_f32 v134, v8, v198
  v_fmac_f32 v135, v8, v199
  v_fmac_f32 v136, v8, v200
  v_fmac_f32 v137, v8, v201
  v_fmac_f32 v138, v8, v202
  v_fmac_f32 v139, v8, v203
  v_fmac_f32 v140, v8, v204
  v_fmac_f32 v141, v8, v205
  v_fmac_f32 v142, v8, v206
  v_fmac_f32 v143, v8, v207
  v_fma_f32 v128, v128, v9, v208
  v_fma_f32 v129, v129, v9, v209
  v_fma_f32 v130, v130, v9, v210
  v_fma_f32 v131, v131, v9, v211
  v_fma_f32 v132, v132, v9, v212
  v_fma_f32 v133, v133, v9, v213
  v_fma_f32 v134, v134, v9, v214
  v_fma_f32 v135, v135, v9, v215
  v_fma_f32 v136, v136, v9, v216
  v_fma_f32 v137, v137, v9, v217
  v_fma_f32 v138, v138, v9, v218
  v_fma_f32 v139, v139, v9, v219
  v_fma_f32 v140, v140, v9, v220
  v_fma_f32 v141, v141, v9, v221
  v_fma_f32 v142, v142, v9, v222
  v_fma_f32 v143, v143, v9, v223
  v_mul_f32 v224, v128, v128
  v_mul_f32 v225, v129, v129
  v_mul_f32 v226, v130, v130
  v_mul_f32 v227, v131, v131
  v_mul_f32 v228, v132, v132
  v_mul_f32 v229, v133, v133
  v_mul_f32 v230, v134, v134
  v_mul_f32 v231, v135, v135
  v_fmaak_f32 v224, v12, v224, 0xc0135761
  v_fmaak_f32 v225, v12, v225, 0xc0135761
  v_fmaak_f32 v226, v12, v226, 0xc0135761
  v_fmaak_f32 v227, v12, v227, 0xc0135761
  v_fmaak_f32 v228, v12, v228, 0xc0135761
  v_fmaak_f32 v229, v12, v229, 0xc0135761
  v_fmaak_f32 v230, v12, v230, 0xc0135761
  v_fmaak_f32 v231, v12, v231, 0xc0135761
  v_mul_f32 v224, v224, v128
  v_mul_f32 v225, v225, v129
  v_mul_f32 v226, v226, v130
  v_mul_f32 v227, v227, v131
  v_mul_f32 v228, v228, v132
  v_mul_f32 v229, v229, v133
  v_mul_f32 v230, v230, v134
  v_mul_f32 v231, v231, v135
  v_exp_f32 v224, v224
  v_exp_f32 v225, v225
  v_exp_f32 v226, v226
  v_exp_f32 v227, v227
  v_exp_f32 v228, v228
  v_exp_f32 v229, v229
  v_exp_f32 v230, v230
  v_exp_f32 v231, v231
  v_mul_f32 v128, v128, v136
  v_mul_f32 v129, v129, v137
  v_mul_f32 v130, v130, v138
  v_mul_f32 v131, v131, v139
  v_mul_f32 v132, v132, v140
  v_mul_f32 v133, v133, v141
  v_mul_f32 v134, v134, v142
  v_mul_f32 v135, v135, v143
  v_add_f32 v224, 1.0, v224
  v_add_f32 v225, 1.0, v225
  v_add_f32 v226, 1.0, v226
  v_add_f32 v227, 1.0, v227
  v_add_f32 v228, 1.0, v228
  v_add_f32 v229, 1.0, v229
  v_add_f32 v230, 1.0, v230
  v_add_f32 v231, 1.0, v231
  v_rcp_f32 v224, v224
  v_rcp_f32 v225, v225
  v_rcp_f32 v226, v226
  v_rcp_f32 v227, v227
  v_rcp_f32 v228, v228
  v_rcp_f32 v229, v229
  v_rcp_f32 v230, v230
  v_rcp_f32 v231, v231
  s_nop 0
  v_mul_f32 v128, v128, v224
  v_mul_f32 v129, v129, v225
  v_mul_f32 v130, v130, v226
  v_mul_f32 v131, v131, v227
  v_mul_f32 v132, v132, v228
  v_mul_f32 v133, v133, v229
  v_mul_f32 v134, v134, v230
  v_mul_f32 v135, v135, v231
  v_cvt_pk_bf16_f32 v232, v128, v129
  v_cvt_pk_bf16_f32 v233, v130, v131
  v_cvt_pk_bf16_f32 v234, v132, v133
  v_cvt_pk_bf16_f32 v235, v134, v135
  buffer_store_dwordx4 v[232:235], v6, s[28:31], s79 offen sc1
  s_add_u32 s79, s79, 1024
  s_cmp_ge_u32 s2, 224
  s_cbranch_scc1 L_nop6_47
  s_waitcnt vmcnt(11)
  s_lshr_b32 s44, s67, 1
  s_lshl_b32 s44, s44, 4
  s_lshl_b32 s45, s3, 2
  s_add_u32 s44, s44, s45
  s_lshl_b32 s44, s44, 8
  s_add_u32 s48, s44, 786432
  s_mov_b32 s71, 0
L_ahp_50:
  v_cmp_ne_u32 vcc, s64, v244
  s_cbranch_vccz L_ahok_49
  s_add_u32 s71, s71, 1
  s_cmp_gt_u32 s71, 400000
  s_cbranch_scc1 L_ahok_49
  buffer_load_dword v244, v245, s[28:31], s48 offen sc1
  s_waitcnt vmcnt(0)
  s_branch L_ahp_50
L_ahok_49:
  v_mov_b32 v247, v245
  s_xor_b32 s44, s76, 0
  s_mul_i32 s44, s44, 112
  s_mul_i32 s45, s3, 28
  s_add_u32 s44, s44, s45
  s_lshl_b32 s44, s44, 10
  s_add_u32 s52, s44, 17956864
  s_xor_b32 s44, s76, 1
  s_mul_i32 s44, s44, 112
  s_mul_i32 s45, s3, 28
  s_add_u32 s44, s44, s45
  s_lshl_b32 s44, s44, 10
  s_add_u32 s53, s44, 17956864
  s_add_u32 s54, s10, 0
  s_and_b32 s54, s54, 3
  s_mul_i32 s54, s54, 7168
  s_add_u32 s54, s54, s52
  s_add_u32 s55, s10, 0
  s_and_b32 s55, s55, 3
  s_mul_i32 s55, s55, 7168
  s_add_u32 s55, s55, s53
  buffer_load_dwordx4 v[80:83], v6, s[28:31], s54 offen offset:0 sc1
  buffer_load_dwordx4 v[84:87], v6, s[28:31], s55 offen offset:0 sc1
  buffer_load_dwordx4 v[88:91], v6, s[28:31], s54 offen offset:1024 sc1
  buffer_load_dwordx4 v[92:95], v6, s[28:31], s55 offen offset:1024 sc1
  buffer_load_dwordx4 v[96:99], v6, s[28:31], s54 offen offset:2048 sc1
  buffer_load_dwordx4 v[100:103], v6, s[28:31], s55 offen offset:2048 sc1
  buffer_load_dwordx4 v[104:107], v6, s[28:31], s54 offen offset:3072 sc1
  buffer_load_dwordx4 v[108:111], v6, s[28:31], s55 offen offset:3072 sc1
  s_add_u32 s54, s10, 1
  s_and_b32 s54, s54, 3
  s_mul_i32 s54, s54, 7168
  s_add_u32 s54, s54, s52
  s_add_u32 s55, s10, 1
  s_and_b32 s55, s55, 3
  s_mul_i32 s55, s55, 7168
  s_add_u32 s55, s55, s53
  buffer_load_dwordx4 v[112:115], v6, s[28:31], s54 offen offset:0 sc1
  buffer_load_dwordx4 v[116:119], v6, s[28:31], s55 offen offset:0 sc1
  buffer_load_dwordx4 v[120:123], v6, s[28:31], s54 offen offset:1024 sc1
  buffer_load_dwordx4 v[124:127], v6, s[28:31], s55 offen offset:1024 sc1
  s_waitcnt vmcnt(12)
  s_barrier
  s_lshl_b32 s44, s69, 4
  s_add_u32 s44, s44, s70
  s_lshl_b32 s44, s44, 8
  s_add_u32 s48, s44, 589824
  s_cmp_lg_u32 s3, 0
  s_cbranch_scc1 L_pub_51
  v_mov_b32 v14, s64
  v_mov_b32 v15, 0
  s_mov_b64 exec, 1
  buffer_store_dword v14, v15, s[28:31], s48 offen sc1
  s_mov_b64 exec, -1
L_pub_51:
  buffer_load_dwordx4 v[128:131], v6, s[28:31], s54 offen offset:2048 sc1
  buffer_load_dwordx4 v[132:135], v6, s[28:31], s55 offen offset:2048 sc1
  s_waitcnt vmcnt(12)
  v_mfma_f32_32x32x16_bf16 v[16:31], a[0:3], v[80:83], 0
  v_mfma_f32_32x32x16_bf16 v[48:63], a[0:3], v[84:87], 0
  v_mfma_f32_32x32x16_bf16 v[32:47], a[112:115], v[80:83], 0
  v_mfma_f32_32x32x16_bf16 v[64:79], a[112:115], v[84:87], 0
  buffer_load_dwordx4 v[136:139], v6, s[28:31], s54 offen offset:3072 sc1
  buffer_load_dwordx4 v[140:143], v6, s[28:31], s55 offen offset:3072 sc1
  s_waitcnt vmcnt(12)
  v_mfma_f32_32x32x16_bf16 v[16:31], a[4:7], v[88:91], v[16:31]
  v_mfma_f32_32x32x16_bf16 v[48:63], a[4:7], v[92:95], v[48:63]
  v_mfma_f32_32x32x16_bf16 v[32:47], a[116:119], v[88:91], v[32:47]
  v_mfma_f32_32x32x16_bf16 v[64:79], a[116:119], v[92:95], v[64:79]
  s_add_u32 s54, s10, 2
  s_and_b32 s54, s54, 3
  s_mul_i32 s54, s54, 7168
  s_add_u32 s54, s54, s52
  s_add_u32 s55, s10, 2
  s_and_b32 s55, s55, 3
  s_mul_i32 s55, s55, 7168
  s_add_u32 s55, s55, s53
  buffer_load_dwordx4 v[80:83], v6, s[28:31], s54 offen offset:0 sc1
  buffer_load_dwordx4 v[84:87], v6, s[28:31], s55 offen offset:0 sc1
  s_waitcnt vmcnt(12)
  v_mfma_f32_32x32x16_bf16 v[16:31], a[8:11], v[96:99], v[16:31]
  v_mfma_f32_32x32x16_bf16 v[48:63], a[8:11], v[100:103], v[48:63]
  v_mfma_f32_32x32x16_bf16 v[32:47], a[120:123], v[96:99], v[32:47]
  v_mfma_f32_32x32x16_bf16 v[64:79], a[120:123], v[100:103], v[64:79]
  buffer_load_dwordx4 v[88:91], v6, s[28:31], s54 offen offset:1024 sc1
  buffer_load_dwordx4 v[92:95], v6, s[28:31], s55 offen offset:1024 sc1
  s_waitcnt vmcnt(12)
  v_mfma_f32_32x32x16_bf16 v[16:31], a[12:15], v[104:107], v[16:31]
  v_mfma_f32_32x32x16_bf16 v[48:63], a[12:15], v[108:111], v[48:63]
  v_mfma_f32_32x32x16_bf16 v[32:47], a[124:127], v[104:107], v[32:47]
  v_mfma_f32_32x32x16_bf16 v[64:79], a[124:127], v[108:111], v[64:79]
  s_lshr_b32 s44, s67, 1
  s_lshl_b32 s44, s44, 4
  s_lshl_b32 s45, s3, 2
  s_add_u32 s44, s44, s45
  s_lshl_b32 s44, s44, 8
  s_add_u32 s48, s44, 589824
  s_mov_b32 s50, s48
  buffer_load_dword v9, v247, s[28:31], s50 offen sc1
  buffer_load_dwordx4 v[96:99], v6, s[28:31], s54 offen offset:2048 sc1
  buffer_load_dwordx4 v[100:103], v6, s[28:31], s55 offen offset:2048 sc1
  s_waitcnt vmcnt(13)
  v_mfma_f32_32x32x16_bf16 v[16:31], a[16:19], v[112:115], v[16:31]
  v_mfma_f32_32x32x16_bf16 v[48:63], a[16:19], v[116:119], v[48:63]
  v_mfma_f32_32x32x16_bf16 v[32:47], a[128:131], v[112:115], v[32:47]
  v_mfma_f32_32x32x16_bf16 v[64:79], a[128:131], v[116:119], v[64:79]
  buffer_load_dwordx4 v[104:107], v6, s[28:31], s54 offen offset:3072 sc1
  buffer_load_dwordx4 v[108:111], v6, s[28:31], s55 offen offset:3072 sc1
  s_waitcnt vmcnt(13)
  v_mfma_f32_32x32x16_bf16 v[16:31], a[20:23], v[120:123], v[16:31]
  v_mfma_f32_32x32x16_bf16 v[48:63], a[20:23], v[124:127], v[48:63]
  v_mfma_f32_32x32x16_bf16 v[32:47], a[132:135], v[120:123], v[32:47]
  v_mfma_f32_32x32x16_bf16 v[64:79], a[132:135], v[124:127], v[64:79]
  s_add_u32 s54, s10, 3
  s_and_b32 s54, s54, 3
  s_mul_i32 s54, s54, 7168
  s_add_u32 s54, s54, s52
  s_add_u32 s55, s10, 3
  s_and_b32 s55, s55, 3
  s_mul_i32 s55, s55, 7168
  s_add_u32 s55, s55, s53
  buffer_load_dwordx4 v[112:115], v6, s[28:31], s54 offen offset:0 sc1
  buffer_load_dwordx4 v[116:119], v6, s[28:31], s55 offen offset:0 sc1
  s_waitcnt vmcnt(13)
  v_mfma_f32_32x32x16_bf16 v[16:31], a[24:27], v[128:131], v[16:31]
  v_mfma_f32_32x32x16_bf16 v[48:63], a[24:27], v[132:135], v[48:63]
  v_mfma_f32_32x32x16_bf16 v[32:47], a[136:139], v[128:131], v[32:47]
  v_mfma_f32_32x32x16_bf16 v[64:79], a[136:139], v[132:135], v[64:79]
  buffer_load_dwordx4 v[120:123], v6, s[28:31], s54 offen offset:1024 sc1
  buffer_load_dwordx4 v[124:127], v6, s[28:31], s55 offen offset:1024 sc1
  s_waitcnt vmcnt(13)
  v_mfma_f32_32x32x16_bf16 v[16:31], a[28:31], v[136:139], v[16:31]
  v_mfma_f32_32x32x16_bf16 v[48:63], a[28:31], v[140:143], v[48:63]
  v_mfma_f32_32x32x16_bf16 v[32:47], a[140:143], v[136:139], v[32:47]
  v_mfma_f32_32x32x16_bf16 v[64:79], a[140:143], v[140:143], v[64:79]
  buffer_load_dwordx4 v[128:131], v6, s[28:31], s54 offen offset:2048 sc1
  buffer_load_dwordx4 v[132:135], v6, s[28:31], s55 offen offset:2048 sc1
  s_waitcnt vmcnt(13)
  v_mfma_f32_32x32x16_bf16 v[16:31], a[32:35], v[80:83], v[16:31]
  v_mfma_f32_32x32x16_bf16 v[48:63], a[32:35], v[84:87], v[48:63]
  v_mfma_f32_32x32x16_bf16 v[32:47], a[144:147], v[80:83], v[32:47]
  v_mfma_f32_32x32x16_bf16 v[64:79], a[144:147], v[84:87], v[64:79]
  buffer_load_dwordx4 v[136:139], v6, s[28:31], s54 offen offset:3072 sc1
  buffer_load_dwordx4 v[140:143], v6, s[28:31], s55 offen offset:3072 sc1
  s_waitcnt vmcnt(13)
  v_mfma_f32_32x32x16_bf16 v[16:31], a[36:39], v[88:91], v[16:31]
  v_mfma_f32_32x32x16_bf16 v[48:63], a[36:39], v[92:95], v[48:63]
  v_mfma_f32_32x32x16_bf16 v[32:47], a[148:151], v[88:91], v[32:47]
  v_mfma_f32_32x32x16_bf16 v[64:79], a[148:151], v[92:95], v[64:79]
  s_waitcnt vmcnt(12)
  s_mov_b32 s71, 0
L_afp_53:
  v_cmp_ne_u32 vcc, s64, v9
  s_cbranch_vccz L_afok_52
  s_add_u32 s71, s71, 1
  s_cmp_gt_u32 s71, 400000
  s_cbranch_scc1 L_afok_52
  buffer_load_dword v9, v247, s[28:31], s50 offen sc1
  s_waitcnt vmcnt(0)
  s_branch L_afp_53
L_afok_52:
  s_add_u32 s54, s10, 0
  s_and_b32 s54, s54, 3
  s_mul_i32 s54, s54, 7168
  s_add_u32 s54, s54, s52
  s_add_u32 s54, s54, 4096
  s_add_u32 s55, s10, 0
  s_and_b32 s55, s55, 3
  s_mul_i32 s55, s55, 7168
  s_add_u32 s55, s55, s53
  s_add_u32 s55, s55, 4096
  buffer_load_dwordx4 v[80:83], v6, s[28:31], s54 offen offset:0 sc1
  buffer_load_dwordx4 v[84:87], v6, s[28:31], s55 offen offset:0 sc1
  s_waitcnt vmcnt(12)
  v_mfma_f32_32x32x16_bf16 v[16:31], a[40:43], v[96:99], v[16:31]
  v_mfma_f32_32x32x16_bf16 v[48:63], a[40:43], v[100:103], v[48:63]
  v_mfma_f32_32x32x16_bf16 v[32:47], a[152:155], v[96:99], v[32:47]
  v_mfma_f32_32x32x16_bf16 v[64:79], a[152:155], v[100:103], v[64:79]
  buffer_load_dwordx4 v[88:91], v6, s[28:31], s54 offen offset:1024 sc1
  buffer_load_dwordx4 v[92:95], v6, s[28:31], s55 offen offset:1024 sc1
  s_waitcnt vmcnt(12)
  v_mfma_f32_32x32x16_bf16 v[16:31], a[44:47], v[104:107], v[16:31]
  v_mfma_f32_32x32x16_bf16 v[48:63], a[44:47], v[108:111], v[48:63]
  v_mfma_f32_32x32x16_bf16 v[32:47], a[156:159], v[104:107], v[32:47]
  v_mfma_f32_32x32x16_bf16 v[64:79], a[156:159], v[108:111], v[64:79]
  buffer_load_dwordx4 v[96:99], v6, s[28:31], s54 offen offset:2048 sc1
  buffer_load_dwordx4 v[100:103], v6, s[28:31], s55 offen offset:2048 sc1
  s_waitcnt vmcnt(12)
  v_mfma_f32_32x32x16_bf16 v[16:31], a[48:51], v[112:115], v[16:31]
  v_mfma_f32_32x32x16_bf16 v[48:63], a[48:51], v[116:119], v[48:63]
  v_mfma_f32_32x32x16_bf16 v[32:47], a[160:163], v[112:115], v[32:47]
  v_mfma_f32_32x32x16_bf16 v[64:79], a[160:163], v[116:119], v[64:79]
  s_add_u32 s54, s10, 1
  s_and_b32 s54, s54, 3
  s_mul_i32 s54, s54, 7168
  s_add_u32 s54, s54, s52
  s_add_u32 s54, s54, 4096
  s_add_u32 s55, s10, 1
  s_and_b32 s55, s55, 3
  s_mul_i32 s55, s55, 7168
  s_add_u32 s55, s55, s53
  s_add_u32 s55, s55, 4096
  buffer_load_dwordx4 v[104:107], v6, s[28:31], s54 offen offset:0 sc1
  buffer_load_dwordx4 v[108:111], v6, s[28:31], s55 offen offset:0 sc1
  s_waitcnt vmcnt(12)
  v_mfma_f32_32x32x16_bf16 v[16:31], a[52:55], v[120:123], v[16:31]
  v_mfma_f32_32x32x16_bf16 v[48:63], a[52:55], v[124:127], v[48:63]
  v_mfma_f32_32x32x16_bf16 v[32:47], a[164:167], v[120:123], v[32:47]
  v_mfma_f32_32x32x16_bf16 v[64:79], a[164:167], v[124:127], v[64:79]
  buffer_load_dwordx4 v[112:115], v6, s[28:31], s54 offen offset:1024 sc1
  buffer_load_dwordx4 v[116:119], v6, s[28:31], s55 offen offset:1024 sc1
  s_waitcnt vmcnt(12)
  v_mfma_f32_32x32x16_bf16 v[16:31], a[56:59], v[128:131], v[16:31]
  v_mfma_f32_32x32x16_bf16 v[48:63], a[56:59], v[132:135], v[48:63]
  v_mfma_f32_32x32x16_bf16 v[32:47], a[168:171], v[128:131], v[32:47]
  v_mfma_f32_32x32x16_bf16 v[64:79], a[168:171], v[132:135], v[64:79]
  buffer_load_dwordx4 v[120:123], v6, s[28:31], s54 offen offset:2048 sc1
  buffer_load_dwordx4 v[124:127], v6, s[28:31], s55 offen offset:2048 sc1
  s_waitcnt vmcnt(12)
  v_mfma_f32_32x32x16_bf16 v[16:31], a[60:63], v[136:139], v[16:31]
  v_mfma_f32_32x32x16_bf16 v[48:63], a[60:63], v[140:143], v[48:63]
  v_mfma_f32_32x32x16_bf16 v[32:47], a[172:175], v[136:139], v[32:47]
  v_mfma_f32_32x32x16_bf16 v[64:79], a[172:175], v[140:143], v[64:79]
  s_add_u32 s54, s10, 2
  s_and_b32 s54, s54, 3
  s_mul_i32 s54, s54, 7168
  s_add_u32 s54, s54, s52
  s_add_u32 s54, s54, 4096
  s_add_u32 s55, s10, 2
  s_and_b32 s55, s55, 3
  s_mul_i32 s55, s55, 7168
  s_add_u32 s55, s55, s53
  s_add_u32 s55, s55, 4096
  buffer_load_dwordx4 v[128:131], v6, s[28:31], s54 offen offset:0 sc1
  buffer_load_dwordx4 v[132:135], v6, s[28:31], s55 offen offset:0 sc1
  s_waitcnt vmcnt(12)
  v_mfma_f32_32x32x16_bf16 v[16:31], a[64:67], v[80:83], v[16:31]
  v_mfma_f32_32x32x16_bf16 v[48:63], a[64:67], v[84:87], v[48:63]
  v_mfma_f32_32x32x16_bf16 v[32:47], a[176:179], v[80:83], v[32:47]
  v_mfma_f32_32x32x16_bf16 v[64:79], a[176:179], v[84:87], v[64:79]
  buffer_load_dwordx4 v[136:139], v6, s[28:31], s54 offen offset:1024 sc1
  buffer_load_dwordx4 v[140:143], v6, s[28:31], s55 offen offset:1024 sc1
  s_waitcnt vmcnt(12)
  v_mfma_f32_32x32x16_bf16 v[16:31], a[68:71], v[88:91], v[16:31]
  v_mfma_f32_32x32x16_bf16 v[48:63], a[68:71], v[92:95], v[48:63]
  v_mfma_f32_32x32x16_bf16 v[32:47], a[180:183], v[88:91], v[32:47]
  v_mfma_f32_32x32x16_bf16 v[64:79], a[180:183], v[92:95], v[64:79]
  buffer_load_dwordx4 v[80:83], v6, s[28:31], s54 offen offset:2048 sc1
  buffer_load_dwordx4 v[84:87], v6, s[28:31], s55 offen offset:2048 sc1
  s_waitcnt vmcnt(12)
  v_mfma_f32_32x32x16_bf16 v[16:31], a[72:75], v[96:99], v[16:31]
  v_mfma_f32_32x32x16_bf16 v[48:63], a[72:75], v[100:103], v[48:63]
  v_mfma_f32_32x32x16_bf16 v[32:47], a[184:187], v[96:99], v[32:47]
  v_mfma_f32_32x32x16_bf16 v[64:79], a[184:187], v[100:103], v[64:79]
  s_add_u32 s54, s10, 3
  s_and_b32 s54, s54, 3
  s_mul_i32 s54, s54, 7168
  s_add_u32 s54, s54, s52
  s_add_u32 s54, s54, 4096
  s_add_u32 s55, s10, 3
  s_and_b32 s55, s55, 3
  s_mul_i32 s55, s55, 7168
  s_add_u32 s55, s55, s53
  s_add_u32 s55, s55, 4096
  buffer_load_dwordx4 v[88:91], v6, s[28:31], s54 offen offset:0 sc1
  buffer_load_dwordx4 v[92:95], v6, s[28:31], s55 offen offset:0 sc1
  s_waitcnt vmcnt(12)
  v_mfma_f32_32x32x16_bf16 v[16:31], a[76:79], v[104:107], v[16:31]
  v_mfma_f32_32x32x16_bf16 v[48:63], a[76:79], v[108:111], v[48:63]
  v_mfma_f32_32x32x16_bf16 v[32:47], a[188:191], v[104:107], v[32:47]
  v_mfma_f32_32x32x16_bf16 v[64:79], a[188:191], v[108:111], v[64:79]
  buffer_load_dwordx4 v[96:99], v6, s[28:31], s54 offen offset:1024 sc1
  buffer_load_dwordx4 v[100:103], v6, s[28:31], s55 offen offset:1024 sc1
  s_waitcnt vmcnt(12)
  v_mfma_f32_32x32x16_bf16 v[16:31], a[80:83], v[112:115], v[16:31]
  v_mfma_f32_32x32x16_bf16 v[48:63], a[80:83], v[116:119], v[48:63]
  v_mfma_f32_32x32x16_bf16 v[32:47], a[192:195], v[112:115], v[32:47]
  v_mfma_f32_32x32x16_bf16 v[64:79], a[192:195], v[116:119], v[64:79]
  buffer_load_dwordx4 v[104:107], v6, s[28:31], s54 offen offset:2048 sc1
  buffer_load_dwordx4 v[108:111], v6, s[28:31], s55 offen offset:2048 sc1
  s_waitcnt vmcnt(12)
  v_mfma_f32_32x32x16_bf16 v[16:31], a[84:87], v[120:123], v[16:31]
  v_mfma_f32_32x32x16_bf16 v[48:63], a[84:87], v[124:127], v[48:63]
  v_mfma_f32_32x32x16_bf16 v[32:47], a[196:199], v[120:123], v[32:47]
  v_mfma_f32_32x32x16_bf16 v[64:79], a[196:199], v[124:127], v[64:79]
  s_waitcnt vmcnt(10)
  v_mfma_f32_32x32x16_bf16 v[16:31], a[88:91], v[128:131], v[16:31]
  v_mfma_f32_32x32x16_bf16 v[48:63], a[88:91], v[132:135], v[48:63]
  v_mfma_f32_32x32x16_bf16 v[32:47], a[200:203], v[128:131], v[32:47]
  v_mfma_f32_32x32x16_bf16 v[64:79], a[200:203], v[132:135], v[64:79]
  s_mov_b32 s71, 0
L_gbp_55:
  v_cmp_ne_u32 vcc, s64, v237
  v_cmp_ne_u32 s[56:57], s64, v239
  s_or_b64 vcc, vcc, s[56:57]
  v_cmp_ne_u32 s[56:57], s64, v241
  s_or_b64 vcc, vcc, s[56:57]
  v_cmp_ne_u32 s[56:57], s64, v243
  s_or_b64 vcc, vcc, s[56:57]
  s_cbranch_vccz L_gbok_54
  s_add_u32 s71, s71, 1
  s_cmp_gt_u32 s71, 400000
  s_cbranch_scc1 L_gbok_54
  buffer_load_dwordx2 v[236:237], v246, s[28:31], s18 offen sc1
  buffer_load_dwordx2 v[238:239], v246, s[28:31], s19 offen sc1
  buffer_load_dwordx2 v[240:241], v246, s[28:31], s20 offen sc1
  buffer_load_dwordx2 v[242:243], v246, s[28:31], s21 offen sc1
  s_waitcnt vmcnt(0)
  s_branch L_gbp_55
L_gbok_54:
  v_add_f32 v236, v236, v238
  v_add_f32 v240, v240, v242
  v_add_f32 v9, v236, v240
  v_cvt_pk_bf16_f32 v9, v9, v9
  v_lshlrev_b32 v9, 16, v9
  v_and_b32 v8, 63, v0
  v_lshlrev_b32 v8, 2, v8
  v_add_u32 v8, 49152, v8
  ds_write_b32 v8, v9
  s_and_b32 s44, s3, 1
  s_lshl_b32 s44, s44, 7
  v_lshlrev_b32 v8, 4, v4
  v_add_u32 v8, s44, v8
  v_add_u32 v8, 49152, v8
  s_waitcnt lgkmcnt(0)
  ds_read_b128 v[160:163], v8 offset:0
  ds_read_b128 v[164:167], v8 offset:32
  ds_read_b128 v[168:171], v8 offset:64
  ds_read_b128 v[172:175], v8 offset:96
  s_mov_b32 s58, 0xffff0000
  v_lshlrev_b32 v192, 16, v248
  v_and_b32 v193, s58, v248
  v_lshlrev_b32 v194, 16, v249
  v_and_b32 v195, s58, v249
  v_lshlrev_b32 v196, 16, v250
  v_and_b32 v197, s58, v250
  v_lshlrev_b32 v198, 16, v251
  v_and_b32 v199, s58, v251
  v_lshlrev_b32 v200, 16, v252
  v_and_b32 v201, s58, v252
  v_lshlrev_b32 v202, 16, v253
  v_and_b32 v203, s58, v253
  v_lshlrev_b32 v204, 16, v254
  v_and_b32 v205, s58, v254
  v_lshlrev_b32 v206, 16, v255
  v_and_b32 v207, s58, v255
  s_mov_b32 s32, s22
  s_and_b32 s33, s23, 0xffff
  s_mov_b32 s34, 1835008
  s_mov_b32 s35, 0x20000
  s_lshl_b32 s44, s76, 5
  v_add_u32 v5, s44, v3
  v_mul_u32_u24 v7, 896, v5
  v_lshl_add_u32 v7, v4, 4, v7
  s_lshl_b32 s44, s75, 6
  v_add_u32 v7, s44, v7
  s_waitcnt vmcnt(8)
  v_mfma_f32_32x32x16_bf16 v[16:31], a[92:95], v[136:139], v[16:31]
  v_mfma_f32_32x32x16_bf16 v[48:63], a[92:95], v[140:143], v[48:63]
  v_mfma_f32_32x32x16_bf16 v[32:47], a[204:207], v[136:139], v[32:47]
  v_mfma_f32_32x32x16_bf16 v[64:79], a[204:207], v[140:143], v[64:79]
  s_waitcnt vmcnt(6)
  v_mfma_f32_32x32x16_bf16 v[16:31], a[96:99], v[80:83], v[16:31]
  v_mfma_f32_32x32x16_bf16 v[48:63], a[96:99], v[84:87], v[48:63]
  v_mfma_f32_32x32x16_bf16 v[32:47], a[208:211], v[80:83], v[32:47]
  v_mfma_f32_32x32x16_bf16 v[64:79], a[208:211], v[84:87], v[64:79]
  s_waitcnt vmcnt(4)
  v_mfma_f32_32x32x16_bf16 v[16:31], a[100:103], v[88:91], v[16:31]
  v_mfma_f32_32x32x16_bf16 v[48:63], a[100:103], v[92:95], v[48:63]
  v_mfma_f32_32x32x16_bf16 v[32:47], a[212:215], v[88:91], v[32:47]
  v_mfma_f32_32x32x16_bf16 v[64:79], a[212:215], v[92:95], v[64:79]
  s_waitcnt vmcnt(2)
  v_mfma_f32_32x32x16_bf16 v[16:31], a[104:107], v[96:99], v[16:31]
  v_mfma_f32_32x32x16_bf16 v[48:63], a[104:107], v[100:103], v[48:63]
  v_mfma_f32_32x32x16_bf16 v[32:47], a[216:219], v[96:99], v[32:47]
  v_mfma_f32_32x32x16_bf16 v[64:79], a[216:219], v[100:103], v[64:79]
  s_waitcnt vmcnt(0)
  v_mfma_f32_32x32x16_bf16 v[16:31], a[108:111], v[104:107], v[16:31]
  v_mfma_f32_32x32x16_bf16 v[48:63], a[108:111], v[108:111], v[48:63]
  v_mfma_f32_32x32x16_bf16 v[32:47], a[220:223], v[104:107], v[32:47]
  v_mfma_f32_32x32x16_bf16 v[64:79], a[220:223], v[108:111], v[64:79]
  s_nop 6
  s_xor_b32 s44, s3, 1
  s_mul_i32 s44, s44, 3
  s_add_u32 s44, s44, 0
  s_lshl_b32 s44, s44, 12
  v_add_u32 v9, s44, v6
  ds_write_b128 v9, v[32:35] offset:0
  ds_write_b128 v9, v[36:39] offset:1024
  ds_write_b128 v9, v[40:43] offset:2048
  ds_write_b128 v9, v[44:47] offset:3072
  s_xor_b32 s44, s3, 2
  s_mul_i32 s44, s44, 3
  s_add_u32 s44, s44, 1
  s_lshl_b32 s44, s44, 12
  v_add_u32 v9, s44, v6
  ds_write_b128 v9, v[48:51] offset:0
  ds_write_b128 v9, v[52:55] offset:1024
  ds_write_b128 v9, v[56:59] offset:2048
  ds_write_b128 v9, v[60:63] offset:3072
  s_xor_b32 s44, s3, 3
  s_mul_i32 s44, s44, 3
  s_add_u32 s44, s44, 2
  s_lshl_b32 s44, s44, 12
  v_add_u32 v9, s44, v6
  ds_write_b128 v9, v[64:67] offset:0
  ds_write_b128 v9, v[68:71] offset:1024
  ds_write_b128 v9, v[72:75] offset:2048
  ds_write_b128 v9, v[76:79] offset:3072
  s_waitcnt lgkmcnt(0)
  s_barrier
  s_mul_i32 s44, s3, 12288
  v_add_u32 v9, s44, v6
  ds_read_b128 v[32:35], v9 offset:0
  ds_read_b128 v[36:39], v9 offset:1024
  ds_read_b128 v[40:43], v9 offset:2048
  ds_read_b128 v[44:47], v9 offset:3072
  ds_read_b128 v[48:51], v9 offset:4096
  ds_read_b128 v[52:55], v9 offset:5120
  ds_read_b128 v[56:59], v9 offset:6144
  ds_read_b128 v[60:63], v9 offset:7168
  ds_read_b128 v[64:67], v9 offset:8192
  ds_read_b128 v[68:71], v9 offset:9216
  ds_read_b128 v[72:75], v9 offset:10240
  ds_read_b128 v[76:79], v9 offset:11264
  s_waitcnt lgkmcnt(8)
  v_add_f32 v16, v16, v32
  v_add_f32 v17, v17, v33
  v_add_f32 v18, v18, v34
  v_add_f32 v19, v19, v35
  v_add_f32 v20, v20, v36
  v_add_f32 v21, v21, v37
  v_add_f32 v22, v22, v38
  v_add_f32 v23, v23, v39
  v_add_f32 v24, v24, v40
  v_add_f32 v25, v25, v41
  v_add_f32 v26, v26, v42
  v_add_f32 v27, v27, v43
  v_add_f32 v28, v28, v44
  v_add_f32 v29, v29, v45
  v_add_f32 v30, v30, v46
  v_add_f32 v31, v31, v47
  s_waitcnt lgkmcnt(4)
  v_add_f32 v16, v16, v48
  v_add_f32 v17, v17, v49
  v_add_f32 v18, v18, v50
  v_add_f32 v19, v19, v51
  v_add_f32 v20, v20, v52
  v_add_f32 v21, v21, v53
  v_add_f32 v22, v22, v54
  v_add_f32 v23, v23, v55
  v_add_f32 v24, v24, v56
  v_add_f32 v25, v25, v57
  v_add_f32 v26, v26, v58
  v_add_f32 v27, v27, v59
  v_add_f32 v28, v28, v60
  v_add_f32 v29, v29, v61
  v_add_f32 v30, v30, v62
  v_add_f32 v31, v31, v63
  s_waitcnt lgkmcnt(0)
  v_add_f32 v16, v16, v64
  v_add_f32 v17, v17, v65
  v_add_f32 v18, v18, v66
  v_add_f32 v19, v19, v67
  v_add_f32 v20, v20, v68
  v_add_f32 v21, v21, v69
  v_add_f32 v22, v22, v70
  v_add_f32 v23, v23, v71
  v_add_f32 v24, v24, v72
  v_add_f32 v25, v25, v73
  v_add_f32 v26, v26, v74
  v_add_f32 v27, v27, v75
  v_add_f32 v28, v28, v76
  v_add_f32 v29, v29, v77
  v_add_f32 v30, v30, v78
  v_add_f32 v31, v31, v79
  v_fma_f32 v16, v16, v160, v192
  v_fma_f32 v17, v17, v161, v193
  v_fma_f32 v18, v18, v162, v194
  v_fma_f32 v19, v19, v163, v195
  v_fma_f32 v20, v20, v164, v196
  v_fma_f32 v21, v21, v165, v197
  v_fma_f32 v22, v22, v166, v198
  v_fma_f32 v23, v23, v167, v199
  v_fma_f32 v24, v24, v168, v200
  v_fma_f32 v25, v25, v169, v201
  v_fma_f32 v26, v26, v170, v202
  v_fma_f32 v27, v27, v171, v203
  v_fma_f32 v28, v28, v172, v204
  v_fma_f32 v29, v29, v173, v205
  v_fma_f32 v30, v30, v174, v206
  v_fma_f32 v31, v31, v175, v207
  v_cvt_pk_bf16_f32 v80, v16, v17
  v_cvt_pk_bf16_f32 v81, v18, v19
  v_cvt_pk_bf16_f32 v82, v20, v21
  v_cvt_pk_bf16_f32 v83, v22, v23
  v_cvt_pk_bf16_f32 v84, v24, v25
  v_cvt_pk_bf16_f32 v85, v26, v27
  v_cvt_pk_bf16_f32 v86, v28, v29
  v_cvt_pk_bf16_f32 v87, v30, v31
  s_nop 1
  v_permlane32_swap_b32 v80, v82
  v_permlane32_swap_b32 v81, v83
  v_permlane32_swap_b32 v84, v86
  v_permlane32_swap_b32 v85, v87
  buffer_store_dwordx4 v[80:83], v7, s[32:35], 0 offen offset:0
  buffer_store_dwordx4 v[84:87], v7, s[32:35], 0 offen offset:32
  s_branch L_fin_48
L_nop6_47:
  s_waitcnt vmcnt(0)
  s_barrier
  s_lshl_b32 s44, s69, 4
  s_add_u32 s44, s44, s70
  s_lshl_b32 s44, s44, 8
  s_add_u32 s48, s44, 589824
  s_cmp_lg_u32 s3, 0
  s_cbranch_scc1 L_pub_56
  v_mov_b32 v14, s64
  v_mov_b32 v15, 0
  s_mov_b64 exec, 1
  buffer_store_dword v14, v15, s[28:31], s48 offen sc1
  s_mov_b64 exec, -1
L_pub_56:
L_fin_48:
  s_cmp_lg_u32 s2, 0
  s_cbranch_scc1 L_noep_57
  s_cmp_lg_u32 s3, 0
  s_cbranch_scc1 L_noep_57
  v_mov_b32 v8, s64
  v_mov_b32 v9, 0
  s_mov_b32 s44, 32768
  s_mov_b64 exec, 1
  buffer_store_dword v8, v9, s[28:31], s44 offen sc1
L_noep_57:
L_end:
  s_endpgm
.section .rodata,"a"
.p2align 6
.amdhsa_kernel adaLN_cond__softmax_full_mha__glu_gated_geglu__prompt_kernel
  .amdhsa_next_free_vgpr 512
  .amdhsa_next_free_sgpr 102
  .amdhsa_accum_offset 256
  .amdhsa_group_segment_fixed_size 0
  .amdhsa_kernarg_size 96
  .amdhsa_user_sgpr_count 2
  .amdhsa_user_sgpr_kernarg_segment_ptr 1
  .amdhsa_system_sgpr_workgroup_id_x 1
  .amdhsa_float_denorm_mode_32 3
.end_amdhsa_kernel
```
